```python
import torch

def _softmax(x, axis=-1):
    return torch.softmax(x, dim=axis)
def _gelu(x):
    return torch.nn.functional.gelu(x, approximate="tanh")
def _silu(x):
    return torch.nn.functional.silu(x)
def _sigmoid(x):
    return torch.sigmoid(x)
def _layernorm(x, axis=-1, eps=1e-5):
    m = x.mean(dim=axis, keepdim=True)
    v = x.var(dim=axis, keepdim=True, unbiased=False)
    return (x - m) / torch.sqrt(v + eps)
def _scatter_add(tgt, idx, src, axis=0):
    return tgt.clone().index_add_(axis, idx, src)
def _segment_sum(src, seg, n):
    out = torch.zeros((n,) + src.shape[1:], dtype=src.dtype)
    return out.index_add_(0, seg, src)
def _pad(x, pw):
    flat = tuple(v for pair in reversed(pw) for v in pair)
    return torch.nn.functional.pad(x, flat)

kernel_name = 'recurrent_scan__linear_attn_block__glu_gated_glu__prompt'

def setup_inputs():

    _w = (lambda a: (lambda t: t.to(torch.bfloat16) if t.is_floating_point() else t)(torch.as_tensor(a)))
    def _A_setup():
        B, S, D = 1, 2048, 512
        return {
            "x": _w((lambda *s: torch.randn(*s, dtype=torch.bfloat16) * 0.05)(B, S, D)),
            "wqkv": _w((lambda *s: torch.randn(*s, dtype=torch.bfloat16) * 0.05)(D, 3 * D)),
            "wo": _w((lambda *s: torch.randn(*s, dtype=torch.bfloat16) * 0.05)(D, D)),
        }
    _A_in = _A_setup()

    def _B_setup():
        B, S, D, F = 1, 2048, 512, 1792
        return {
            "x": _w((lambda *s: torch.randn(*s, dtype=torch.bfloat16) * 0.05)(B, S, D)),
            "w_gate": _w((lambda *s: torch.randn(*s, dtype=torch.bfloat16) * 0.05)(D, F)),
            "w_up": _w((lambda *s: torch.randn(*s, dtype=torch.bfloat16) * 0.05)(D, F)),
            "w_down": _w((lambda *s: torch.randn(*s, dtype=torch.bfloat16) * 0.05)(F, D)),
        }
    _B_in = _B_setup()

    return {
        "A_x": _A_in["x"],
        "A_wqkv": _A_in["wqkv"],
        "A_wo": _A_in["wo"],
        "B_x": _B_in["x"],
        "B_w_gate": _B_in["w_gate"],
        "B_w_up": _B_in["w_up"],
        "B_w_down": _B_in["w_down"],
    }

def reference(A_x, A_wqkv, A_wo, B_x, B_w_gate, B_w_up, B_w_down):
    def _A_ref(x, wqkv, wo):
        B, S, D = x.shape
        H = 32; Dh = D // H
        qkv = (lambda x, *d: x.permute(*d))((x @ wqkv).reshape(B, S, 3, H, Dh), 2, 0, 3, 1, 4)
        q, k, v = qkv[0], qkv[1], qkv[2]
        phi = lambda t: torch.where(t > 0, t + 1, torch.exp(t)) + 1e-6
        pq, pk = phi(q), phi(k)
        kv = torch.einsum("bhsd,bhse->bhde", pk, v)
        z = torch.einsum("bhsd->bhd", pk)
        num = torch.einsum("bhqd,bhde->bhqe", pq, kv)
        den = torch.einsum("bhqd,bhd->bhq", pq, z)[..., None] + 1e-6
        o = num / den
        return (lambda x, *d: x.permute(*d))(o, 0, 2, 1, 3).reshape(B, S, D) @ wo

    def _B_ref(x, w_gate, w_up, w_down):
        g = torch.einsum("bsd,df->bsf", x, w_gate)
        u = torch.einsum("bsd,df->bsf", x, w_up)
        h = _sigmoid(g) * u
        return torch.einsum("bsf,fd->bsd", h, w_down)

    x = A_x
    xn = _layernorm(x, axis=-1)
    s = _A_ref(xn, A_wqkv, A_wo)
    g = _silu(_B_ref(xn, B_w_gate, B_w_up, B_w_down))
    return x + s * g
```

```asm
; @launch grid=(256,1,1) block=(256,1,1) lds=163840
.amdgcn_target "amdgcn-amd-amdhsa--gfx950"
.text
.globl recurrent_scan__linear_attn_block__glu_gated_glu__prompt_kernel
.p2align 8
.type recurrent_scan__linear_attn_block__glu_gated_glu__prompt_kernel,@function
recurrent_scan__linear_attn_block__glu_gated_glu__prompt_kernel:
  s_load_dwordx16 s[84:99], s[0:1], 0
  s_cmp_ge_u32 s2, 256
  s_cbranch_scc1 k_exit
  s_getpc_b64 s[78:79]
k_pc:
  s_lshr_b32 s22, s2, 3
  s_lshl_b32 s67, s22, 11
  v_lshl_add_u32 v218, v0, 3, s67
  v_min_u32 v218, k_end-k_pc-8, v218
  global_load_dwordx2 v[252:253], v218, s[78:79]
  v_lshrrev_b32 v218, 6, v0
  v_and_b32 v200, 63, v0
  v_readfirstlane_b32 s64, v218
  s_and_b32 s20, s22, 7
  s_and_b32 s67, s2, 1
  s_lshl_b32 s67, s67, 3
  s_add_u32 s20, s20, s67
  s_lshr_b32 s67, s2, 2
  s_xor_b32 s67, s67, s2
  s_and_b32 s101, s67, 2
  s_lshr_b32 s67, s67, 2
  s_and_b32 s67, s67, 4
  s_or_b32 s101, s101, s67
  v_lshrrev_b32 v218, 3, v200
  v_lshrrev_b32 v219, 4, v200
  v_and_b32 v223, 7, v200
  v_xor_b32 v219, v219, v223
  v_lshlrev_b32 v219, 4, v219
  v_lshl_add_u32 v222, v218, 10, v219
  v_xor_b32 v223, 64, v222
  v_add_u32 v223, 7168, v223
  v_add_u32 v224, 14336, v222
  v_add_u32 v225, 14336, v223
  s_lshl_b32 s65, s64, 12
  s_lshl_b32 s100, s20, 2
  s_add_u32 s76, s100, s64
  s_lshl_b32 s100, s76, 15
  s_mov_b32 s26, 2097152
  s_mov_b32 s27, 0x20000
  s_add_u32 s66, s101, 0
  s_and_b32 s66, s66, 7
  s_lshl_b32 s66, s66, 7
  s_add_u32 m0, s65, 0
  s_add_u32 s66, s66, s100
  s_waitcnt lgkmcnt(0)
  s_mov_b64 s[24:25], s[84:85]
  buffer_load_dwordx4 v222, s[24:27], s66 offen lds
  buffer_load_dwordx4 v223, s[24:27], s66 offen offset:1024 lds
  buffer_load_dwordx4 v224, s[24:27], s66 offen offset:2048 lds
  buffer_load_dwordx4 v225, s[24:27], s66 offen offset:3072 lds
  s_load_dwordx2 s[44:45], s[0:1], 72
  s_load_dwordx2 s[48:49], s[0:1], 64
  s_mov_b64 s[36:37], s[86:87]
  s_mov_b64 s[40:41], s[86:87]
  s_mov_b64 s[28:29], s[92:93]
  s_mov_b64 s[32:33], s[94:95]
  s_mov_b64 s[56:57], s[88:89]
  s_mov_b64 s[52:53], s[96:97]
  s_mov_b64 s[60:61], s[98:99]
  s_lshr_b32 s22, s22, 3
  s_and_b32 s67, s2, 6
  s_lshl_b32 s67, s67, 1
  s_add_u32 s22, s22, s67
  s_mul_i32 s76, s76, 147456
  s_mov_b32 s30, 1835008
  s_mov_b32 s31, 0x20000
  s_mov_b32 s38, 1572864
  s_mov_b32 s39, 0x20000
  s_sub_u32 s32, s32, 2048
  s_subb_u32 s33, s33, 0
  s_mov_b32 s34, 1837056
  s_mov_b32 s35, 0x20000
  s_lshr_b32 s21, s22, 1
  v_and_b32 v219, 16, v200
  v_lshrrev_b32 v219, 2, v219
  v_and_b32 v220, 7, v200
  v_xor_b32 v219, v219, v220
  v_lshlrev_b32 v219, 4, v219
  s_and_b32 s66, s22, 1
  s_cmp_eq_u32 s66, 1
  s_cbranch_scc1 k_B
  s_lshl_b32 s66, s21, 7
  s_add_u32 s66, s66, 1024
  s_lshl_b32 s67, s64, 4
  v_add_u32 v220, s67, v218
  v_mul_u32_u24 v220, 3072, v220
  v_add3_u32 v201, v220, v219, s66
  v_add_u32 v202, 23552, v201
  s_sub_u32 s40, s40, 1024
  s_subb_u32 s41, s41, 0
  s_mov_b32 s42, 1573888
  s_mov_b32 s43, 0x20000
  s_add_u32 s66, s101, 1
  s_and_b32 s66, s66, 7
  s_lshl_b32 s66, s66, 7
  s_add_u32 m0, s65, 16384
  s_add_u32 s66, s66, s100
  buffer_load_dwordx4 v222, s[24:27], s66 offen lds
  buffer_load_dwordx4 v223, s[24:27], s66 offen offset:1024 lds
  buffer_load_dwordx4 v224, s[24:27], s66 offen offset:2048 lds
  buffer_load_dwordx4 v225, s[24:27], s66 offen offset:3072 lds
  s_add_u32 s66, s101, 0
  s_and_b32 s66, s66, 7
  s_lshl_b32 s66, s66, 3
  s_bfe_u32 s67, s20, 65538
  s_add_u32 s66, s66, s67
  s_mul_i32 s66, s66, 24576
  buffer_load_dword a236, v201, s[36:39], s66 offen
  buffer_load_dword a237, v201, s[40:43], s66 offen offset:2048
  s_add_u32 s66, s101, 2
  s_and_b32 s66, s66, 7
  s_lshl_b32 s66, s66, 7
  s_add_u32 m0, s65, 32768
  s_add_u32 s66, s66, s100
  buffer_load_dwordx4 v222, s[24:27], s66 offen lds
  buffer_load_dwordx4 v223, s[24:27], s66 offen offset:1024 lds
  buffer_load_dwordx4 v224, s[24:27], s66 offen offset:2048 lds
  buffer_load_dwordx4 v225, s[24:27], s66 offen offset:3072 lds
  s_mov_b32 s46, 12058624
  s_mov_b32 s47, 0x20000
  s_or_b32 s66, s2, s64
  s_cmp_eq_u32 s66, 0
  s_cselect_b32 s77, 0, 2130706432
  v_lshlrev_b32 v246, 12, v200
  v_add_u32 v246, s77, v246
  v_mov_b32 v247, 0
  s_mov_b32 s67, 11534336
  s_waitcnt lgkmcnt(0)
  buffer_store_dword v247, v246, s[44:47], s67 offen sc1
  s_branch k_A_main
k_B:
  s_lshl_b32 s66, s21, 7
  s_lshl_b32 s67, s64, 4
  v_add_u32 v220, s67, v218
  v_mul_u32_u24 v220, 3584, v220
  v_add3_u32 v201, v220, v219, s66
  v_add_u32 v202, 27648, v201
  s_add_u32 s40, s40, 47104
  s_addc_u32 s41, s41, 0
  s_mov_b32 s42, 1525760
  s_mov_b32 s43, 0x20000
  s_add_u32 s66, s101, 1
  s_and_b32 s66, s66, 7
  s_lshl_b32 s66, s66, 7
  s_add_u32 m0, s65, 16384
  s_add_u32 s66, s66, s100
  buffer_load_dwordx4 v222, s[24:27], s66 offen lds
  buffer_load_dwordx4 v223, s[24:27], s66 offen offset:1024 lds
  buffer_load_dwordx4 v224, s[24:27], s66 offen offset:2048 lds
  buffer_load_dwordx4 v225, s[24:27], s66 offen offset:3072 lds
  s_add_u32 s66, s101, 0
  s_and_b32 s66, s66, 7
  s_lshl_b32 s66, s66, 3
  s_bfe_u32 s67, s20, 65538
  s_add_u32 s66, s66, s67
  s_mul_i32 s66, s66, 28672
  buffer_load_dword a236, v201, s[28:31], s66 offen
  buffer_load_dword a237, v201, s[32:35], s66 offen offset:2048
  s_add_u32 s66, s101, 2
  s_and_b32 s66, s66, 7
  s_lshl_b32 s66, s66, 7
  s_add_u32 m0, s65, 32768
  s_add_u32 s66, s66, s100
  buffer_load_dwordx4 v222, s[24:27], s66 offen lds
  buffer_load_dwordx4 v223, s[24:27], s66 offen offset:1024 lds
  buffer_load_dwordx4 v224, s[24:27], s66 offen offset:2048 lds
  buffer_load_dwordx4 v225, s[24:27], s66 offen offset:3072 lds
  s_mov_b32 s46, 12058624
  s_mov_b32 s47, 0x20000
  s_or_b32 s66, s2, s64
  s_cmp_eq_u32 s66, 0
  s_cselect_b32 s77, 0, 2130706432
  v_lshlrev_b32 v246, 12, v200
  v_add_u32 v246, s77, v246
  v_mov_b32 v247, 0
  s_mov_b32 s67, 11534336
  s_waitcnt lgkmcnt(0)
  buffer_store_dword v247, v246, s[44:47], s67 offen sc1
  s_lshr_b32 s18, s20, 1
  s_lshl_b32 s18, s18, 3
  s_and_b32 s67, s20, 1
  s_add_u32 s18, s18, s67
  s_mov_b32 s50, 256
  s_mov_b32 s51, 0x20000
  s_mov_b32 s54, 1835008
  s_mov_b32 s55, 0x20000
  s_mov_b32 s58, 524288
  s_mov_b32 s59, 0x20000
  s_mov_b32 s62, 2097152
  s_mov_b32 s63, 0x20000
  s_add_u32 s66, s101, 0
  s_and_b32 s66, s66, 7
  s_mul_i32 s84, s66, 229376
  s_mul_i32 s92, s66, 196608
  s_add_u32 s66, s101, 1
  s_and_b32 s66, s66, 7
  s_mul_i32 s85, s66, 229376
  s_mul_i32 s93, s66, 196608
  s_add_u32 s66, s101, 2
  s_and_b32 s66, s66, 7
  s_mul_i32 s86, s66, 229376
  s_mul_i32 s94, s66, 196608
  s_add_u32 s66, s101, 3
  s_and_b32 s66, s66, 7
  s_mul_i32 s87, s66, 229376
  s_mul_i32 s95, s66, 196608
  s_add_u32 s66, s101, 4
  s_and_b32 s66, s66, 7
  s_mul_i32 s88, s66, 229376
  s_mul_i32 s96, s66, 196608
  s_add_u32 s66, s101, 5
  s_and_b32 s66, s66, 7
  s_mul_i32 s89, s66, 229376
  s_mul_i32 s97, s66, 196608
  s_add_u32 s66, s101, 6
  s_and_b32 s66, s66, 7
  s_mul_i32 s90, s66, 229376
  s_mul_i32 s98, s66, 196608
  s_add_u32 s66, s101, 7
  s_and_b32 s66, s66, 7
  s_mul_i32 s91, s66, 229376
  s_mul_i32 s99, s66, 196608
  s_mov_b32 s72, 3216550459
  s_mov_b32 s73, 1069066811
  s_mov_b32 s74, 0xffff0000
  s_mov_b32 s75, 0x358637bd
  s_mov_b32 s78, 0xffff0000
  s_mov_b32 s79, 0xffff0000
  s_lshr_b32 s66, s2, 3
  s_lshr_b32 s19, s66, 2
  s_and_b32 s66, s66, 3
  s_and_b32 s23, s2, 7
  s_lshl_b32 s23, s23, 2
  s_add_u32 s23, s23, s66
  s_add_u32 s15, s66, s19
  s_and_b32 s15, s15, 0
  s_lshl_b32 s15, s15, 17
  s_lshl_b32 s80, s21, 12
  s_add_u32 s80, s80, 11534336
  s_lshl_b32 s81, s20, 12
  s_add_u32 s81, s81, 11567104
  s_lshr_b32 s82, s23, 1
  s_lshl_b32 s82, s82, 12
  s_add_u32 s82, s82, 11567104
  s_cmp_eq_u32 s64, 0
  s_cselect_b32 s83, 1, 0
  v_cmp_eq_u32 vcc, 0, v0
  v_mov_b32 v209, 2130706432
  s_nop 0
  v_cndmask_b32 v209, v209, 0, vcc
  v_lshlrev_b32 v221, 7, v200
  v_add_u32 v221, s77, v221
  v_lshl_add_u32 v210, v218, 10, v219
  s_lshl_b32 s66, s19, 7
  s_lshl_b32 s67, s64, 14
  s_add_u32 s66, s66, s67
  v_add_u32 v210, s66, v210
  v_add_u32 v211, 7168, v210
  v_lshrrev_b32 v239, 5, v200
  v_lshlrev_b32 v239, 3, v239
  v_bfe_u32 v240, v200, 2, 2
  v_add_u32 v239, v239, v240
  v_and_b32 v240, 16, v200
  v_lshlrev_b32 v240, 1, v240
  v_and_b32 v241, 3, v200
  v_lshl_add_u32 v240, v241, 3, v240
  v_lshl_add_u32 v198, v239, 6, v240
  v_lshl_add_u32 v192, v239, 7, v240
  v_and_b32 v241, 8, v200
  v_lshlrev_b32 v241, 3, v241
  v_xor_b32 v192, v192, v241
  v_xor_b32 v193, 64, v192
  v_add_u32 v194, 65536, v192
  v_add_u32 v195, 65536, v193
  v_add_u32 v196, 131072, v192
  v_add_u32 v197, 131072, v193
  v_lshrrev_b32 v239, 5, v200
  v_lshlrev_b32 v239, 2, v239
  v_bfe_u32 v240, v200, 2, 2
  v_add_u32 v239, v239, v240
  v_lshlrev_b32 v239, 7, v239
  v_and_b32 v240, 1, v200
  v_lshl_add_u32 v239, v240, 5, v239
  v_and_b32 v240, 16, v200
  v_add_u32 v239, v239, v240
  v_and_b32 v240, 2, v200
  v_lshl_add_u32 v239, v240, 2, v239
  v_xor_b32 v239, v239, v241
  s_lshr_b32 s66, s64, 1
  s_lshl_b32 s66, s66, 6
  s_add_u32 s66, s66, s65
  v_xor_b32 v212, s66, v239
  v_xor_b32 v213, 64, v212
  v_add_u32 v214, 65536, v212
  v_add_u32 v215, 65536, v213
  v_add_u32 v216, 131072, v212
  v_add_u32 v217, 131072, v213
  v_bfe_u32 v239, v200, 1, 3
  v_lshrrev_b32 v240, 5, v200
  v_xor_b32 v239, v239, v240
  v_lshlrev_b32 v239, 4, v239
  v_and_b32 v240, 31, v200
  v_lshl_add_u32 v239, v240, 7, v239
  v_add_u32 v226, s65, v239
  v_xor_b32 v227, 32, v226
  v_xor_b32 v228, 64, v226
  v_xor_b32 v229, 96, v226
  v_add_u32 v230, 0x10000, v226
  v_add_u32 v231, 0x10000, v227
  v_add_u32 v232, 0x10000, v228
  v_add_u32 v233, 0x10000, v229
  v_mov_b32 v234, 0
  v_mov_b32 v235, 0
  v_mov_b32 v236, 0
  v_mov_b32 v237, 0
  s_lshl_b32 s66, s23, 1
  s_and_b32 s67, s64, 1
  s_add_u32 s23, s66, s67
  s_lshl_b32 s66, s21, 7
  s_and_b32 s67, s64, 1
  s_lshl_b32 s67, s67, 5
  v_add_u32 v220, s67, v218
  v_mul_u32_u24 v220, 3072, v220
  v_add3_u32 v203, v220, v219, s66
  v_add_u32 v204, 23552, v203
  v_add_u32 v205, 2560, v201
  v_add_u32 v206, 2560, v202
  s_lshl_b32 s66, s21, 12
  s_add_u32 s69, s66, s76
  s_add_u32 s70, s69, 114688
  s_add_u32 s71, s69, 81920
  s_lshl_b32 s66, s21, 2
  s_add_u32 s66, s66, s64
  s_lshl_b32 s76, s66, 13
  s_add_u32 s76, s76, 10485760
  s_lshl_b32 s77, s66, 12
  s_add_u32 s77, s77, 11010048
  v_lshlrev_b32 v200, 4, v200
  s_lshr_b32 s12, s64, 1
  s_add_u32 s12, s12, s101
  s_add_u32 s13, s12, 0
  s_and_b32 s13, s13, 7
  s_mul_i32 s92, s13, 196608
  s_add_u32 s13, s12, 2
  s_and_b32 s13, s13, 7
  s_mul_i32 s93, s13, 196608
  s_add_u32 s13, s12, 4
  s_and_b32 s13, s13, 7
  s_mul_i32 s94, s13, 196608
  s_add_u32 s13, s12, 6
  s_and_b32 s13, s13, 7
  s_mul_i32 s95, s13, 196608
  s_waitcnt vmcnt(11)
  ds_read_b128 v[0:3], v226 offset:0
  ds_read_b128 v[4:7], v227 offset:0
  ds_read_b128 v[8:11], v228 offset:0
  ds_read_b128 v[12:15], v229 offset:0
  s_add_u32 s66, s101, 3
  s_and_b32 s66, s66, 7
  s_lshl_b32 s66, s66, 7
  s_add_u32 m0, s65, 49152
  s_add_u32 s66, s66, s100
  buffer_load_dwordx4 v222, s[24:27], s66 offen lds
  buffer_load_dwordx4 v223, s[24:27], s66 offen offset:1024 lds
  buffer_load_dwordx4 v224, s[24:27], s66 offen offset:2048 lds
  buffer_load_dwordx4 v225, s[24:27], s66 offen offset:3072 lds
  s_mov_b32 s68, 0x3f803f80
  s_waitcnt lgkmcnt(3)
  v_dot2c_f32_bf16 v234, s68, v0
  v_dot2c_f32_bf16 v236, v0, v0
  v_dot2c_f32_bf16 v235, s68, v1
  v_dot2c_f32_bf16 v237, v1, v1
  v_dot2c_f32_bf16 v234, s68, v2
  v_dot2c_f32_bf16 v236, v2, v2
  v_dot2c_f32_bf16 v235, s68, v3
  v_dot2c_f32_bf16 v237, v3, v3
  s_waitcnt lgkmcnt(2)
  v_dot2c_f32_bf16 v234, s68, v4
  v_dot2c_f32_bf16 v236, v4, v4
  v_dot2c_f32_bf16 v235, s68, v5
  v_dot2c_f32_bf16 v237, v5, v5
  v_dot2c_f32_bf16 v234, s68, v6
  v_dot2c_f32_bf16 v236, v6, v6
  v_dot2c_f32_bf16 v235, s68, v7
  v_dot2c_f32_bf16 v237, v7, v7
  s_waitcnt lgkmcnt(1)
  v_dot2c_f32_bf16 v234, s68, v8
  v_dot2c_f32_bf16 v236, v8, v8
  v_dot2c_f32_bf16 v235, s68, v9
  v_dot2c_f32_bf16 v237, v9, v9
  v_dot2c_f32_bf16 v234, s68, v10
  v_dot2c_f32_bf16 v236, v10, v10
  v_dot2c_f32_bf16 v235, s68, v11
  v_dot2c_f32_bf16 v237, v11, v11
  s_waitcnt lgkmcnt(0)
  v_dot2c_f32_bf16 v234, s68, v12
  v_dot2c_f32_bf16 v236, v12, v12
  v_dot2c_f32_bf16 v235, s68, v13
  v_dot2c_f32_bf16 v237, v13, v13
  v_dot2c_f32_bf16 v234, s68, v14
  v_dot2c_f32_bf16 v236, v14, v14
  v_dot2c_f32_bf16 v235, s68, v15
  v_dot2c_f32_bf16 v237, v15, v15
  s_waitcnt vmcnt(11)
  ds_read_b128 v[16:19], v226 offset:16384
  ds_read_b128 v[20:23], v227 offset:16384
  ds_read_b128 v[24:27], v228 offset:16384
  ds_read_b128 v[28:31], v229 offset:16384
  s_add_u32 s66, s101, 4
  s_and_b32 s66, s66, 7
  s_lshl_b32 s66, s66, 7
  s_add_u32 m0, s65, 65536
  s_add_u32 s66, s66, s100
  buffer_load_dwordx4 v222, s[24:27], s66 offen lds
  buffer_load_dwordx4 v223, s[24:27], s66 offen offset:1024 lds
  buffer_load_dwordx4 v224, s[24:27], s66 offen offset:2048 lds
  buffer_load_dwordx4 v225, s[24:27], s66 offen offset:3072 lds
  s_mov_b32 s68, 0x3f803f80
  s_waitcnt lgkmcnt(3)
  v_dot2c_f32_bf16 v234, s68, v16
  v_dot2c_f32_bf16 v236, v16, v16
  v_dot2c_f32_bf16 v235, s68, v17
  v_dot2c_f32_bf16 v237, v17, v17
  v_dot2c_f32_bf16 v234, s68, v18
  v_dot2c_f32_bf16 v236, v18, v18
  v_dot2c_f32_bf16 v235, s68, v19
  v_dot2c_f32_bf16 v237, v19, v19
  s_waitcnt vmcnt(9)
  ds_read_b128 v[32:35], v226 offset:32768
  ds_read_b128 v[36:39], v227 offset:32768
  ds_read_b128 v[40:43], v228 offset:32768
  ds_read_b128 v[44:47], v229 offset:32768
  s_waitcnt lgkmcnt(6)
  v_dot2c_f32_bf16 v234, s68, v20
  v_dot2c_f32_bf16 v236, v20, v20
  v_dot2c_f32_bf16 v235, s68, v21
  v_dot2c_f32_bf16 v237, v21, v21
  v_dot2c_f32_bf16 v234, s68, v22
  v_dot2c_f32_bf16 v236, v22, v22
  v_dot2c_f32_bf16 v235, s68, v23
  v_dot2c_f32_bf16 v237, v23, v23
  s_waitcnt lgkmcnt(5)
  v_dot2c_f32_bf16 v234, s68, v24
  v_dot2c_f32_bf16 v236, v24, v24
  v_dot2c_f32_bf16 v235, s68, v25
  v_dot2c_f32_bf16 v237, v25, v25
  v_dot2c_f32_bf16 v234, s68, v26
  v_dot2c_f32_bf16 v236, v26, v26
  v_dot2c_f32_bf16 v235, s68, v27
  v_dot2c_f32_bf16 v237, v27, v27
  s_waitcnt lgkmcnt(4)
  v_dot2c_f32_bf16 v234, s68, v28
  v_dot2c_f32_bf16 v236, v28, v28
  v_dot2c_f32_bf16 v235, s68, v29
  v_dot2c_f32_bf16 v237, v29, v29
  v_dot2c_f32_bf16 v234, s68, v30
  v_dot2c_f32_bf16 v236, v30, v30
  v_dot2c_f32_bf16 v235, s68, v31
  v_dot2c_f32_bf16 v237, v31, v31
  s_add_u32 s66, s101, 5
  s_and_b32 s66, s66, 7
  s_lshl_b32 s66, s66, 7
  s_add_u32 m0, s65, 81920
  s_add_u32 s66, s66, s100
  buffer_load_dwordx4 v222, s[24:27], s66 offen lds
  buffer_load_dwordx4 v223, s[24:27], s66 offen offset:1024 lds
  buffer_load_dwordx4 v224, s[24:27], s66 offen offset:2048 lds
  buffer_load_dwordx4 v225, s[24:27], s66 offen offset:3072 lds
  s_mov_b32 s68, 0x3f803f80
  s_waitcnt lgkmcnt(3)
  v_dot2c_f32_bf16 v234, s68, v32
  v_dot2c_f32_bf16 v236, v32, v32
  v_dot2c_f32_bf16 v235, s68, v33
  v_dot2c_f32_bf16 v237, v33, v33
  v_dot2c_f32_bf16 v234, s68, v34
  v_dot2c_f32_bf16 v236, v34, v34
  v_dot2c_f32_bf16 v235, s68, v35
  v_dot2c_f32_bf16 v237, v35, v35
  s_waitcnt vmcnt(8)
  ds_read_b128 v[48:51], v226 offset:49152
  ds_read_b128 v[52:55], v227 offset:49152
  ds_read_b128 v[56:59], v228 offset:49152
  ds_read_b128 v[60:63], v229 offset:49152
  s_waitcnt lgkmcnt(6)
  v_dot2c_f32_bf16 v234, s68, v36
  v_dot2c_f32_bf16 v236, v36, v36
  v_dot2c_f32_bf16 v235, s68, v37
  v_dot2c_f32_bf16 v237, v37, v37
  v_dot2c_f32_bf16 v234, s68, v38
  v_dot2c_f32_bf16 v236, v38, v38
  v_dot2c_f32_bf16 v235, s68, v39
  v_dot2c_f32_bf16 v237, v39, v39
  s_waitcnt lgkmcnt(5)
  v_dot2c_f32_bf16 v234, s68, v40
  v_dot2c_f32_bf16 v236, v40, v40
  v_dot2c_f32_bf16 v235, s68, v41
  v_dot2c_f32_bf16 v237, v41, v41
  v_dot2c_f32_bf16 v234, s68, v42
  v_dot2c_f32_bf16 v236, v42, v42
  v_dot2c_f32_bf16 v235, s68, v43
  v_dot2c_f32_bf16 v237, v43, v43
  s_waitcnt lgkmcnt(4)
  v_dot2c_f32_bf16 v234, s68, v44
  v_dot2c_f32_bf16 v236, v44, v44
  v_dot2c_f32_bf16 v235, s68, v45
  v_dot2c_f32_bf16 v237, v45, v45
  v_dot2c_f32_bf16 v234, s68, v46
  v_dot2c_f32_bf16 v236, v46, v46
  v_dot2c_f32_bf16 v235, s68, v47
  v_dot2c_f32_bf16 v237, v47, v47
  s_add_u32 s66, s101, 6
  s_and_b32 s66, s66, 7
  s_lshl_b32 s66, s66, 7
  s_add_u32 m0, s65, 98304
  s_add_u32 s66, s66, s100
  buffer_load_dwordx4 v222, s[24:27], s66 offen lds
  buffer_load_dwordx4 v223, s[24:27], s66 offen offset:1024 lds
  buffer_load_dwordx4 v224, s[24:27], s66 offen offset:2048 lds
  buffer_load_dwordx4 v225, s[24:27], s66 offen offset:3072 lds
  s_mov_b32 s68, 0x3f803f80
  s_waitcnt lgkmcnt(3)
  v_dot2c_f32_bf16 v234, s68, v48
  v_dot2c_f32_bf16 v236, v48, v48
  v_dot2c_f32_bf16 v235, s68, v49
  v_dot2c_f32_bf16 v237, v49, v49
  v_dot2c_f32_bf16 v234, s68, v50
  v_dot2c_f32_bf16 v236, v50, v50
  v_dot2c_f32_bf16 v235, s68, v51
  v_dot2c_f32_bf16 v237, v51, v51
  s_waitcnt vmcnt(8)
  ds_read_b128 v[128:131], v230 offset:0
  ds_read_b128 v[132:135], v231 offset:0
  ds_read_b128 v[136:139], v232 offset:0
  ds_read_b128 v[140:143], v233 offset:0
  s_waitcnt lgkmcnt(6)
  v_dot2c_f32_bf16 v234, s68, v52
  v_dot2c_f32_bf16 v236, v52, v52
  v_dot2c_f32_bf16 v235, s68, v53
  v_dot2c_f32_bf16 v237, v53, v53
  v_dot2c_f32_bf16 v234, s68, v54
  v_dot2c_f32_bf16 v236, v54, v54
  v_dot2c_f32_bf16 v235, s68, v55
  v_dot2c_f32_bf16 v237, v55, v55
  s_waitcnt lgkmcnt(5)
  v_dot2c_f32_bf16 v234, s68, v56
  v_dot2c_f32_bf16 v236, v56, v56
  v_dot2c_f32_bf16 v235, s68, v57
  v_dot2c_f32_bf16 v237, v57, v57
  v_dot2c_f32_bf16 v234, s68, v58
  v_dot2c_f32_bf16 v236, v58, v58
  v_dot2c_f32_bf16 v235, s68, v59
  v_dot2c_f32_bf16 v237, v59, v59
  s_waitcnt lgkmcnt(4)
  v_dot2c_f32_bf16 v234, s68, v60
  v_dot2c_f32_bf16 v236, v60, v60
  v_dot2c_f32_bf16 v235, s68, v61
  v_dot2c_f32_bf16 v237, v61, v61
  v_dot2c_f32_bf16 v234, s68, v62
  v_dot2c_f32_bf16 v236, v62, v62
  v_dot2c_f32_bf16 v235, s68, v63
  v_dot2c_f32_bf16 v237, v63, v63
  v_mov_b32 v218, 1
  buffer_store_dword v218, v221, s[48:51], 0 offen sc1
  s_add_u32 s66, s101, 7
  s_and_b32 s66, s66, 7
  s_lshl_b32 s66, s66, 7
  s_add_u32 m0, s65, 114688
  s_add_u32 s66, s66, s100
  buffer_load_dwordx4 v222, s[24:27], s66 offen lds
  buffer_load_dwordx4 v223, s[24:27], s66 offen offset:1024 lds
  buffer_load_dwordx4 v224, s[24:27], s66 offen offset:2048 lds
  buffer_load_dwordx4 v225, s[24:27], s66 offen offset:3072 lds
  s_mov_b32 s68, 0x3f803f80
  s_waitcnt lgkmcnt(3)
  v_dot2c_f32_bf16 v234, s68, v128
  v_dot2c_f32_bf16 v236, v128, v128
  v_dot2c_f32_bf16 v235, s68, v129
  v_dot2c_f32_bf16 v237, v129, v129
  v_dot2c_f32_bf16 v234, s68, v130
  v_dot2c_f32_bf16 v236, v130, v130
  v_dot2c_f32_bf16 v235, s68, v131
  v_dot2c_f32_bf16 v237, v131, v131
  s_waitcnt vmcnt(9)
  ds_read_b128 v[144:147], v230 offset:16384
  ds_read_b128 v[148:151], v231 offset:16384
  ds_read_b128 v[152:155], v232 offset:16384
  ds_read_b128 v[156:159], v233 offset:16384
  s_waitcnt lgkmcnt(6)
  v_dot2c_f32_bf16 v234, s68, v132
  v_dot2c_f32_bf16 v236, v132, v132
  v_dot2c_f32_bf16 v235, s68, v133
  v_dot2c_f32_bf16 v237, v133, v133
  v_dot2c_f32_bf16 v234, s68, v134
  v_dot2c_f32_bf16 v236, v134, v134
  v_dot2c_f32_bf16 v235, s68, v135
  v_dot2c_f32_bf16 v237, v135, v135
  s_waitcnt lgkmcnt(5)
  v_dot2c_f32_bf16 v234, s68, v136
  v_dot2c_f32_bf16 v236, v136, v136
  v_dot2c_f32_bf16 v235, s68, v137
  v_dot2c_f32_bf16 v237, v137, v137
  v_dot2c_f32_bf16 v234, s68, v138
  v_dot2c_f32_bf16 v236, v138, v138
  v_dot2c_f32_bf16 v235, s68, v139
  v_dot2c_f32_bf16 v237, v139, v139
  s_waitcnt lgkmcnt(4)
  v_dot2c_f32_bf16 v234, s68, v140
  v_dot2c_f32_bf16 v236, v140, v140
  v_dot2c_f32_bf16 v235, s68, v141
  v_dot2c_f32_bf16 v237, v141, v141
  v_dot2c_f32_bf16 v234, s68, v142
  v_dot2c_f32_bf16 v236, v142, v142
  v_dot2c_f32_bf16 v235, s68, v143
  v_dot2c_f32_bf16 v237, v143, v143
  s_barrier
  s_add_u32 m0, s65, 131072
  s_nop 0
  buffer_load_dwordx4 v201, s[28:31], s84 offen lds
  buffer_load_dwordx4 v202, s[28:31], s84 offen offset:1024 lds
  buffer_load_dwordx4 v201, s[32:35], s84 offen offset:2048 lds
  buffer_load_dwordx4 v202, s[32:35], s84 offen offset:3072 lds
  s_mov_b32 s68, 0x3f803f80
  s_waitcnt lgkmcnt(3)
  v_dot2c_f32_bf16 v234, s68, v144
  v_dot2c_f32_bf16 v236, v144, v144
  v_dot2c_f32_bf16 v235, s68, v145
  v_dot2c_f32_bf16 v237, v145, v145
  v_dot2c_f32_bf16 v234, s68, v146
  v_dot2c_f32_bf16 v236, v146, v146
  v_dot2c_f32_bf16 v235, s68, v147
  v_dot2c_f32_bf16 v237, v147, v147
  s_waitcnt vmcnt(9)
  ds_read_b128 v[160:163], v230 offset:32768
  ds_read_b128 v[164:167], v231 offset:32768
  ds_read_b128 v[168:171], v232 offset:32768
  ds_read_b128 v[172:175], v233 offset:32768
  s_waitcnt lgkmcnt(6)
  v_dot2c_f32_bf16 v234, s68, v148
  v_dot2c_f32_bf16 v236, v148, v148
  v_dot2c_f32_bf16 v235, s68, v149
  v_dot2c_f32_bf16 v237, v149, v149
  v_dot2c_f32_bf16 v234, s68, v150
  v_dot2c_f32_bf16 v236, v150, v150
  v_dot2c_f32_bf16 v235, s68, v151
  v_dot2c_f32_bf16 v237, v151, v151
  s_waitcnt lgkmcnt(5)
  v_dot2c_f32_bf16 v234, s68, v152
  v_dot2c_f32_bf16 v236, v152, v152
  v_dot2c_f32_bf16 v235, s68, v153
  v_dot2c_f32_bf16 v237, v153, v153
  v_dot2c_f32_bf16 v234, s68, v154
  v_dot2c_f32_bf16 v236, v154, v154
  v_dot2c_f32_bf16 v235, s68, v155
  v_dot2c_f32_bf16 v237, v155, v155
  s_waitcnt lgkmcnt(4)
  v_dot2c_f32_bf16 v234, s68, v156
  v_dot2c_f32_bf16 v236, v156, v156
  v_dot2c_f32_bf16 v235, s68, v157
  v_dot2c_f32_bf16 v237, v157, v157
  v_dot2c_f32_bf16 v234, s68, v158
  v_dot2c_f32_bf16 v236, v158, v158
  v_dot2c_f32_bf16 v235, s68, v159
  v_dot2c_f32_bf16 v237, v159, v159
  s_add_u32 m0, s65, 147456
  s_nop 0
  buffer_load_dwordx4 v201, s[28:31], s85 offen lds
  buffer_load_dwordx4 v202, s[28:31], s85 offen offset:1024 lds
  buffer_load_dwordx4 v201, s[32:35], s85 offen offset:2048 lds
  buffer_load_dwordx4 v202, s[32:35], s85 offen offset:3072 lds
  s_mov_b32 s68, 0x3f803f80
  s_waitcnt lgkmcnt(3)
  v_dot2c_f32_bf16 v234, s68, v160
  v_dot2c_f32_bf16 v236, v160, v160
  v_dot2c_f32_bf16 v235, s68, v161
  v_dot2c_f32_bf16 v237, v161, v161
  v_dot2c_f32_bf16 v234, s68, v162
  v_dot2c_f32_bf16 v236, v162, v162
  v_dot2c_f32_bf16 v235, s68, v163
  v_dot2c_f32_bf16 v237, v163, v163
  s_waitcnt vmcnt(8)
  ds_read_b128 v[176:179], v230 offset:49152
  ds_read_b128 v[180:183], v231 offset:49152
  ds_read_b128 v[184:187], v232 offset:49152
  ds_read_b128 v[188:191], v233 offset:49152
  s_waitcnt lgkmcnt(6)
  v_dot2c_f32_bf16 v234, s68, v164
  v_dot2c_f32_bf16 v236, v164, v164
  v_dot2c_f32_bf16 v235, s68, v165
  v_dot2c_f32_bf16 v237, v165, v165
  v_dot2c_f32_bf16 v234, s68, v166
  v_dot2c_f32_bf16 v236, v166, v166
  v_dot2c_f32_bf16 v235, s68, v167
  v_dot2c_f32_bf16 v237, v167, v167
  s_waitcnt lgkmcnt(5)
  v_dot2c_f32_bf16 v234, s68, v168
  v_dot2c_f32_bf16 v236, v168, v168
  v_dot2c_f32_bf16 v235, s68, v169
  v_dot2c_f32_bf16 v237, v169, v169
  v_dot2c_f32_bf16 v234, s68, v170
  v_dot2c_f32_bf16 v236, v170, v170
  v_dot2c_f32_bf16 v235, s68, v171
  v_dot2c_f32_bf16 v237, v171, v171
  s_waitcnt lgkmcnt(4)
  v_dot2c_f32_bf16 v234, s68, v172
  v_dot2c_f32_bf16 v236, v172, v172
  v_dot2c_f32_bf16 v235, s68, v173
  v_dot2c_f32_bf16 v237, v173, v173
  v_dot2c_f32_bf16 v234, s68, v174
  v_dot2c_f32_bf16 v236, v174, v174
  v_dot2c_f32_bf16 v235, s68, v175
  v_dot2c_f32_bf16 v237, v175, v175
  s_add_u32 m0, s65, 0
  s_nop 0
  buffer_load_dwordx4 v201, s[28:31], s86 offen lds
  buffer_load_dwordx4 v202, s[28:31], s86 offen offset:1024 lds
  buffer_load_dwordx4 v201, s[32:35], s86 offen offset:2048 lds
  buffer_load_dwordx4 v202, s[32:35], s86 offen offset:3072 lds
  s_mov_b32 s68, 0x3f803f80
  s_waitcnt lgkmcnt(3)
  v_dot2c_f32_bf16 v234, s68, v176
  v_dot2c_f32_bf16 v236, v176, v176
  v_dot2c_f32_bf16 v235, s68, v177
  v_dot2c_f32_bf16 v237, v177, v177
  v_dot2c_f32_bf16 v234, s68, v178
  v_dot2c_f32_bf16 v236, v178, v178
  v_dot2c_f32_bf16 v235, s68, v179
  v_dot2c_f32_bf16 v237, v179, v179
  s_waitcnt lgkmcnt(2)
  v_dot2c_f32_bf16 v234, s68, v180
  v_dot2c_f32_bf16 v236, v180, v180
  v_dot2c_f32_bf16 v235, s68, v181
  v_dot2c_f32_bf16 v237, v181, v181
  v_dot2c_f32_bf16 v234, s68, v182
  v_dot2c_f32_bf16 v236, v182, v182
  v_dot2c_f32_bf16 v235, s68, v183
  v_dot2c_f32_bf16 v237, v183, v183
  s_waitcnt lgkmcnt(1)
  v_dot2c_f32_bf16 v234, s68, v184
  v_dot2c_f32_bf16 v236, v184, v184
  v_dot2c_f32_bf16 v235, s68, v185
  v_dot2c_f32_bf16 v237, v185, v185
  v_dot2c_f32_bf16 v234, s68, v186
  v_dot2c_f32_bf16 v236, v186, v186
  v_dot2c_f32_bf16 v235, s68, v187
  v_dot2c_f32_bf16 v237, v187, v187
  s_waitcnt lgkmcnt(0)
  v_dot2c_f32_bf16 v234, s68, v188
  v_dot2c_f32_bf16 v236, v188, v188
  v_dot2c_f32_bf16 v235, s68, v189
  v_dot2c_f32_bf16 v237, v189, v189
  v_dot2c_f32_bf16 v234, s68, v190
  v_dot2c_f32_bf16 v236, v190, v190
  v_dot2c_f32_bf16 v235, s68, v191
  v_dot2c_f32_bf16 v237, v191, v191
  s_waitcnt vmcnt(8)
  s_barrier
  ds_read_b64_tr_b16 a[64:65], v196 offset:0
  ds_read_b64_tr_b16 a[66:67], v196 offset:512
  ds_read_b64_tr_b16 a[68:69], v197 offset:0
  ds_read_b64_tr_b16 a[70:71], v197 offset:512
  ds_read_b64_tr_b16 a[72:73], v196 offset:2048
  ds_read_b64_tr_b16 a[74:75], v196 offset:2560
  ds_read_b64_tr_b16 a[76:77], v197 offset:2048
  ds_read_b64_tr_b16 a[78:79], v197 offset:2560
  ds_read_b64_tr_b16 a[80:81], v196 offset:4096
  ds_read_b64_tr_b16 a[82:83], v196 offset:4608
  ds_read_b64_tr_b16 a[84:85], v197 offset:4096
  ds_read_b64_tr_b16 a[86:87], v197 offset:4608
  ds_read_b64_tr_b16 a[88:89], v196 offset:6144
  ds_read_b64_tr_b16 a[90:91], v196 offset:6656
  ds_read_b64_tr_b16 a[92:93], v197 offset:6144
  ds_read_b64_tr_b16 a[94:95], v197 offset:6656
  s_and_b32 s66, s2, 1
  s_lshl_b32 s100, s66, 7
  v_add_f32 v234, v234, v235
  v_add_f32 v236, v236, v237
  v_mov_b32 v235, v234
  v_mov_b32 v237, v236
  s_nop 0
  v_permlane32_swap_b32 v234, v235
  v_permlane32_swap_b32 v236, v237
  v_add_f32 v234, v234, v235
  v_add_f32 v236, v236, v237
  v_mul_f32 v234, 0x3b000000, v234
  v_mul_f32 v236, 0x3b000000, v236
  v_fma_f32 v236, -v234, v234, v236
  v_max_f32 v236, 0, v236
  v_cvt_pk_bf16_f32 v234, v234, v236
  v_and_b32 v236, s74, v234
  v_lshlrev_b32 v234, 16, v234
  v_add_f32 v236, 0x3727c5ac, v236
  v_cvt_pk_bf16_f32 v236, v236, v236
  v_and_b32 v236, s74, v236
  v_sqrt_f32 v236, v236
  s_nop 0
  v_cvt_pk_bf16_f32 v236, v236, v236
  v_and_b32 v236, s74, v236
  v_rcp_f32 v208, v236
  s_nop 0
  v_mul_f32_e64 v207, -v234, v208
  v_lshlrev_b32 v238, 16, v0
  v_and_b32 v239, s74, v0
  v_lshlrev_b32 v240, 16, v1
  v_and_b32 v241, s74, v1
  v_lshlrev_b32 v242, 16, v2
  v_and_b32 v243, s74, v2
  v_lshlrev_b32 v244, 16, v3
  v_and_b32 v245, s74, v3
  v_fma_f32 v238, v238, v208, v207
  v_fma_f32 v239, v239, v208, v207
  v_fma_f32 v240, v240, v208, v207
  v_fma_f32 v241, v241, v208, v207
  v_fma_f32 v242, v242, v208, v207
  v_fma_f32 v243, v243, v208, v207
  v_fma_f32 v244, v244, v208, v207
  v_fma_f32 v245, v245, v208, v207
  v_cvt_pk_bf16_f32 v0, v238, v239
  v_cvt_pk_bf16_f32 v1, v240, v241
  v_cvt_pk_bf16_f32 v2, v242, v243
  v_cvt_pk_bf16_f32 v3, v244, v245
  v_lshlrev_b32 v246, 16, v4
  v_and_b32 v247, s74, v4
  v_lshlrev_b32 v248, 16, v5
  v_and_b32 v249, s74, v5
  s_waitcnt lgkmcnt(8)
  v_mfma_f32_32x32x16_bf16 v[64:79], a[64:67], v[0:3], 0
  s_add_u32 m0, s65, 16384
  ds_read_b64_tr_b16 a[96:97], v196 offset:8192
  ds_read_b64_tr_b16 a[98:99], v196 offset:8704
  buffer_load_dwordx4 v201, s[28:31], s87 offen lds
  v_lshlrev_b32 v250, 16, v6
  v_and_b32 v251, s74, v6
  v_lshlrev_b32 v252, 16, v7
  v_and_b32 v253, s74, v7
  v_fma_f32 v246, v246, v208, v207
  v_mfma_f32_32x32x16_bf16 v[80:95], a[68:71], v[0:3], 0
  ds_read_b64_tr_b16 a[100:101], v197 offset:8192
  ds_read_b64_tr_b16 a[102:103], v197 offset:8704
  buffer_load_dwordx4 v202, s[28:31], s87 offen offset:1024 lds
  v_fma_f32 v247, v247, v208, v207
  v_fma_f32 v248, v248, v208, v207
  v_fma_f32 v249, v249, v208, v207
  v_fma_f32 v250, v250, v208, v207
  v_fma_f32 v251, v251, v208, v207
  v_mfma_f32_32x32x16_bf16 v[96:111], a[72:75], v[0:3], 0
  ds_read_b64_tr_b16 a[104:105], v196 offset:10240
  ds_read_b64_tr_b16 a[106:107], v196 offset:10752
  buffer_load_dwordx4 v201, s[32:35], s87 offen offset:2048 lds
  v_fma_f32 v252, v252, v208, v207
  v_fma_f32 v253, v253, v208, v207
  v_cvt_pk_bf16_f32 v4, v246, v247
  v_cvt_pk_bf16_f32 v5, v248, v249
  v_cvt_pk_bf16_f32 v6, v250, v251
  v_mfma_f32_32x32x16_bf16 v[112:127], a[76:79], v[0:3], 0
  s_waitcnt lgkmcnt(6)
  ds_read_b64_tr_b16 a[108:109], v197 offset:10240
  ds_read_b64_tr_b16 a[110:111], v197 offset:10752
  buffer_load_dwordx4 v202, s[32:35], s87 offen offset:3072 lds
  v_cvt_pk_bf16_f32 v7, v252, v253
  v_lshlrev_b32 v238, 16, v8
  v_and_b32 v239, s74, v8
  v_lshlrev_b32 v240, 16, v9
  v_and_b32 v241, s74, v9
  v_mfma_f32_32x32x16_bf16 v[64:79], a[80:83], v[4:7], v[64:79]
  s_add_u32 m0, s65, 32768
  s_add_u32 s0, s15, 0
  s_and_b32 s0, s0, 524287
  ds_read_b64_tr_b16 a[64:65], v196 offset:12288
  ds_read_b64_tr_b16 a[66:67], v196 offset:12800
  buffer_load_dwordx4 v210, s[52:55], s0 offen lds
  v_lshlrev_b32 v242, 16, v10
  v_and_b32 v243, s74, v10
  v_lshlrev_b32 v244, 16, v11
  v_and_b32 v245, s74, v11
  v_fma_f32 v238, v238, v208, v207
  v_mfma_f32_32x32x16_bf16 v[80:95], a[84:87], v[4:7], v[80:95]
  ds_read_b64_tr_b16 a[68:69], v197 offset:12288
  ds_read_b64_tr_b16 a[70:71], v197 offset:12800
  buffer_load_dwordx4 v211, s[52:55], s0 offen offset:1024 lds
  v_fma_f32 v239, v239, v208, v207
  v_fma_f32 v240, v240, v208, v207
  v_fma_f32 v241, v241, v208, v207
  v_fma_f32 v242, v242, v208, v207
  v_fma_f32 v243, v243, v208, v207
  v_mfma_f32_32x32x16_bf16 v[96:111], a[88:91], v[4:7], v[96:111]
  s_add_u32 s0, s0, 63488
  ds_read_b64_tr_b16 a[72:73], v196 offset:14336
  ds_read_b64_tr_b16 a[74:75], v196 offset:14848
  buffer_load_dwordx4 v210, s[52:55], s0 offen offset:2048 lds
  v_fma_f32 v244, v244, v208, v207
  v_fma_f32 v245, v245, v208, v207
  v_cvt_pk_bf16_f32 v8, v238, v239
  v_cvt_pk_bf16_f32 v9, v240, v241
  v_cvt_pk_bf16_f32 v10, v242, v243
  v_mfma_f32_32x32x16_bf16 v[112:127], a[92:95], v[4:7], v[112:127]
  s_waitcnt lgkmcnt(6)
  ds_read_b64_tr_b16 a[76:77], v197 offset:14336
  ds_read_b64_tr_b16 a[78:79], v197 offset:14848
  buffer_load_dwordx4 v211, s[52:55], s0 offen offset:3072 lds
  v_cvt_pk_bf16_f32 v11, v244, v245
  v_lshlrev_b32 v246, 16, v12
  v_and_b32 v247, s74, v12
  v_lshlrev_b32 v248, 16, v13
  v_and_b32 v249, s74, v13
  v_mfma_f32_32x32x16_bf16 v[64:79], a[96:99], v[8:11], v[64:79]
  s_mul_i32 s66, s2, 2048
  s_lshl_b32 s67, s64, 7
  s_mul_i32 s67, s67, 4
  s_add_u32 s66, s66, s67
  s_add_u32 s66, s66, 0
  v_min_u32 v235, 48, v200
  v_lshlrev_b32 v235, 3, v235
  buffer_load_dword a232, v235, s[52:55], s66 offen offset:0
  s_mul_i32 s66, s2, 2048
  s_lshl_b32 s67, s64, 7
  s_mul_i32 s67, s67, 4
  s_add_u32 s66, s66, s67
  s_add_u32 s66, s66, 524288
  v_min_u32 v235, 48, v200
  v_lshlrev_b32 v235, 3, v235
  buffer_load_dword a233, v235, s[52:55], s66 offen offset:0
  s_mul_i32 s66, s2, 3072
  s_lshl_b32 s67, s64, 7
  s_mul_i32 s67, s67, 6
  s_add_u32 s66, s66, s67
  s_add_u32 s66, s66, 1048576
  v_min_u32 v235, 80, v200
  v_lshlrev_b32 v235, 3, v235
  buffer_load_dword a234, v235, s[52:55], s66 offen offset:0
  s_mul_i32 s66, s2, 2048
  s_lshl_b32 s67, s64, 7
  s_mul_i32 s67, s67, 4
  s_add_u32 s66, s66, s67
  s_add_u32 s66, s66, 0
  v_min_u32 v235, 48, v200
  v_lshlrev_b32 v235, 3, v235
  buffer_load_dword a235, v235, s[56:59], s66 offen offset:0
  s_waitcnt vmcnt(16)
  s_barrier
  ds_read_b64_tr_b16 a[80:81], v196 offset:16384
  ds_read_b64_tr_b16 a[82:83], v196 offset:16896
  v_lshlrev_b32 v250, 16, v14
  v_and_b32 v251, s74, v14
  v_lshlrev_b32 v252, 16, v15
  v_and_b32 v253, s74, v15
  v_fma_f32 v246, v246, v208, v207
  v_mfma_f32_32x32x16_bf16 v[80:95], a[100:103], v[8:11], v[80:95]
  s_add_u32 m0, s65, 49152
  ds_read_b64_tr_b16 a[84:85], v197 offset:16384
  ds_read_b64_tr_b16 a[86:87], v197 offset:16896
  buffer_load_dwordx4 v201, s[28:31], s88 offen lds
  v_fma_f32 v247, v247, v208, v207
  v_fma_f32 v248, v248, v208, v207
  v_fma_f32 v249, v249, v208, v207
  v_fma_f32 v250, v250, v208, v207
  v_fma_f32 v251, v251, v208, v207
  v_mfma_f32_32x32x16_bf16 v[96:111], a[104:107], v[8:11], v[96:111]
  ds_read_b64_tr_b16 a[88:89], v196 offset:18432
  ds_read_b64_tr_b16 a[90:91], v196 offset:18944
  v_fma_f32 v252, v252, v208, v207
  v_fma_f32 v253, v253, v208, v207
  v_cvt_pk_bf16_f32 v12, v246, v247
  v_cvt_pk_bf16_f32 v13, v248, v249
  v_cvt_pk_bf16_f32 v14, v250, v251
  v_mfma_f32_32x32x16_bf16 v[112:127], a[108:111], v[8:11], v[112:127]
  s_waitcnt lgkmcnt(6)
  ds_read_b64_tr_b16 a[92:93], v197 offset:18432
  ds_read_b64_tr_b16 a[94:95], v197 offset:18944
  buffer_load_dwordx4 v202, s[28:31], s88 offen offset:1024 lds
  v_cvt_pk_bf16_f32 v15, v252, v253
  v_lshlrev_b32 v238, 16, v16
  v_and_b32 v239, s74, v16
  v_lshlrev_b32 v240, 16, v17
  v_and_b32 v241, s74, v17
  v_mfma_f32_32x32x16_bf16 v[64:79], a[64:67], v[12:15], v[64:79]
  ds_read_b64_tr_b16 a[96:97], v196 offset:20480
  ds_read_b64_tr_b16 a[98:99], v196 offset:20992
  v_lshlrev_b32 v242, 16, v18
  v_and_b32 v243, s74, v18
  v_lshlrev_b32 v244, 16, v19
  v_and_b32 v245, s74, v19
  v_fma_f32 v238, v238, v208, v207
  v_mfma_f32_32x32x16_bf16 v[80:95], a[68:71], v[12:15], v[80:95]
  ds_read_b64_tr_b16 a[100:101], v197 offset:20480
  ds_read_b64_tr_b16 a[102:103], v197 offset:20992
  buffer_load_dwordx4 v201, s[32:35], s88 offen offset:2048 lds
  v_fma_f32 v239, v239, v208, v207
  v_fma_f32 v240, v240, v208, v207
  v_fma_f32 v241, v241, v208, v207
  v_fma_f32 v242, v242, v208, v207
  v_fma_f32 v243, v243, v208, v207
  v_mfma_f32_32x32x16_bf16 v[96:111], a[72:75], v[12:15], v[96:111]
  ds_read_b64_tr_b16 a[104:105], v196 offset:22528
  ds_read_b64_tr_b16 a[106:107], v196 offset:23040
  v_fma_f32 v244, v244, v208, v207
  v_fma_f32 v245, v245, v208, v207
  v_cvt_pk_bf16_f32 v16, v238, v239
  v_cvt_pk_bf16_f32 v17, v240, v241
  v_cvt_pk_bf16_f32 v18, v242, v243
  v_mfma_f32_32x32x16_bf16 v[112:127], a[76:79], v[12:15], v[112:127]
  s_waitcnt lgkmcnt(6)
  ds_read_b64_tr_b16 a[108:109], v197 offset:22528
  ds_read_b64_tr_b16 a[110:111], v197 offset:23040
  buffer_load_dwordx4 v202, s[32:35], s88 offen offset:3072 lds
  v_cvt_pk_bf16_f32 v19, v244, v245
  v_lshlrev_b32 v246, 16, v20
  v_and_b32 v247, s74, v20
  v_lshlrev_b32 v248, 16, v21
  v_and_b32 v249, s74, v21
  v_mfma_f32_32x32x16_bf16 v[64:79], a[80:83], v[16:19], v[64:79]
  ds_read_b64_tr_b16 a[64:65], v196 offset:24576
  ds_read_b64_tr_b16 a[66:67], v196 offset:25088
  v_lshlrev_b32 v250, 16, v22
  v_and_b32 v251, s74, v22
  v_lshlrev_b32 v252, 16, v23
  v_and_b32 v253, s74, v23
  v_fma_f32 v246, v246, v208, v207
  v_mfma_f32_32x32x16_bf16 v[80:95], a[84:87], v[16:19], v[80:95]
  s_add_u32 m0, s65, 65536
  s_add_u32 s0, s15, 131072
  s_and_b32 s0, s0, 524287
  ds_read_b64_tr_b16 a[68:69], v197 offset:24576
  ds_read_b64_tr_b16 a[70:71], v197 offset:25088
  buffer_load_dwordx4 v210, s[52:55], s0 offen lds
  v_fma_f32 v247, v247, v208, v207
  v_fma_f32 v248, v248, v208, v207
  v_fma_f32 v249, v249, v208, v207
  v_fma_f32 v250, v250, v208, v207
  v_fma_f32 v251, v251, v208, v207
  v_mfma_f32_32x32x16_bf16 v[96:111], a[88:91], v[16:19], v[96:111]
  ds_read_b64_tr_b16 a[72:73], v196 offset:26624
  ds_read_b64_tr_b16 a[74:75], v196 offset:27136
  v_fma_f32 v252, v252, v208, v207
  v_fma_f32 v253, v253, v208, v207
  v_cvt_pk_bf16_f32 v20, v246, v247
  v_cvt_pk_bf16_f32 v21, v248, v249
  v_cvt_pk_bf16_f32 v22, v250, v251
  v_mfma_f32_32x32x16_bf16 v[112:127], a[92:95], v[16:19], v[112:127]
  s_waitcnt lgkmcnt(6)
  ds_read_b64_tr_b16 a[76:77], v197 offset:26624
  ds_read_b64_tr_b16 a[78:79], v197 offset:27136
  buffer_load_dwordx4 v211, s[52:55], s0 offen offset:1024 lds
  v_cvt_pk_bf16_f32 v23, v252, v253
  v_lshlrev_b32 v238, 16, v24
  v_and_b32 v239, s74, v24
  v_lshlrev_b32 v240, 16, v25
  v_and_b32 v241, s74, v25
  v_mfma_f32_32x32x16_bf16 v[64:79], a[96:99], v[20:23], v[64:79]
  ds_read_b64_tr_b16 a[80:81], v196 offset:28672
  ds_read_b64_tr_b16 a[82:83], v196 offset:29184
  v_lshlrev_b32 v242, 16, v26
  v_and_b32 v243, s74, v26
  v_lshlrev_b32 v244, 16, v27
  v_and_b32 v245, s74, v27
  v_fma_f32 v238, v238, v208, v207
  v_mfma_f32_32x32x16_bf16 v[80:95], a[100:103], v[20:23], v[80:95]
  s_add_u32 s0, s0, 63488
  ds_read_b64_tr_b16 a[84:85], v197 offset:28672
  ds_read_b64_tr_b16 a[86:87], v197 offset:29184
  buffer_load_dwordx4 v210, s[52:55], s0 offen offset:2048 lds
  v_fma_f32 v239, v239, v208, v207
  v_fma_f32 v240, v240, v208, v207
  v_fma_f32 v241, v241, v208, v207
  v_fma_f32 v242, v242, v208, v207
  v_fma_f32 v243, v243, v208, v207
  v_mfma_f32_32x32x16_bf16 v[96:111], a[104:107], v[20:23], v[96:111]
  ds_read_b64_tr_b16 a[88:89], v196 offset:30720
  ds_read_b64_tr_b16 a[90:91], v196 offset:31232
  v_fma_f32 v244, v244, v208, v207
  v_fma_f32 v245, v245, v208, v207
  v_cvt_pk_bf16_f32 v24, v238, v239
  v_cvt_pk_bf16_f32 v25, v240, v241
  v_cvt_pk_bf16_f32 v26, v242, v243
  v_mfma_f32_32x32x16_bf16 v[112:127], a[108:111], v[20:23], v[112:127]
  s_waitcnt lgkmcnt(6)
  ds_read_b64_tr_b16 a[92:93], v197 offset:30720
  ds_read_b64_tr_b16 a[94:95], v197 offset:31232
  buffer_load_dwordx4 v211, s[52:55], s0 offen offset:3072 lds
  v_cvt_pk_bf16_f32 v27, v244, v245
  v_lshlrev_b32 v246, 16, v28
  v_and_b32 v247, s74, v28
  v_lshlrev_b32 v248, 16, v29
  v_and_b32 v249, s74, v29
  v_mfma_f32_32x32x16_bf16 v[64:79], a[64:67], v[24:27], v[64:79]
  s_waitcnt vmcnt(20)
  s_barrier
  ds_read_b64_tr_b16 a[96:97], v192 offset:0
  ds_read_b64_tr_b16 a[98:99], v192 offset:512
  v_lshlrev_b32 v250, 16, v30
  v_and_b32 v251, s74, v30
  v_lshlrev_b32 v252, 16, v31
  v_and_b32 v253, s74, v31
  v_fma_f32 v246, v246, v208, v207
  v_mfma_f32_32x32x16_bf16 v[80:95], a[68:71], v[24:27], v[80:95]
  s_add_u32 m0, s65, 131072
  ds_read_b64_tr_b16 a[100:101], v193 offset:0
  ds_read_b64_tr_b16 a[102:103], v193 offset:512
  buffer_load_dwordx4 v201, s[28:31], s89 offen lds
  v_fma_f32 v247, v247, v208, v207
  v_fma_f32 v248, v248, v208, v207
  v_fma_f32 v249, v249, v208, v207
  v_fma_f32 v250, v250, v208, v207
  v_fma_f32 v251, v251, v208, v207
  v_mfma_f32_32x32x16_bf16 v[96:111], a[72:75], v[24:27], v[96:111]
  ds_read_b64_tr_b16 a[104:105], v192 offset:2048
  ds_read_b64_tr_b16 a[106:107], v192 offset:2560
  v_fma_f32 v252, v252, v208, v207
  v_fma_f32 v253, v253, v208, v207
  v_cvt_pk_bf16_f32 v28, v246, v247
  v_cvt_pk_bf16_f32 v29, v248, v249
  v_cvt_pk_bf16_f32 v30, v250, v251
  v_mfma_f32_32x32x16_bf16 v[112:127], a[76:79], v[24:27], v[112:127]
  s_waitcnt lgkmcnt(6)
  ds_read_b64_tr_b16 a[108:109], v193 offset:2048
  ds_read_b64_tr_b16 a[110:111], v193 offset:2560
  buffer_load_dwordx4 v202, s[28:31], s89 offen offset:1024 lds
  v_cvt_pk_bf16_f32 v31, v252, v253
  v_lshlrev_b32 v238, 16, v32
  v_and_b32 v239, s74, v32
  v_lshlrev_b32 v240, 16, v33
  v_and_b32 v241, s74, v33
  v_mfma_f32_32x32x16_bf16 v[64:79], a[80:83], v[28:31], v[64:79]
  ds_read_b64_tr_b16 a[64:65], v192 offset:4096
  ds_read_b64_tr_b16 a[66:67], v192 offset:4608
  v_lshlrev_b32 v242, 16, v34
  v_and_b32 v243, s74, v34
  v_lshlrev_b32 v244, 16, v35
  v_and_b32 v245, s74, v35
  v_fma_f32 v238, v238, v208, v207
  v_mfma_f32_32x32x16_bf16 v[80:95], a[84:87], v[28:31], v[80:95]
  ds_read_b64_tr_b16 a[68:69], v193 offset:4096
  ds_read_b64_tr_b16 a[70:71], v193 offset:4608
  buffer_load_dwordx4 v201, s[32:35], s89 offen offset:2048 lds
  v_fma_f32 v239, v239, v208, v207
  v_fma_f32 v240, v240, v208, v207
  v_fma_f32 v241, v241, v208, v207
  v_fma_f32 v242, v242, v208, v207
  v_fma_f32 v243, v243, v208, v207
  v_mfma_f32_32x32x16_bf16 v[96:111], a[88:91], v[28:31], v[96:111]
  ds_read_b64_tr_b16 a[72:73], v192 offset:6144
  ds_read_b64_tr_b16 a[74:75], v192 offset:6656
  v_fma_f32 v244, v244, v208, v207
  v_fma_f32 v245, v245, v208, v207
  v_cvt_pk_bf16_f32 v32, v238, v239
  v_cvt_pk_bf16_f32 v33, v240, v241
  v_cvt_pk_bf16_f32 v34, v242, v243
  v_mfma_f32_32x32x16_bf16 v[112:127], a[92:95], v[28:31], v[112:127]
  s_waitcnt lgkmcnt(6)
  ds_read_b64_tr_b16 a[76:77], v193 offset:6144
  ds_read_b64_tr_b16 a[78:79], v193 offset:6656
  buffer_load_dwordx4 v202, s[32:35], s89 offen offset:3072 lds
  v_cvt_pk_bf16_f32 v35, v244, v245
  v_lshlrev_b32 v246, 16, v36
  v_and_b32 v247, s74, v36
  v_lshlrev_b32 v248, 16, v37
  v_and_b32 v249, s74, v37
  v_mfma_f32_32x32x16_bf16 v[64:79], a[96:99], v[32:35], v[64:79]
  s_add_u32 m0, s65, 81920
  s_add_u32 s0, s15, 262144
  s_and_b32 s0, s0, 524287
  ds_read_b64_tr_b16 a[80:81], v192 offset:8192
  ds_read_b64_tr_b16 a[82:83], v192 offset:8704
  buffer_load_dwordx4 v210, s[52:55], s0 offen lds
  v_lshlrev_b32 v250, 16, v38
  v_and_b32 v251, s74, v38
  v_lshlrev_b32 v252, 16, v39
  v_and_b32 v253, s74, v39
  v_fma_f32 v246, v246, v208, v207
  v_mfma_f32_32x32x16_bf16 v[80:95], a[100:103], v[32:35], v[80:95]
  ds_read_b64_tr_b16 a[84:85], v193 offset:8192
  ds_read_b64_tr_b16 a[86:87], v193 offset:8704
  v_fma_f32 v247, v247, v208, v207
  v_fma_f32 v248, v248, v208, v207
  v_fma_f32 v249, v249, v208, v207
  v_fma_f32 v250, v250, v208, v207
  v_fma_f32 v251, v251, v208, v207
  v_mfma_f32_32x32x16_bf16 v[96:111], a[104:107], v[32:35], v[96:111]
  ds_read_b64_tr_b16 a[88:89], v192 offset:10240
  ds_read_b64_tr_b16 a[90:91], v192 offset:10752
  buffer_load_dwordx4 v211, s[52:55], s0 offen offset:1024 lds
  v_fma_f32 v252, v252, v208, v207
  v_fma_f32 v253, v253, v208, v207
  v_cvt_pk_bf16_f32 v36, v246, v247
  v_cvt_pk_bf16_f32 v37, v248, v249
  v_cvt_pk_bf16_f32 v38, v250, v251
  v_mfma_f32_32x32x16_bf16 v[112:127], a[108:111], v[32:35], v[112:127]
  s_waitcnt lgkmcnt(6)
  ds_read_b64_tr_b16 a[92:93], v193 offset:10240
  ds_read_b64_tr_b16 a[94:95], v193 offset:10752
  v_cvt_pk_bf16_f32 v39, v252, v253
  v_lshlrev_b32 v238, 16, v40
  v_and_b32 v239, s74, v40
  v_lshlrev_b32 v240, 16, v41
  v_and_b32 v241, s74, v41
  v_mfma_f32_32x32x16_bf16 v[64:79], a[64:67], v[36:39], v[64:79]
  s_add_u32 s0, s0, 63488
  ds_read_b64_tr_b16 a[96:97], v192 offset:12288
  ds_read_b64_tr_b16 a[98:99], v192 offset:12800
  buffer_load_dwordx4 v210, s[52:55], s0 offen offset:2048 lds
  v_lshlrev_b32 v242, 16, v42
  v_and_b32 v243, s74, v42
  v_lshlrev_b32 v244, 16, v43
  v_and_b32 v245, s74, v43
  v_fma_f32 v238, v238, v208, v207
  v_mfma_f32_32x32x16_bf16 v[80:95], a[68:71], v[36:39], v[80:95]
  ds_read_b64_tr_b16 a[100:101], v193 offset:12288
  ds_read_b64_tr_b16 a[102:103], v193 offset:12800
  v_fma_f32 v239, v239, v208, v207
  v_fma_f32 v240, v240, v208, v207
  v_fma_f32 v241, v241, v208, v207
  v_fma_f32 v242, v242, v208, v207
  v_fma_f32 v243, v243, v208, v207
  v_mfma_f32_32x32x16_bf16 v[96:111], a[72:75], v[36:39], v[96:111]
  ds_read_b64_tr_b16 a[104:105], v192 offset:14336
  ds_read_b64_tr_b16 a[106:107], v192 offset:14848
  buffer_load_dwordx4 v211, s[52:55], s0 offen offset:3072 lds
  v_fma_f32 v244, v244, v208, v207
  v_fma_f32 v245, v245, v208, v207
  v_cvt_pk_bf16_f32 v40, v238, v239
  v_cvt_pk_bf16_f32 v41, v240, v241
  v_cvt_pk_bf16_f32 v42, v242, v243
  v_mfma_f32_32x32x16_bf16 v[112:127], a[76:79], v[36:39], v[112:127]
  s_waitcnt lgkmcnt(6)
  ds_read_b64_tr_b16 a[108:109], v193 offset:14336
  ds_read_b64_tr_b16 a[110:111], v193 offset:14848
  v_cvt_pk_bf16_f32 v43, v244, v245
  v_lshlrev_b32 v246, 16, v44
  v_and_b32 v247, s74, v44
  v_lshlrev_b32 v248, 16, v45
  v_and_b32 v249, s74, v45
  v_mfma_f32_32x32x16_bf16 v[64:79], a[80:83], v[40:43], v[64:79]
  s_waitcnt vmcnt(24)
  s_barrier
  buffer_load_dword v221, v209, s[48:51], s100 offen sc1
  s_add_u32 m0, s65, 147456
  ds_read_b64_tr_b16 a[64:65], v192 offset:16384
  ds_read_b64_tr_b16 a[66:67], v192 offset:16896
  buffer_load_dwordx4 v201, s[28:31], s90 offen lds
  v_lshlrev_b32 v250, 16, v46
  v_and_b32 v251, s74, v46
  v_lshlrev_b32 v252, 16, v47
  v_and_b32 v253, s74, v47
  v_fma_f32 v246, v246, v208, v207
  v_mfma_f32_32x32x16_bf16 v[80:95], a[84:87], v[40:43], v[80:95]
  ds_read_b64_tr_b16 a[68:69], v193 offset:16384
  ds_read_b64_tr_b16 a[70:71], v193 offset:16896
  buffer_load_dwordx4 v202, s[28:31], s90 offen offset:1024 lds
  v_fma_f32 v247, v247, v208, v207
  v_fma_f32 v248, v248, v208, v207
  v_fma_f32 v249, v249, v208, v207
  v_fma_f32 v250, v250, v208, v207
  v_fma_f32 v251, v251, v208, v207
  v_mfma_f32_32x32x16_bf16 v[96:111], a[88:91], v[40:43], v[96:111]
  ds_read_b64_tr_b16 a[72:73], v192 offset:18432
  ds_read_b64_tr_b16 a[74:75], v192 offset:18944
  v_fma_f32 v252, v252, v208, v207
  v_fma_f32 v253, v253, v208, v207
  v_cvt_pk_bf16_f32 v44, v246, v247
  v_cvt_pk_bf16_f32 v45, v248, v249
  v_cvt_pk_bf16_f32 v46, v250, v251
  v_mfma_f32_32x32x16_bf16 v[112:127], a[92:95], v[40:43], v[112:127]
  s_waitcnt lgkmcnt(6)
  ds_read_b64_tr_b16 a[76:77], v193 offset:18432
  ds_read_b64_tr_b16 a[78:79], v193 offset:18944
  buffer_load_dwordx4 v201, s[32:35], s90 offen offset:2048 lds
  v_cvt_pk_bf16_f32 v47, v252, v253
  v_lshlrev_b32 v238, 16, v48
  v_and_b32 v239, s74, v48
  v_lshlrev_b32 v240, 16, v49
  v_and_b32 v241, s74, v49
  v_mfma_f32_32x32x16_bf16 v[64:79], a[96:99], v[44:47], v[64:79]
  s_waitcnt vmcnt(24)
  ds_read_b64_tr_b16 a[80:81], v192 offset:20480
  ds_read_b64_tr_b16 a[82:83], v192 offset:20992
  ds_read_b64_tr_b16 a[112:113], v212 offset:32768
  v_lshlrev_b32 v242, 16, v50
  v_and_b32 v243, s74, v50
  v_lshlrev_b32 v244, 16, v51
  v_and_b32 v245, s74, v51
  v_fma_f32 v238, v238, v208, v207
  v_mfma_f32_32x32x16_bf16 v[80:95], a[100:103], v[44:47], v[80:95]
  ds_read_b64_tr_b16 a[84:85], v193 offset:20480
  ds_read_b64_tr_b16 a[86:87], v193 offset:20992
  ds_read_b64_tr_b16 a[114:115], v212 offset:33792
  buffer_load_dwordx4 v202, s[32:35], s90 offen offset:3072 lds
  v_fma_f32 v239, v239, v208, v207
  v_fma_f32 v240, v240, v208, v207
  v_fma_f32 v241, v241, v208, v207
  v_fma_f32 v242, v242, v208, v207
  v_fma_f32 v243, v243, v208, v207
  v_mfma_f32_32x32x16_bf16 v[96:111], a[104:107], v[44:47], v[96:111]
  ds_read_b64_tr_b16 a[88:89], v192 offset:22528
  ds_read_b64_tr_b16 a[90:91], v192 offset:23040
  ds_read_b64_tr_b16 a[116:117], v213 offset:32768
  v_fma_f32 v244, v244, v208, v207
  v_fma_f32 v245, v245, v208, v207
  v_cvt_pk_bf16_f32 v48, v238, v239
  v_cvt_pk_bf16_f32 v49, v240, v241
  v_cvt_pk_bf16_f32 v50, v242, v243
  v_mfma_f32_32x32x16_bf16 v[112:127], a[108:111], v[44:47], v[112:127]
  s_waitcnt lgkmcnt(9)
  s_add_u32 m0, s65, 98304
  s_add_u32 s0, s15, 393216
  s_and_b32 s0, s0, 524287
  ds_read_b64_tr_b16 a[92:93], v193 offset:22528
  ds_read_b64_tr_b16 a[94:95], v193 offset:23040
  ds_read_b64_tr_b16 a[118:119], v213 offset:33792
  buffer_load_dwordx4 v210, s[52:55], s0 offen lds
  v_cvt_pk_bf16_f32 v51, v244, v245
  v_lshlrev_b32 v246, 16, v52
  v_and_b32 v247, s74, v52
  v_lshlrev_b32 v248, 16, v53
  v_and_b32 v249, s74, v53
  v_mfma_f32_32x32x16_bf16 v[64:79], a[64:67], v[48:51], v[64:79]
  ds_read_b64_tr_b16 a[96:97], v192 offset:24576
  ds_read_b64_tr_b16 a[98:99], v192 offset:25088
  ds_read_b64_tr_b16 a[120:121], v212 offset:34816
  buffer_load_dwordx4 v211, s[52:55], s0 offen offset:1024 lds
  v_lshlrev_b32 v250, 16, v54
  v_and_b32 v251, s74, v54
  v_lshlrev_b32 v252, 16, v55
  v_and_b32 v253, s74, v55
  v_fma_f32 v246, v246, v208, v207
  v_mfma_f32_32x32x16_bf16 v[80:95], a[68:71], v[48:51], v[80:95]
  ds_read_b64_tr_b16 a[100:101], v193 offset:24576
  ds_read_b64_tr_b16 a[102:103], v193 offset:25088
  ds_read_b64_tr_b16 a[122:123], v212 offset:35840
  v_fma_f32 v247, v247, v208, v207
  v_fma_f32 v248, v248, v208, v207
  v_fma_f32 v249, v249, v208, v207
  v_fma_f32 v250, v250, v208, v207
  v_fma_f32 v251, v251, v208, v207
  v_mfma_f32_32x32x16_bf16 v[96:111], a[72:75], v[48:51], v[96:111]
  s_add_u32 s0, s0, 63488
  ds_read_b64_tr_b16 a[104:105], v192 offset:26624
  ds_read_b64_tr_b16 a[106:107], v192 offset:27136
  ds_read_b64_tr_b16 a[124:125], v213 offset:34816
  buffer_load_dwordx4 v210, s[52:55], s0 offen offset:2048 lds
  v_fma_f32 v252, v252, v208, v207
  v_fma_f32 v253, v253, v208, v207
  v_cvt_pk_bf16_f32 v52, v246, v247
  v_cvt_pk_bf16_f32 v53, v248, v249
  v_cvt_pk_bf16_f32 v54, v250, v251
  v_mfma_f32_32x32x16_bf16 v[112:127], a[76:79], v[48:51], v[112:127]
  s_waitcnt lgkmcnt(10)
  ds_read_b64_tr_b16 a[108:109], v193 offset:26624
  ds_read_b64_tr_b16 a[110:111], v193 offset:27136
  ds_read_b64_tr_b16 a[126:127], v213 offset:35840
  buffer_load_dwordx4 v211, s[52:55], s0 offen offset:3072 lds
  v_cvt_pk_bf16_f32 v55, v252, v253
  v_lshlrev_b32 v238, 16, v56
  v_and_b32 v239, s74, v56
  v_lshlrev_b32 v240, 16, v57
  v_and_b32 v241, s74, v57
  v_mfma_f32_32x32x16_bf16 v[64:79], a[80:83], v[52:55], v[64:79]
  ds_read_b64_tr_b16 a[64:65], v192 offset:28672
  ds_read_b64_tr_b16 a[66:67], v192 offset:29184
  v_lshlrev_b32 v242, 16, v58
  v_and_b32 v243, s74, v58
  v_lshlrev_b32 v244, 16, v59
  v_and_b32 v245, s74, v59
  v_fma_f32 v238, v238, v208, v207
  v_mfma_f32_32x32x16_bf16 v[80:95], a[84:87], v[52:55], v[80:95]
  ds_read_b64_tr_b16 a[68:69], v193 offset:28672
  ds_read_b64_tr_b16 a[70:71], v193 offset:29184
  v_fma_f32 v239, v239, v208, v207
  v_fma_f32 v240, v240, v208, v207
  v_fma_f32 v241, v241, v208, v207
  v_fma_f32 v242, v242, v208, v207
  v_fma_f32 v243, v243, v208, v207
  v_mfma_f32_32x32x16_bf16 v[96:111], a[88:91], v[52:55], v[96:111]
  ds_read_b64_tr_b16 a[72:73], v192 offset:30720
  ds_read_b64_tr_b16 a[74:75], v192 offset:31232
  v_fma_f32 v244, v244, v208, v207
  v_fma_f32 v245, v245, v208, v207
  v_cvt_pk_bf16_f32 v56, v238, v239
  v_cvt_pk_bf16_f32 v57, v240, v241
  v_cvt_pk_bf16_f32 v58, v242, v243
  v_mfma_f32_32x32x16_bf16 v[112:127], a[92:95], v[52:55], v[112:127]
  s_waitcnt lgkmcnt(7)
  ds_read_b64_tr_b16 a[76:77], v193 offset:30720
  ds_read_b64_tr_b16 a[78:79], v193 offset:31232
  v_cvt_pk_bf16_f32 v59, v244, v245
  v_lshlrev_b32 v246, 16, v60
  v_and_b32 v247, s74, v60
  v_lshlrev_b32 v248, 16, v61
  v_and_b32 v249, s74, v61
  v_mfma_f32_32x32x16_bf16 v[64:79], a[96:99], v[56:59], v[64:79]
  s_waitcnt vmcnt(21)
  s_barrier
  s_add_u32 m0, s65, 0
  ds_read_b64_tr_b16 a[80:81], v192 offset:49152
  ds_read_b64_tr_b16 a[82:83], v192 offset:49664
  buffer_load_dwordx4 v201, s[28:31], s91 offen lds
  v_lshlrev_b32 v250, 16, v62
  v_and_b32 v251, s74, v62
  v_lshlrev_b32 v252, 16, v63
  v_and_b32 v253, s74, v63
  v_fma_f32 v246, v246, v208, v207
  v_mfma_f32_32x32x16_bf16 v[80:95], a[100:103], v[56:59], v[80:95]
  ds_read_b64_tr_b16 a[84:85], v193 offset:49152
  ds_read_b64_tr_b16 a[86:87], v193 offset:49664
  buffer_load_dwordx4 v202, s[28:31], s91 offen offset:1024 lds
  v_fma_f32 v247, v247, v208, v207
  v_fma_f32 v248, v248, v208, v207
  v_fma_f32 v249, v249, v208, v207
  v_fma_f32 v250, v250, v208, v207
  v_fma_f32 v251, v251, v208, v207
  v_mfma_f32_32x32x16_bf16 v[96:111], a[104:107], v[56:59], v[96:111]
  ds_read_b64_tr_b16 a[88:89], v192 offset:51200
  ds_read_b64_tr_b16 a[90:91], v192 offset:51712
  v_fma_f32 v252, v252, v208, v207
  v_fma_f32 v253, v253, v208, v207
  v_cvt_pk_bf16_f32 v60, v246, v247
  v_cvt_pk_bf16_f32 v61, v248, v249
  v_cvt_pk_bf16_f32 v62, v250, v251
  v_mfma_f32_32x32x16_bf16 v[112:127], a[108:111], v[56:59], v[112:127]
  s_waitcnt lgkmcnt(6)
  ds_read_b64_tr_b16 a[92:93], v193 offset:51200
  ds_read_b64_tr_b16 a[94:95], v193 offset:51712
  buffer_load_dwordx4 v201, s[32:35], s91 offen offset:2048 lds
  v_cvt_pk_bf16_f32 v63, v252, v253
  v_lshlrev_b32 v238, 16, v128
  v_and_b32 v239, s74, v128
  v_lshlrev_b32 v240, 16, v129
  v_and_b32 v241, s74, v129
  v_mfma_f32_32x32x16_bf16 v[64:79], a[64:67], v[60:63], v[64:79]
  s_waitcnt vmcnt(20)
  ds_read_b64_tr_b16 a[96:97], v192 offset:53248
  ds_read_b64_tr_b16 a[98:99], v192 offset:53760
  ds_read_b64_tr_b16 a[128:129], v214 offset:0
  buffer_load_dwordx4 v202, s[32:35], s91 offen offset:3072 lds
  v_lshlrev_b32 v242, 16, v130
  v_and_b32 v243, s74, v130
  v_lshlrev_b32 v244, 16, v131
  v_and_b32 v245, s74, v131
  v_fma_f32 v238, v238, v208, v207
  v_mfma_f32_32x32x16_bf16 v[80:95], a[68:71], v[60:63], v[80:95]
  ds_read_b64_tr_b16 a[100:101], v193 offset:53248
  ds_read_b64_tr_b16 a[102:103], v193 offset:53760
  ds_read_b64_tr_b16 a[130:131], v214 offset:1024
  v_fma_f32 v239, v239, v208, v207
  v_fma_f32 v240, v240, v208, v207
  v_fma_f32 v241, v241, v208, v207
  v_fma_f32 v242, v242, v208, v207
  v_fma_f32 v243, v243, v208, v207
  v_mfma_f32_32x32x16_bf16 v[96:111], a[72:75], v[60:63], v[96:111]
  s_add_u32 m0, s65, 32768
  s_add_u32 s0, s15, 0
  s_and_b32 s0, s0, 524287
  s_add_u32 s0, s0, 524288
  ds_read_b64_tr_b16 a[104:105], v192 offset:55296
  ds_read_b64_tr_b16 a[106:107], v192 offset:55808
  ds_read_b64_tr_b16 a[132:133], v215 offset:0
  buffer_load_dwordx4 v210, s[52:55], s0 offen lds
  v_fma_f32 v244, v244, v208, v207
  v_fma_f32 v245, v245, v208, v207
  v_cvt_pk_bf16_f32 v128, v238, v239
  v_cvt_pk_bf16_f32 v129, v240, v241
  v_cvt_pk_bf16_f32 v130, v242, v243
  v_mfma_f32_32x32x16_bf16 v[112:127], a[76:79], v[60:63], v[112:127]
  s_waitcnt lgkmcnt(9)
  ds_read_b64_tr_b16 a[108:109], v193 offset:55296
  ds_read_b64_tr_b16 a[110:111], v193 offset:55808
  ds_read_b64_tr_b16 a[134:135], v215 offset:1024
  buffer_load_dwordx4 v211, s[52:55], s0 offen offset:1024 lds
  v_cvt_pk_bf16_f32 v131, v244, v245
  v_lshlrev_b32 v246, 16, v132
  v_and_b32 v247, s74, v132
  v_lshlrev_b32 v248, 16, v133
  v_and_b32 v249, s74, v133
  v_mfma_f32_32x32x16_bf16 v[64:79], a[80:83], v[128:131], v[64:79]
  ds_read_b64_tr_b16 a[64:65], v192 offset:57344
  ds_read_b64_tr_b16 a[66:67], v192 offset:57856
  ds_read_b64_tr_b16 a[136:137], v214 offset:2048
  v_lshlrev_b32 v250, 16, v134
  v_and_b32 v251, s74, v134
  v_lshlrev_b32 v252, 16, v135
  v_and_b32 v253, s74, v135
  v_fma_f32 v246, v246, v208, v207
  v_fma_f32 v247, v247, v208, v207
  v_mfma_f32_32x32x16_bf16 v[80:95], a[84:87], v[128:131], v[80:95]
  s_add_u32 s0, s0, 63488
  ds_read_b64_tr_b16 a[68:69], v193 offset:57344
  ds_read_b64_tr_b16 a[70:71], v193 offset:57856
  ds_read_b64_tr_b16 a[138:139], v214 offset:3072
  buffer_load_dwordx4 v210, s[52:55], s0 offen offset:2048 lds
  v_fma_f32 v248, v248, v208, v207
  v_fma_f32 v249, v249, v208, v207
  v_fma_f32 v250, v250, v208, v207
  v_fma_f32 v251, v251, v208, v207
  v_fma_f32 v252, v252, v208, v207
  v_fma_f32 v253, v253, v208, v207
  v_mfma_f32_32x32x16_bf16 v[96:111], a[88:91], v[128:131], v[96:111]
  ds_read_b64_tr_b16 a[72:73], v192 offset:59392
  ds_read_b64_tr_b16 a[74:75], v192 offset:59904
  ds_read_b64_tr_b16 a[140:141], v215 offset:2048
  v_cvt_pk_bf16_f32 v132, v246, v247
  v_cvt_pk_bf16_f32 v133, v248, v249
  v_cvt_pk_bf16_f32 v134, v250, v251
  v_cvt_pk_bf16_f32 v135, v252, v253
  v_accvgpr_write_b32 a0, v128
  v_accvgpr_write_b32 a1, v129
  v_mfma_f32_32x32x16_bf16 v[112:127], a[92:95], v[128:131], v[112:127]
  s_waitcnt lgkmcnt(10)
  ds_read_b64_tr_b16 a[76:77], v193 offset:59392
  ds_read_b64_tr_b16 a[78:79], v193 offset:59904
  ds_read_b64_tr_b16 a[142:143], v215 offset:3072
  buffer_load_dwordx4 v211, s[52:55], s0 offen offset:3072 lds
  v_accvgpr_write_b32 a2, v130
  v_accvgpr_write_b32 a3, v131
  v_lshlrev_b32 v238, 16, v136
  v_and_b32 v239, s74, v136
  v_lshlrev_b32 v240, 16, v137
  v_and_b32 v241, s74, v137
  v_mfma_f32_32x32x16_bf16 v[64:79], a[96:99], v[132:135], v[64:79]
  s_lshr_b32 s66, s20, 2
  s_lshl_b32 s66, s66, 1
  s_lshr_b32 s67, s64, 1
  s_add_u32 s66, s66, s67
  s_lshl_b32 s66, s66, 3
  s_and_b32 s67, s20, 3
  s_lshl_b32 s67, s67, 0
  s_add_u32 s66, s66, s67
  s_mul_i32 s66, s66, 24576
  ds_read_b64_tr_b16 a[80:81], v192 offset:61440
  ds_read_b64_tr_b16 a[82:83], v192 offset:61952
  buffer_load_dword a252, v203, s[36:39], s66 offen
  v_lshlrev_b32 v242, 16, v138
  v_and_b32 v243, s74, v138
  v_lshlrev_b32 v244, 16, v139
  v_and_b32 v245, s74, v139
  v_fma_f32 v238, v238, v208, v207
  v_fma_f32 v239, v239, v208, v207
  v_mfma_f32_32x32x16_bf16 v[80:95], a[100:103], v[132:135], v[80:95]
  ds_read_b64_tr_b16 a[84:85], v193 offset:61440
  ds_read_b64_tr_b16 a[86:87], v193 offset:61952
  v_fma_f32 v240, v240, v208, v207
  v_fma_f32 v241, v241, v208, v207
  v_fma_f32 v242, v242, v208, v207
  v_fma_f32 v243, v243, v208, v207
  v_fma_f32 v244, v244, v208, v207
  v_fma_f32 v245, v245, v208, v207
  v_mfma_f32_32x32x16_bf16 v[96:111], a[104:107], v[132:135], v[96:111]
  ds_read_b64_tr_b16 a[88:89], v192 offset:63488
  ds_read_b64_tr_b16 a[90:91], v192 offset:64000
  v_cvt_pk_bf16_f32 v136, v238, v239
  v_cvt_pk_bf16_f32 v137, v240, v241
  v_cvt_pk_bf16_f32 v138, v242, v243
  v_cvt_pk_bf16_f32 v139, v244, v245
  v_accvgpr_write_b32 a4, v132
  v_accvgpr_write_b32 a5, v133
  v_mfma_f32_32x32x16_bf16 v[112:127], a[108:111], v[132:135], v[112:127]
  s_waitcnt lgkmcnt(7)
  ds_read_b64_tr_b16 a[92:93], v193 offset:63488
  ds_read_b64_tr_b16 a[94:95], v193 offset:64000
  v_accvgpr_write_b32 a6, v134
  v_accvgpr_write_b32 a7, v135
  v_lshlrev_b32 v246, 16, v140
  v_and_b32 v247, s74, v140
  v_lshlrev_b32 v248, 16, v141
  v_and_b32 v249, s74, v141
  v_mfma_f32_32x32x16_bf16 v[64:79], a[64:67], v[136:139], v[64:79]
  s_waitcnt vmcnt(22)
  s_barrier
  s_add_u32 m0, s65, 16384
  ds_read_b64_tr_b16 a[96:97], v196 offset:0
  ds_read_b64_tr_b16 a[98:99], v196 offset:512
  buffer_load_dwordx4 v203, s[36:39], s92 offen lds
  v_lshlrev_b32 v250, 16, v142
  v_and_b32 v251, s74, v142
  v_lshlrev_b32 v252, 16, v143
  v_and_b32 v253, s74, v143
  v_fma_f32 v246, v246, v208, v207
  v_fma_f32 v247, v247, v208, v207
  v_mfma_f32_32x32x16_bf16 v[80:95], a[68:71], v[136:139], v[80:95]
  ds_read_b64_tr_b16 a[100:101], v197 offset:0
  ds_read_b64_tr_b16 a[102:103], v197 offset:512
  buffer_load_dwordx4 v204, s[36:39], s92 offen offset:1024 lds
  v_fma_f32 v248, v248, v208, v207
  v_fma_f32 v249, v249, v208, v207
  v_fma_f32 v250, v250, v208, v207
  v_fma_f32 v251, v251, v208, v207
  v_fma_f32 v252, v252, v208, v207
  v_fma_f32 v253, v253, v208, v207
  v_mfma_f32_32x32x16_bf16 v[96:111], a[72:75], v[136:139], v[96:111]
  ds_read_b64_tr_b16 a[104:105], v196 offset:2048
  ds_read_b64_tr_b16 a[106:107], v196 offset:2560
  buffer_load_dwordx4 v203, s[40:43], s92 offen offset:2048 lds
  v_cvt_pk_bf16_f32 v140, v246, v247
  v_cvt_pk_bf16_f32 v141, v248, v249
  v_cvt_pk_bf16_f32 v142, v250, v251
  v_cvt_pk_bf16_f32 v143, v252, v253
  v_accvgpr_write_b32 a8, v136
  v_accvgpr_write_b32 a9, v137
  v_mfma_f32_32x32x16_bf16 v[112:127], a[76:79], v[136:139], v[112:127]
  s_waitcnt lgkmcnt(6)
  ds_read_b64_tr_b16 a[108:109], v197 offset:2048
  ds_read_b64_tr_b16 a[110:111], v197 offset:2560
  v_accvgpr_write_b32 a10, v138
  v_accvgpr_write_b32 a11, v139
  v_lshlrev_b32 v238, 16, v144
  v_and_b32 v239, s74, v144
  v_lshlrev_b32 v240, 16, v145
  v_and_b32 v241, s74, v145
  v_mfma_f32_32x32x16_bf16 v[64:79], a[80:83], v[140:143], v[64:79]
  s_waitcnt vmcnt(21)
  ds_read_b64_tr_b16 a[64:65], v196 offset:4096
  ds_read_b64_tr_b16 a[66:67], v196 offset:4608
  ds_read_b64_tr_b16 a[144:145], v214 offset:16384
  buffer_load_dwordx4 v204, s[40:43], s92 offen offset:3072 lds
  v_lshlrev_b32 v242, 16, v146
  v_and_b32 v243, s74, v146
  v_lshlrev_b32 v244, 16, v147
  v_and_b32 v245, s74, v147
  v_fma_f32 v238, v238, v208, v207
  v_fma_f32 v239, v239, v208, v207
  v_mfma_f32_32x32x16_bf16 v[80:95], a[84:87], v[140:143], v[80:95]
  ds_read_b64_tr_b16 a[68:69], v197 offset:4096
  ds_read_b64_tr_b16 a[70:71], v197 offset:4608
  ds_read_b64_tr_b16 a[146:147], v214 offset:17408
  v_fma_f32 v240, v240, v208, v207
  v_fma_f32 v241, v241, v208, v207
  v_fma_f32 v242, v242, v208, v207
  v_fma_f32 v243, v243, v208, v207
  v_fma_f32 v244, v244, v208, v207
  v_fma_f32 v245, v245, v208, v207
  v_mfma_f32_32x32x16_bf16 v[96:111], a[88:91], v[140:143], v[96:111]
  s_add_u32 m0, s65, 65536
  s_add_u32 s0, s15, 131072
  s_and_b32 s0, s0, 524287
  s_add_u32 s0, s0, 524288
  ds_read_b64_tr_b16 a[72:73], v196 offset:6144
  ds_read_b64_tr_b16 a[74:75], v196 offset:6656
  ds_read_b64_tr_b16 a[148:149], v215 offset:16384
  buffer_load_dwordx4 v210, s[52:55], s0 offen lds
  v_cvt_pk_bf16_f32 v144, v238, v239
  v_cvt_pk_bf16_f32 v145, v240, v241
  v_cvt_pk_bf16_f32 v146, v242, v243
  v_cvt_pk_bf16_f32 v147, v244, v245
  v_accvgpr_write_b32 a12, v140
  v_accvgpr_write_b32 a13, v141
  v_mfma_f32_32x32x16_bf16 v[112:127], a[92:95], v[140:143], v[112:127]
  s_waitcnt lgkmcnt(9)
  ds_read_b64_tr_b16 a[76:77], v197 offset:6144
  ds_read_b64_tr_b16 a[78:79], v197 offset:6656
  ds_read_b64_tr_b16 a[150:151], v215 offset:17408
  buffer_load_dwordx4 v211, s[52:55], s0 offen offset:1024 lds
  v_accvgpr_write_b32 a14, v142
  v_accvgpr_write_b32 a15, v143
  v_lshlrev_b32 v246, 16, v148
  v_and_b32 v247, s74, v148
  v_lshlrev_b32 v248, 16, v149
  v_and_b32 v249, s74, v149
  v_mfma_f32_32x32x16_bf16 v[64:79], a[96:99], v[144:147], v[64:79]
  s_add_u32 s0, s0, 63488
  ds_read_b64_tr_b16 a[80:81], v196 offset:8192
  ds_read_b64_tr_b16 a[82:83], v196 offset:8704
  ds_read_b64_tr_b16 a[152:153], v214 offset:18432
  buffer_load_dwordx4 v210, s[52:55], s0 offen offset:2048 lds
  v_lshlrev_b32 v250, 16, v150
  v_and_b32 v251, s74, v150
  v_lshlrev_b32 v252, 16, v151
  v_and_b32 v253, s74, v151
  v_fma_f32 v246, v246, v208, v207
  v_fma_f32 v247, v247, v208, v207
  v_mfma_f32_32x32x16_bf16 v[80:95], a[100:103], v[144:147], v[80:95]
  ds_read_b64_tr_b16 a[84:85], v197 offset:8192
  ds_read_b64_tr_b16 a[86:87], v197 offset:8704
  ds_read_b64_tr_b16 a[154:155], v214 offset:19456
  v_fma_f32 v248, v248, v208, v207
  v_fma_f32 v249, v249, v208, v207
  v_fma_f32 v250, v250, v208, v207
  v_fma_f32 v251, v251, v208, v207
  v_fma_f32 v252, v252, v208, v207
  v_fma_f32 v253, v253, v208, v207
  v_mfma_f32_32x32x16_bf16 v[96:111], a[104:107], v[144:147], v[96:111]
  ds_read_b64_tr_b16 a[88:89], v196 offset:10240
  ds_read_b64_tr_b16 a[90:91], v196 offset:10752
  ds_read_b64_tr_b16 a[156:157], v215 offset:18432
  buffer_load_dwordx4 v211, s[52:55], s0 offen offset:3072 lds
  v_cvt_pk_bf16_f32 v148, v246, v247
  v_cvt_pk_bf16_f32 v149, v248, v249
  v_cvt_pk_bf16_f32 v150, v250, v251
  v_cvt_pk_bf16_f32 v151, v252, v253
  v_accvgpr_write_b32 a16, v144
  v_accvgpr_write_b32 a17, v145
  v_mfma_f32_32x32x16_bf16 v[112:127], a[108:111], v[144:147], v[112:127]
  s_waitcnt lgkmcnt(10)
  ds_read_b64_tr_b16 a[92:93], v197 offset:10240
  ds_read_b64_tr_b16 a[94:95], v197 offset:10752
  ds_read_b64_tr_b16 a[158:159], v215 offset:19456
  v_accvgpr_write_b32 a18, v146
  v_accvgpr_write_b32 a19, v147
  v_lshlrev_b32 v238, 16, v152
  v_and_b32 v239, s74, v152
  v_lshlrev_b32 v240, 16, v153
  v_and_b32 v241, s74, v153
  v_mfma_f32_32x32x16_bf16 v[64:79], a[64:67], v[148:151], v[64:79]
  ds_read_b64_tr_b16 a[96:97], v196 offset:12288
  ds_read_b64_tr_b16 a[98:99], v196 offset:12800
  v_lshlrev_b32 v242, 16, v154
  v_and_b32 v243, s74, v154
  v_lshlrev_b32 v244, 16, v155
  v_and_b32 v245, s74, v155
  v_fma_f32 v238, v238, v208, v207
  v_fma_f32 v239, v239, v208, v207
  v_mfma_f32_32x32x16_bf16 v[80:95], a[68:71], v[148:151], v[80:95]
  ds_read_b64_tr_b16 a[100:101], v197 offset:12288
  ds_read_b64_tr_b16 a[102:103], v197 offset:12800
  v_fma_f32 v240, v240, v208, v207
  v_fma_f32 v241, v241, v208, v207
  v_fma_f32 v242, v242, v208, v207
  v_fma_f32 v243, v243, v208, v207
  v_fma_f32 v244, v244, v208, v207
  v_fma_f32 v245, v245, v208, v207
  v_mfma_f32_32x32x16_bf16 v[96:111], a[72:75], v[148:151], v[96:111]
  ds_read_b64_tr_b16 a[104:105], v196 offset:14336
  ds_read_b64_tr_b16 a[106:107], v196 offset:14848
  v_cvt_pk_bf16_f32 v152, v238, v239
  v_cvt_pk_bf16_f32 v153, v240, v241
  v_cvt_pk_bf16_f32 v154, v242, v243
  v_cvt_pk_bf16_f32 v155, v244, v245
  v_accvgpr_write_b32 a20, v148
  v_accvgpr_write_b32 a21, v149
  v_mfma_f32_32x32x16_bf16 v[112:127], a[76:79], v[148:151], v[112:127]
  s_waitcnt lgkmcnt(7)
  ds_read_b64_tr_b16 a[108:109], v197 offset:14336
  ds_read_b64_tr_b16 a[110:111], v197 offset:14848
  v_accvgpr_write_b32 a22, v150
  v_accvgpr_write_b32 a23, v151
  v_lshlrev_b32 v246, 16, v156
  v_and_b32 v247, s74, v156
  v_lshlrev_b32 v248, 16, v157
  v_and_b32 v249, s74, v157
  v_mfma_f32_32x32x16_bf16 v[64:79], a[80:83], v[152:155], v[64:79]
  s_waitcnt vmcnt(25)
  v_readfirstlane_b32 s66, v221
  s_mul_i32 s67, s83, 1
  s_nop 0
  s_bfe_u32 s66, s66, 524288
  s_cmp_eq_u32 s66, s67
  s_cbranch_scc0 k_B_rdy_spin
k_B_rdy_ok:
  s_waitcnt vmcnt(21)
  s_barrier
  s_add_u32 m0, s65, 49152
  ds_read_b64_tr_b16 a[64:65], v196 offset:16384
  ds_read_b64_tr_b16 a[66:67], v196 offset:16896
  buffer_load_dwordx4 v203, s[36:39], s93 offen lds
  v_lshlrev_b32 v250, 16, v158
  v_and_b32 v251, s74, v158
  v_lshlrev_b32 v252, 16, v159
  v_and_b32 v253, s74, v159
  v_fma_f32 v246, v246, v208, v207
  v_fma_f32 v247, v247, v208, v207
  v_mfma_f32_32x32x16_bf16 v[80:95], a[84:87], v[152:155], v[80:95]
  ds_read_b64_tr_b16 a[68:69], v197 offset:16384
  ds_read_b64_tr_b16 a[70:71], v197 offset:16896
  buffer_load_dwordx4 v204, s[36:39], s93 offen offset:1024 lds
  v_fma_f32 v248, v248, v208, v207
  v_fma_f32 v249, v249, v208, v207
  v_fma_f32 v250, v250, v208, v207
  v_fma_f32 v251, v251, v208, v207
  v_fma_f32 v252, v252, v208, v207
  v_fma_f32 v253, v253, v208, v207
  v_mfma_f32_32x32x16_bf16 v[96:111], a[88:91], v[152:155], v[96:111]
  ds_read_b64_tr_b16 a[72:73], v196 offset:18432
  ds_read_b64_tr_b16 a[74:75], v196 offset:18944
  buffer_load_dwordx4 v203, s[40:43], s93 offen offset:2048 lds
  v_cvt_pk_bf16_f32 v156, v246, v247
  v_cvt_pk_bf16_f32 v157, v248, v249
  v_cvt_pk_bf16_f32 v158, v250, v251
  v_cvt_pk_bf16_f32 v159, v252, v253
  v_accvgpr_write_b32 a24, v152
  v_accvgpr_write_b32 a25, v153
  v_mfma_f32_32x32x16_bf16 v[112:127], a[92:95], v[152:155], v[112:127]
  s_waitcnt lgkmcnt(6)
  ds_read_b64_tr_b16 a[76:77], v197 offset:18432
  ds_read_b64_tr_b16 a[78:79], v197 offset:18944
  v_accvgpr_write_b32 a26, v154
  v_accvgpr_write_b32 a27, v155
  v_lshlrev_b32 v238, 16, v160
  v_and_b32 v239, s74, v160
  v_lshlrev_b32 v240, 16, v161
  v_and_b32 v241, s74, v161
  v_mfma_f32_32x32x16_bf16 v[64:79], a[96:99], v[156:159], v[64:79]
  s_waitcnt vmcnt(20)
  ds_read_b64_tr_b16 a[80:81], v196 offset:20480
  ds_read_b64_tr_b16 a[82:83], v196 offset:20992
  ds_read_b64_tr_b16 a[160:161], v214 offset:32768
  buffer_load_dwordx4 v204, s[40:43], s93 offen offset:3072 lds
  v_lshlrev_b32 v242, 16, v162
  v_and_b32 v243, s74, v162
  v_lshlrev_b32 v244, 16, v163
  v_and_b32 v245, s74, v163
  v_fma_f32 v238, v238, v208, v207
  v_fma_f32 v239, v239, v208, v207
  v_mfma_f32_32x32x16_bf16 v[80:95], a[100:103], v[156:159], v[80:95]
  ds_read_b64_tr_b16 a[84:85], v197 offset:20480
  ds_read_b64_tr_b16 a[86:87], v197 offset:20992
  ds_read_b64_tr_b16 a[162:163], v214 offset:33792
  v_fma_f32 v240, v240, v208, v207
  v_fma_f32 v241, v241, v208, v207
  v_fma_f32 v242, v242, v208, v207
  v_fma_f32 v243, v243, v208, v207
  v_fma_f32 v244, v244, v208, v207
  v_fma_f32 v245, v245, v208, v207
  v_mfma_f32_32x32x16_bf16 v[96:111], a[104:107], v[156:159], v[96:111]
  s_add_u32 m0, s65, 81920
  s_add_u32 s0, s15, 262144
  s_and_b32 s0, s0, 524287
  s_add_u32 s0, s0, 524288
  ds_read_b64_tr_b16 a[88:89], v196 offset:22528
  ds_read_b64_tr_b16 a[90:91], v196 offset:23040
  ds_read_b64_tr_b16 a[164:165], v215 offset:32768
  buffer_load_dwordx4 v210, s[52:55], s0 offen lds
  v_cvt_pk_bf16_f32 v160, v238, v239
  v_cvt_pk_bf16_f32 v161, v240, v241
  v_cvt_pk_bf16_f32 v162, v242, v243
  v_cvt_pk_bf16_f32 v163, v244, v245
  v_accvgpr_write_b32 a28, v156
  v_accvgpr_write_b32 a29, v157
  v_mfma_f32_32x32x16_bf16 v[112:127], a[108:111], v[156:159], v[112:127]
  s_waitcnt lgkmcnt(9)
  ds_read_b64_tr_b16 a[92:93], v197 offset:22528
  ds_read_b64_tr_b16 a[94:95], v197 offset:23040
  ds_read_b64_tr_b16 a[166:167], v215 offset:33792
  buffer_load_dwordx4 v211, s[52:55], s0 offen offset:1024 lds
  v_accvgpr_write_b32 a30, v158
  v_accvgpr_write_b32 a31, v159
  v_lshlrev_b32 v246, 16, v164
  v_and_b32 v247, s74, v164
  v_lshlrev_b32 v248, 16, v165
  v_and_b32 v249, s74, v165
  v_mfma_f32_32x32x16_bf16 v[64:79], a[64:67], v[160:163], v[64:79]
  s_add_u32 s0, s0, 63488
  ds_read_b64_tr_b16 a[96:97], v196 offset:24576
  ds_read_b64_tr_b16 a[98:99], v196 offset:25088
  ds_read_b64_tr_b16 a[168:169], v214 offset:34816
  buffer_load_dwordx4 v210, s[52:55], s0 offen offset:2048 lds
  v_lshlrev_b32 v250, 16, v166
  v_and_b32 v251, s74, v166
  v_lshlrev_b32 v252, 16, v167
  v_and_b32 v253, s74, v167
  v_fma_f32 v246, v246, v208, v207
  v_fma_f32 v247, v247, v208, v207
  v_mfma_f32_32x32x16_bf16 v[80:95], a[68:71], v[160:163], v[80:95]
  ds_read_b64_tr_b16 a[100:101], v197 offset:24576
  ds_read_b64_tr_b16 a[102:103], v197 offset:25088
  ds_read_b64_tr_b16 a[170:171], v214 offset:35840
  v_fma_f32 v248, v248, v208, v207
  v_fma_f32 v249, v249, v208, v207
  v_fma_f32 v250, v250, v208, v207
  v_fma_f32 v251, v251, v208, v207
  v_fma_f32 v252, v252, v208, v207
  v_fma_f32 v253, v253, v208, v207
  v_mfma_f32_32x32x16_bf16 v[96:111], a[72:75], v[160:163], v[96:111]
  ds_read_b64_tr_b16 a[104:105], v196 offset:26624
  ds_read_b64_tr_b16 a[106:107], v196 offset:27136
  ds_read_b64_tr_b16 a[172:173], v215 offset:34816
  buffer_load_dwordx4 v211, s[52:55], s0 offen offset:3072 lds
  v_cvt_pk_bf16_f32 v164, v246, v247
  v_cvt_pk_bf16_f32 v165, v248, v249
  v_cvt_pk_bf16_f32 v166, v250, v251
  v_cvt_pk_bf16_f32 v167, v252, v253
  v_accvgpr_write_b32 a32, v160
  v_accvgpr_write_b32 a33, v161
  v_mfma_f32_32x32x16_bf16 v[112:127], a[76:79], v[160:163], v[112:127]
  s_waitcnt lgkmcnt(10)
  ds_read_b64_tr_b16 a[108:109], v197 offset:26624
  ds_read_b64_tr_b16 a[110:111], v197 offset:27136
  ds_read_b64_tr_b16 a[174:175], v215 offset:35840
  v_accvgpr_write_b32 a34, v162
  v_accvgpr_write_b32 a35, v163
  v_lshlrev_b32 v238, 16, v168
  v_and_b32 v239, s74, v168
  v_lshlrev_b32 v240, 16, v169
  v_and_b32 v241, s74, v169
  v_mfma_f32_32x32x16_bf16 v[64:79], a[80:83], v[164:167], v[64:79]
  ds_read_b64_tr_b16 a[64:65], v196 offset:28672
  ds_read_b64_tr_b16 a[66:67], v196 offset:29184
  v_lshlrev_b32 v242, 16, v170
  v_and_b32 v243, s74, v170
  v_lshlrev_b32 v244, 16, v171
  v_and_b32 v245, s74, v171
  v_fma_f32 v238, v238, v208, v207
  v_fma_f32 v239, v239, v208, v207
  v_mfma_f32_32x32x16_bf16 v[80:95], a[84:87], v[164:167], v[80:95]
  ds_read_b64_tr_b16 a[68:69], v197 offset:28672
  ds_read_b64_tr_b16 a[70:71], v197 offset:29184
  v_fma_f32 v240, v240, v208, v207
  v_fma_f32 v241, v241, v208, v207
  v_fma_f32 v242, v242, v208, v207
  v_fma_f32 v243, v243, v208, v207
  v_fma_f32 v244, v244, v208, v207
  v_fma_f32 v245, v245, v208, v207
  v_mfma_f32_32x32x16_bf16 v[96:111], a[88:91], v[164:167], v[96:111]
  ds_read_b64_tr_b16 a[72:73], v196 offset:30720
  ds_read_b64_tr_b16 a[74:75], v196 offset:31232
  v_cvt_pk_bf16_f32 v168, v238, v239
  v_cvt_pk_bf16_f32 v169, v240, v241
  v_cvt_pk_bf16_f32 v170, v242, v243
  v_cvt_pk_bf16_f32 v171, v244, v245
  v_accvgpr_write_b32 a36, v164
  v_accvgpr_write_b32 a37, v165
  v_mfma_f32_32x32x16_bf16 v[112:127], a[92:95], v[164:167], v[112:127]
  s_waitcnt lgkmcnt(7)
  ds_read_b64_tr_b16 a[76:77], v197 offset:30720
  ds_read_b64_tr_b16 a[78:79], v197 offset:31232
  v_accvgpr_write_b32 a38, v166
  v_accvgpr_write_b32 a39, v167
  v_lshlrev_b32 v246, 16, v172
  v_and_b32 v247, s74, v172
  v_lshlrev_b32 v248, 16, v173
  v_and_b32 v249, s74, v173
  v_mfma_f32_32x32x16_bf16 v[64:79], a[96:99], v[168:171], v[64:79]
  s_waitcnt vmcnt(21)
  s_barrier
  s_add_u32 m0, s65, 131072
  ds_read_b64_tr_b16 a[80:81], v192 offset:0
  ds_read_b64_tr_b16 a[82:83], v192 offset:512
  buffer_load_dwordx4 v203, s[36:39], s94 offen lds
  v_lshlrev_b32 v250, 16, v174
  v_and_b32 v251, s74, v174
  v_lshlrev_b32 v252, 16, v175
  v_and_b32 v253, s74, v175
  v_fma_f32 v246, v246, v208, v207
  v_fma_f32 v247, v247, v208, v207
  v_mfma_f32_32x32x16_bf16 v[80:95], a[100:103], v[168:171], v[80:95]
  ds_read_b64_tr_b16 a[84:85], v193 offset:0
  ds_read_b64_tr_b16 a[86:87], v193 offset:512
  buffer_load_dwordx4 v204, s[36:39], s94 offen offset:1024 lds
  v_fma_f32 v248, v248, v208, v207
  v_fma_f32 v249, v249, v208, v207
  v_fma_f32 v250, v250, v208, v207
  v_fma_f32 v251, v251, v208, v207
  v_fma_f32 v252, v252, v208, v207
  v_fma_f32 v253, v253, v208, v207
  v_mfma_f32_32x32x16_bf16 v[96:111], a[104:107], v[168:171], v[96:111]
  ds_read_b64_tr_b16 a[88:89], v192 offset:2048
  ds_read_b64_tr_b16 a[90:91], v192 offset:2560
  buffer_load_dwordx4 v203, s[40:43], s94 offen offset:2048 lds
  v_cvt_pk_bf16_f32 v172, v246, v247
  v_cvt_pk_bf16_f32 v173, v248, v249
  v_cvt_pk_bf16_f32 v174, v250, v251
  v_cvt_pk_bf16_f32 v175, v252, v253
  v_accvgpr_write_b32 a40, v168
  v_accvgpr_write_b32 a41, v169
  v_mfma_f32_32x32x16_bf16 v[112:127], a[108:111], v[168:171], v[112:127]
  s_waitcnt lgkmcnt(6)
  ds_read_b64_tr_b16 a[92:93], v193 offset:2048
  ds_read_b64_tr_b16 a[94:95], v193 offset:2560
  buffer_load_dwordx4 v204, s[40:43], s94 offen offset:3072 lds
  v_accvgpr_write_b32 a42, v170
  v_accvgpr_write_b32 a43, v171
  v_lshlrev_b32 v238, 16, v176
  v_and_b32 v239, s74, v176
  v_lshlrev_b32 v240, 16, v177
  v_and_b32 v241, s74, v177
  v_mfma_f32_32x32x16_bf16 v[64:79], a[64:67], v[172:175], v[64:79]
  s_waitcnt vmcnt(21)
  ds_read_b64_tr_b16 a[96:97], v192 offset:4096
  ds_read_b64_tr_b16 a[98:99], v192 offset:4608
  ds_read_b64_tr_b16 a[176:177], v212 offset:32768
  v_lshlrev_b32 v242, 16, v178
  v_and_b32 v243, s74, v178
  v_lshlrev_b32 v244, 16, v179
  v_and_b32 v245, s74, v179
  v_fma_f32 v238, v238, v208, v207
  v_fma_f32 v239, v239, v208, v207
  v_mfma_f32_32x32x16_bf16 v[80:95], a[68:71], v[172:175], v[80:95]
  s_add_u32 m0, s65, 98304
  s_add_u32 s0, s15, 393216
  s_and_b32 s0, s0, 524287
  s_add_u32 s0, s0, 524288
  ds_read_b64_tr_b16 a[100:101], v193 offset:4096
  ds_read_b64_tr_b16 a[102:103], v193 offset:4608
  ds_read_b64_tr_b16 a[178:179], v212 offset:33792
  buffer_load_dwordx4 v210, s[52:55], s0 offen lds
  v_fma_f32 v240, v240, v208, v207
  v_fma_f32 v241, v241, v208, v207
  v_fma_f32 v242, v242, v208, v207
  v_fma_f32 v243, v243, v208, v207
  v_fma_f32 v244, v244, v208, v207
  v_fma_f32 v245, v245, v208, v207
  v_mfma_f32_32x32x16_bf16 v[96:111], a[72:75], v[172:175], v[96:111]
  ds_read_b64_tr_b16 a[104:105], v192 offset:6144
  ds_read_b64_tr_b16 a[106:107], v192 offset:6656
  ds_read_b64_tr_b16 a[180:181], v213 offset:32768
  v_cvt_pk_bf16_f32 v176, v238, v239
  v_cvt_pk_bf16_f32 v177, v240, v241
  v_cvt_pk_bf16_f32 v178, v242, v243
  v_cvt_pk_bf16_f32 v179, v244, v245
  v_accvgpr_write_b32 a44, v172
  v_accvgpr_write_b32 a45, v173
  v_mfma_f32_32x32x16_bf16 v[112:127], a[76:79], v[172:175], v[112:127]
  s_waitcnt lgkmcnt(9)
  ds_read_b64_tr_b16 a[108:109], v193 offset:6144
  ds_read_b64_tr_b16 a[110:111], v193 offset:6656
  ds_read_b64_tr_b16 a[182:183], v213 offset:33792
  buffer_load_dwordx4 v211, s[52:55], s0 offen offset:1024 lds
  v_accvgpr_write_b32 a46, v174
  v_accvgpr_write_b32 a47, v175
  v_lshlrev_b32 v246, 16, v180
  v_and_b32 v247, s74, v180
  v_lshlrev_b32 v248, 16, v181
  v_and_b32 v249, s74, v181
  v_mfma_f32_32x32x16_bf16 v[64:79], a[80:83], v[176:179], v[64:79]
  s_add_u32 s0, s0, 63488
  ds_read_b64_tr_b16 a[64:65], v192 offset:8192
  ds_read_b64_tr_b16 a[66:67], v192 offset:8704
  ds_read_b64_tr_b16 a[184:185], v212 offset:34816
  buffer_load_dwordx4 v210, s[52:55], s0 offen offset:2048 lds
  v_lshlrev_b32 v250, 16, v182
  v_and_b32 v251, s74, v182
  v_lshlrev_b32 v252, 16, v183
  v_and_b32 v253, s74, v183
  v_fma_f32 v246, v246, v208, v207
  v_fma_f32 v247, v247, v208, v207
  v_mfma_f32_32x32x16_bf16 v[80:95], a[84:87], v[176:179], v[80:95]
  ds_read_b64_tr_b16 a[68:69], v193 offset:8192
  ds_read_b64_tr_b16 a[70:71], v193 offset:8704
  ds_read_b64_tr_b16 a[186:187], v212 offset:35840
  v_fma_f32 v248, v248, v208, v207
  v_fma_f32 v249, v249, v208, v207
  v_fma_f32 v250, v250, v208, v207
  v_fma_f32 v251, v251, v208, v207
  v_fma_f32 v252, v252, v208, v207
  v_fma_f32 v253, v253, v208, v207
  v_mfma_f32_32x32x16_bf16 v[96:111], a[88:91], v[176:179], v[96:111]
  ds_read_b64_tr_b16 a[72:73], v192 offset:10240
  ds_read_b64_tr_b16 a[74:75], v192 offset:10752
  ds_read_b64_tr_b16 a[188:189], v213 offset:34816
  buffer_load_dwordx4 v211, s[52:55], s0 offen offset:3072 lds
  v_cvt_pk_bf16_f32 v180, v246, v247
  v_cvt_pk_bf16_f32 v181, v248, v249
  v_cvt_pk_bf16_f32 v182, v250, v251
  v_cvt_pk_bf16_f32 v183, v252, v253
  v_accvgpr_write_b32 a48, v176
  v_accvgpr_write_b32 a49, v177
  v_mfma_f32_32x32x16_bf16 v[112:127], a[92:95], v[176:179], v[112:127]
  s_waitcnt lgkmcnt(10)
  s_mul_i32 s66, s18, 28672
  ds_read_b64_tr_b16 a[76:77], v193 offset:10240
  ds_read_b64_tr_b16 a[78:79], v193 offset:10752
  ds_read_b64_tr_b16 a[190:191], v213 offset:35840
  buffer_load_dword a254, v205, s[28:31], s66 offen
  v_accvgpr_write_b32 a50, v178
  v_accvgpr_write_b32 a51, v179
  v_lshlrev_b32 v238, 16, v184
  v_and_b32 v239, s74, v184
  v_lshlrev_b32 v240, 16, v185
  v_and_b32 v241, s74, v185
  v_mfma_f32_32x32x16_bf16 v[64:79], a[96:99], v[180:183], v[64:79]
  ds_read_b64_tr_b16 a[80:81], v192 offset:12288
  ds_read_b64_tr_b16 a[82:83], v192 offset:12800
  buffer_load_dword a255, v205, s[32:35], s66 offen offset:2048
  v_lshlrev_b32 v242, 16, v186
  v_and_b32 v243, s74, v186
  v_lshlrev_b32 v244, 16, v187
  v_and_b32 v245, s74, v187
  v_fma_f32 v238, v238, v208, v207
  v_fma_f32 v239, v239, v208, v207
  v_mfma_f32_32x32x16_bf16 v[80:95], a[100:103], v[180:183], v[80:95]
  ds_read_b64_tr_b16 a[84:85], v193 offset:12288
  ds_read_b64_tr_b16 a[86:87], v193 offset:12800
  v_fma_f32 v240, v240, v208, v207
  v_fma_f32 v241, v241, v208, v207
  v_fma_f32 v242, v242, v208, v207
  v_fma_f32 v243, v243, v208, v207
  v_fma_f32 v244, v244, v208, v207
  v_fma_f32 v245, v245, v208, v207
  v_mfma_f32_32x32x16_bf16 v[96:111], a[104:107], v[180:183], v[96:111]
  ds_read_b64_tr_b16 a[88:89], v192 offset:14336
  ds_read_b64_tr_b16 a[90:91], v192 offset:14848
  v_cvt_pk_bf16_f32 v184, v238, v239
  v_cvt_pk_bf16_f32 v185, v240, v241
  v_cvt_pk_bf16_f32 v186, v242, v243
  v_cvt_pk_bf16_f32 v187, v244, v245
  v_accvgpr_write_b32 a52, v180
  v_accvgpr_write_b32 a53, v181
  v_mfma_f32_32x32x16_bf16 v[112:127], a[108:111], v[180:183], v[112:127]
  s_waitcnt lgkmcnt(7)
  ds_read_b64_tr_b16 a[92:93], v193 offset:14336
  ds_read_b64_tr_b16 a[94:95], v193 offset:14848
  v_accvgpr_write_b32 a54, v182
  v_accvgpr_write_b32 a55, v183
  v_lshlrev_b32 v246, 16, v188
  v_and_b32 v247, s74, v188
  v_lshlrev_b32 v248, 16, v189
  v_and_b32 v249, s74, v189
  v_mfma_f32_32x32x16_bf16 v[64:79], a[64:67], v[184:187], v[64:79]
  s_waitcnt vmcnt(22)
  s_barrier
  s_add_u32 m0, s65, 147456
  s_add_u32 s0, s15, 0
  s_and_b32 s0, s0, 262143
  s_add_u32 s0, s0, 1048576
  ds_read_b64_tr_b16 a[96:97], v192 offset:16384
  ds_read_b64_tr_b16 a[98:99], v192 offset:16896
  buffer_load_dwordx4 v210, s[52:55], s0 offen lds
  v_lshlrev_b32 v250, 16, v190
  v_and_b32 v251, s74, v190
  v_lshlrev_b32 v252, 16, v191
  v_and_b32 v253, s74, v191
  v_fma_f32 v246, v246, v208, v207
  v_mfma_f32_32x32x16_bf16 v[80:95], a[68:71], v[184:187], v[80:95]
  ds_read_b64_tr_b16 a[100:101], v193 offset:16384
  ds_read_b64_tr_b16 a[102:103], v193 offset:16896
  buffer_load_dwordx4 v211, s[52:55], s0 offen offset:1024 lds
  v_fma_f32 v247, v247, v208, v207
  v_fma_f32 v248, v248, v208, v207
  v_fma_f32 v249, v249, v208, v207
  v_fma_f32 v250, v250, v208, v207
  v_fma_f32 v251, v251, v208, v207
  v_mfma_f32_32x32x16_bf16 v[96:111], a[72:75], v[184:187], v[96:111]
  s_add_u32 s0, s0, 63488
  ds_read_b64_tr_b16 a[104:105], v192 offset:18432
  ds_read_b64_tr_b16 a[106:107], v192 offset:18944
  buffer_load_dwordx4 v210, s[52:55], s0 offen offset:2048 lds
  v_fma_f32 v252, v252, v208, v207
  v_fma_f32 v253, v253, v208, v207
  v_cvt_pk_bf16_f32 v188, v246, v247
  v_cvt_pk_bf16_f32 v189, v248, v249
  v_cvt_pk_bf16_f32 v190, v250, v251
  v_mfma_f32_32x32x16_bf16 v[112:127], a[76:79], v[184:187], v[112:127]
  s_waitcnt lgkmcnt(6)
  ds_read_b64_tr_b16 a[108:109], v193 offset:18432
  ds_read_b64_tr_b16 a[110:111], v193 offset:18944
  v_cvt_pk_bf16_f32 v191, v252, v253
  v_accvgpr_write_b32 a56, v184
  v_accvgpr_write_b32 a57, v185
  v_accvgpr_write_b32 a58, v186
  v_accvgpr_write_b32 a59, v187
  v_mfma_f32_32x32x16_bf16 v[64:79], a[80:83], v[188:191], v[64:79]
  s_waitcnt vmcnt(21)
  ds_read_b64_tr_b16 a[64:65], v192 offset:20480
  ds_read_b64_tr_b16 a[66:67], v192 offset:20992
  ds_read_b64_tr_b16 a[192:193], v214 offset:0
  buffer_load_dwordx4 v211, s[52:55], s0 offen offset:3072 lds
  v_accvgpr_write_b32 a60, v188
  v_mfma_f32_32x32x16_bf16 v[80:95], a[84:87], v[188:191], v[80:95]
  ds_read_b64_tr_b16 a[68:69], v193 offset:20480
  ds_read_b64_tr_b16 a[70:71], v193 offset:20992
  ds_read_b64_tr_b16 a[194:195], v214 offset:1024
  v_accvgpr_write_b32 a61, v189
  v_mfma_f32_32x32x16_bf16 v[96:111], a[88:91], v[188:191], v[96:111]
  ds_read_b64_tr_b16 a[72:73], v192 offset:22528
  ds_read_b64_tr_b16 a[74:75], v192 offset:23040
  ds_read_b64_tr_b16 a[196:197], v215 offset:0
  v_accvgpr_write_b32 a62, v190
  v_mfma_f32_32x32x16_bf16 v[112:127], a[92:95], v[188:191], v[112:127]
  s_waitcnt lgkmcnt(9)
  ds_read_b64_tr_b16 a[76:77], v193 offset:22528
  ds_read_b64_tr_b16 a[78:79], v193 offset:23040
  ds_read_b64_tr_b16 a[198:199], v215 offset:1024
  v_accvgpr_write_b32 a63, v191
  v_mfma_f32_32x32x16_bf16 v[128:143], a[96:99], v[0:3], 0
  ds_read_b64_tr_b16 a[80:81], v192 offset:24576
  ds_read_b64_tr_b16 a[82:83], v192 offset:25088
  ds_read_b64_tr_b16 a[200:201], v214 offset:2048
  v_mfma_f32_32x32x16_bf16 v[144:159], a[100:103], v[0:3], 0
  ds_read_b64_tr_b16 a[84:85], v193 offset:24576
  ds_read_b64_tr_b16 a[86:87], v193 offset:25088
  ds_read_b64_tr_b16 a[202:203], v214 offset:3072
  v_mfma_f32_32x32x16_bf16 v[128:143], a[104:107], v[4:7], v[128:143]
  ds_read_b64_tr_b16 a[88:89], v192 offset:26624
  ds_read_b64_tr_b16 a[90:91], v192 offset:27136
  ds_read_b64_tr_b16 a[204:205], v215 offset:2048
  v_mul_f32 v64, s72, v64
  v_mul_f32 v65, s72, v65
  v_mul_f32 v66, s72, v66
  v_mul_f32 v67, s72, v67
  v_mfma_f32_32x32x16_bf16 v[144:159], a[108:111], v[4:7], v[144:159]
  s_waitcnt lgkmcnt(10)
  ds_read_b64_tr_b16 a[92:93], v193 offset:26624
  ds_read_b64_tr_b16 a[94:95], v193 offset:27136
  ds_read_b64_tr_b16 a[206:207], v215 offset:3072
  v_exp_f32 v64, v64
  v_exp_f32 v65, v65
  v_mfma_f32_32x32x16_bf16 v[128:143], a[64:67], v[8:11], v[128:143]
  ds_read_b64_tr_b16 a[96:97], v192 offset:28672
  ds_read_b64_tr_b16 a[98:99], v192 offset:29184
  v_exp_f32 v66, v66
  v_exp_f32 v67, v67
  v_add_f32 v64, 1.0, v64
  v_mfma_f32_32x32x16_bf16 v[144:159], a[68:71], v[8:11], v[144:159]
  ds_read_b64_tr_b16 a[100:101], v193 offset:28672
  ds_read_b64_tr_b16 a[102:103], v193 offset:29184
  v_add_f32 v65, 1.0, v65
  v_add_f32 v66, 1.0, v66
  v_add_f32 v67, 1.0, v67
  v_rcp_f32 v64, v64
  v_mfma_f32_32x32x16_bf16 v[128:143], a[72:75], v[12:15], v[128:143]
  ds_read_b64_tr_b16 a[104:105], v192 offset:30720
  ds_read_b64_tr_b16 a[106:107], v192 offset:31232
  v_rcp_f32 v65, v65
  v_rcp_f32 v66, v66
  v_mfma_f32_32x32x16_bf16 v[144:159], a[76:79], v[12:15], v[144:159]
  s_waitcnt lgkmcnt(7)
  ds_read_b64_tr_b16 a[108:109], v193 offset:30720
  ds_read_b64_tr_b16 a[110:111], v193 offset:31232
  v_rcp_f32 v67, v67
  v_mul_f32 v96, v64, v96
  v_mul_f32 v97, v65, v97
  v_mul_f32 v98, v66, v98
  v_mfma_f32_32x32x16_bf16 v[128:143], a[80:83], v[16:19], v[128:143]
  s_waitcnt vmcnt(18)
  s_barrier
  s_add_u32 m0, s65, 0
  ds_read_b64_tr_b16 a[64:65], v192 offset:49152
  ds_read_b64_tr_b16 a[66:67], v192 offset:49664
  buffer_load_dwordx4 v203, s[36:39], s95 offen lds
  v_mul_f32 v99, v67, v99
  v_cvt_pk_bf16_f32 v240, v96, v97
  v_cvt_pk_bf16_f32 v241, v98, v99
  v_mul_f32 v68, s72, v68
  v_mfma_f32_32x32x16_bf16 v[144:159], a[84:87], v[16:19], v[144:159]
  ds_read_b64_tr_b16 a[68:69], v193 offset:49152
  ds_read_b64_tr_b16 a[70:71], v193 offset:49664
  buffer_load_dwordx4 v204, s[36:39], s95 offen offset:1024 lds
  v_mul_f32 v69, s72, v69
  v_mul_f32 v70, s72, v70
  v_mul_f32 v71, s72, v71
  v_mfma_f32_32x32x16_bf16 v[128:143], a[88:91], v[20:23], v[128:143]
  ds_read_b64_tr_b16 a[72:73], v192 offset:51200
  ds_read_b64_tr_b16 a[74:75], v192 offset:51712
  v_exp_f32 v68, v68
  v_exp_f32 v69, v69
  v_mfma_f32_32x32x16_bf16 v[144:159], a[92:95], v[20:23], v[144:159]
  s_waitcnt lgkmcnt(6)
  ds_read_b64_tr_b16 a[76:77], v193 offset:51200
  ds_read_b64_tr_b16 a[78:79], v193 offset:51712
  buffer_load_dwordx4 v203, s[40:43], s95 offen offset:2048 lds
  v_exp_f32 v70, v70
  v_exp_f32 v71, v71
  v_mfma_f32_32x32x16_bf16 v[128:143], a[96:99], v[24:27], v[128:143]
  s_waitcnt vmcnt(17)
  ds_read_b64_tr_b16 a[80:81], v192 offset:53248
  ds_read_b64_tr_b16 a[82:83], v192 offset:53760
  ds_read_b64_tr_b16 a[208:209], v214 offset:16384
  v_add_f32 v68, 1.0, v68
  v_add_f32 v69, 1.0, v69
  v_add_f32 v70, 1.0, v70
  v_add_f32 v71, 1.0, v71
  v_mfma_f32_32x32x16_bf16 v[144:159], a[100:103], v[24:27], v[144:159]
  ds_read_b64_tr_b16 a[84:85], v193 offset:53248
  ds_read_b64_tr_b16 a[86:87], v193 offset:53760
  ds_read_b64_tr_b16 a[210:211], v214 offset:17408
  buffer_load_dwordx4 v204, s[40:43], s95 offen offset:3072 lds
  v_rcp_f32 v68, v68
  v_rcp_f32 v69, v69
  v_mfma_f32_32x32x16_bf16 v[128:143], a[104:107], v[28:31], v[128:143]
  ds_read_b64_tr_b16 a[88:89], v192 offset:55296
  ds_read_b64_tr_b16 a[90:91], v192 offset:55808
  ds_read_b64_tr_b16 a[212:213], v215 offset:16384
  v_rcp_f32 v70, v70
  v_rcp_f32 v71, v71
  v_mfma_f32_32x32x16_bf16 v[144:159], a[108:111], v[28:31], v[144:159]
  s_waitcnt lgkmcnt(9)
  ds_read_b64_tr_b16 a[92:93], v193 offset:55296
  ds_read_b64_tr_b16 a[94:95], v193 offset:55808
  ds_read_b64_tr_b16 a[214:215], v215 offset:17408
  v_mul_f32 v100, v68, v100
  v_mul_f32 v101, v69, v101
  v_mul_f32 v102, v70, v102
  v_mul_f32 v103, v71, v103
  v_mfma_f32_32x32x16_bf16 v[128:143], a[64:67], v[32:35], v[128:143]
  ds_read_b64_tr_b16 a[96:97], v192 offset:57344
  ds_read_b64_tr_b16 a[98:99], v192 offset:57856
  ds_read_b64_tr_b16 a[216:217], v214 offset:18432
  v_cvt_pk_bf16_f32 v242, v100, v101
  v_cvt_pk_bf16_f32 v243, v102, v103
  v_mfma_f32_32x32x16_bf16 v[144:159], a[68:71], v[32:35], v[144:159]
  ds_read_b64_tr_b16 a[100:101], v193 offset:57344
  ds_read_b64_tr_b16 a[102:103], v193 offset:57856
  ds_read_b64_tr_b16 a[218:219], v214 offset:19456
  buffer_store_dwordx4 v[240:243], v200, s[44:47], s69 offen offset:0 sc1
  v_mul_f32 v72, s72, v72
  v_mul_f32 v73, s72, v73
  v_mfma_f32_32x32x16_bf16 v[128:143], a[72:75], v[36:39], v[128:143]
  ds_read_b64_tr_b16 a[104:105], v192 offset:59392
  ds_read_b64_tr_b16 a[106:107], v192 offset:59904
  ds_read_b64_tr_b16 a[220:221], v215 offset:18432
  v_mul_f32 v74, s72, v74
  v_mul_f32 v75, s72, v75
  v_exp_f32 v72, v72
  v_mfma_f32_32x32x16_bf16 v[144:159], a[76:79], v[36:39], v[144:159]
  s_waitcnt lgkmcnt(10)
  ds_read_b64_tr_b16 a[108:109], v193 offset:59392
  ds_read_b64_tr_b16 a[110:111], v193 offset:59904
  ds_read_b64_tr_b16 a[222:223], v215 offset:19456
  v_exp_f32 v73, v73
  v_exp_f32 v74, v74
  v_mfma_f32_32x32x16_bf16 v[128:143], a[80:83], v[40:43], v[128:143]
  ds_read_b64_tr_b16 a[64:65], v192 offset:61440
  ds_read_b64_tr_b16 a[66:67], v192 offset:61952
  v_exp_f32 v75, v75
  v_add_f32 v72, 1.0, v72
  v_add_f32 v73, 1.0, v73
  v_add_f32 v74, 1.0, v74
  v_mfma_f32_32x32x16_bf16 v[144:159], a[84:87], v[40:43], v[144:159]
  ds_read_b64_tr_b16 a[68:69], v193 offset:61440
  ds_read_b64_tr_b16 a[70:71], v193 offset:61952
  v_add_f32 v75, 1.0, v75
  v_rcp_f32 v72, v72
  v_rcp_f32 v73, v73
  v_mfma_f32_32x32x16_bf16 v[128:143], a[88:91], v[44:47], v[128:143]
  ds_read_b64_tr_b16 a[72:73], v192 offset:63488
  ds_read_b64_tr_b16 a[74:75], v192 offset:64000
  v_rcp_f32 v74, v74
  v_rcp_f32 v75, v75
  v_mul_f32 v104, v72, v104
  v_mfma_f32_32x32x16_bf16 v[144:159], a[92:95], v[44:47], v[144:159]
  s_waitcnt lgkmcnt(7)
  ds_read_b64_tr_b16 a[76:77], v193 offset:63488
  ds_read_b64_tr_b16 a[78:79], v193 offset:64000
  v_mul_f32 v105, v73, v105
  v_mul_f32 v106, v74, v106
  v_mul_f32 v107, v75, v107
  v_cvt_pk_bf16_f32 v244, v104, v105
  v_cvt_pk_bf16_f32 v245, v106, v107
  v_mfma_f32_32x32x16_bf16 v[128:143], a[96:99], v[48:51], v[128:143]
  s_waitcnt vmcnt(15)
  s_barrier
  s_add_u32 m0, s65, 16384
  ds_read_b64_tr_b16 a[80:81], v196 offset:0
  ds_read_b64_tr_b16 a[82:83], v196 offset:512
  buffer_load_dwordx4 v205, s[28:31], s84 offen lds
  v_mul_f32 v76, s72, v76
  v_mul_f32 v77, s72, v77
  v_mul_f32 v78, s72, v78
  v_mul_f32 v79, s72, v79
  v_mfma_f32_32x32x16_bf16 v[144:159], a[100:103], v[48:51], v[144:159]
  ds_read_b64_tr_b16 a[84:85], v197 offset:0
  ds_read_b64_tr_b16 a[86:87], v197 offset:512
  buffer_load_dwordx4 v206, s[28:31], s84 offen offset:1024 lds
  v_exp_f32 v76, v76
  v_exp_f32 v77, v77
  v_mfma_f32_32x32x16_bf16 v[128:143], a[104:107], v[52:55], v[128:143]
  ds_read_b64_tr_b16 a[88:89], v196 offset:2048
  ds_read_b64_tr_b16 a[90:91], v196 offset:2560
  v_exp_f32 v78, v78
  v_exp_f32 v79, v79
  v_add_f32 v76, 1.0, v76
  v_mfma_f32_32x32x16_bf16 v[144:159], a[108:111], v[52:55], v[144:159]
  s_waitcnt lgkmcnt(6)
  ds_read_b64_tr_b16 a[92:93], v197 offset:2048
  ds_read_b64_tr_b16 a[94:95], v197 offset:2560
  buffer_load_dwordx4 v205, s[32:35], s84 offen offset:2048 lds
  v_add_f32 v77, 1.0, v77
  v_add_f32 v78, 1.0, v78
  v_add_f32 v79, 1.0, v79
  v_mfma_f32_32x32x16_bf16 v[128:143], a[64:67], v[56:59], v[128:143]
  s_waitcnt vmcnt(14)
  ds_read_b64_tr_b16 a[96:97], v196 offset:4096
  ds_read_b64_tr_b16 a[98:99], v196 offset:4608
  ds_read_b64_tr_b16 a[224:225], v214 offset:32768
  v_rcp_f32 v76, v76
  v_rcp_f32 v77, v77
  v_mfma_f32_32x32x16_bf16 v[144:159], a[68:71], v[56:59], v[144:159]
  ds_read_b64_tr_b16 a[100:101], v197 offset:4096
  ds_read_b64_tr_b16 a[102:103], v197 offset:4608
  ds_read_b64_tr_b16 a[226:227], v214 offset:33792
  buffer_load_dwordx4 v206, s[32:35], s84 offen offset:3072 lds
  v_rcp_f32 v78, v78
  v_rcp_f32 v79, v79
  v_mfma_f32_32x32x16_bf16 v[128:143], a[72:75], v[60:63], v[128:143]
  ds_read_b64_tr_b16 a[104:105], v196 offset:6144
  ds_read_b64_tr_b16 a[106:107], v196 offset:6656
  ds_read_b64_tr_b16 a[228:229], v215 offset:32768
  v_mul_f32 v108, v76, v108
  v_mul_f32 v109, v77, v109
  v_mul_f32 v110, v78, v110
  v_mul_f32 v111, v79, v111
  v_mfma_f32_32x32x16_bf16 v[144:159], a[76:79], v[60:63], v[144:159]
  s_waitcnt lgkmcnt(9)
  s_add_u32 m0, s65, 32768
  s_add_u32 s1, s15, 131072
  s_and_b32 s1, s1, 262143
  s_add_u32 s1, s1, 1048576
  ds_read_b64_tr_b16 a[108:109], v197 offset:6144
  ds_read_b64_tr_b16 a[110:111], v197 offset:6656
  ds_read_b64_tr_b16 a[230:231], v215 offset:33792
  buffer_load_dwordx4 v210, s[52:55], s1 offen lds
  v_cvt_pk_bf16_f32 v246, v108, v109
  v_cvt_pk_bf16_f32 v247, v110, v111
  v_mfma_f32_32x32x16_bf16 v[128:143], a[80:83], a[0:3], v[128:143]
  ds_read_b64_tr_b16 a[64:65], v196 offset:8192
  ds_read_b64_tr_b16 a[66:67], v196 offset:8704
  ds_read_b64_tr_b16 a[232:233], v214 offset:34816
  buffer_store_dwordx4 v[244:247], v200, s[44:47], s69 offen offset:1024 sc1
  buffer_load_dwordx4 v211, s[52:55], s1 offen offset:1024 lds
  v_mul_f32 v80, s72, v80
  v_mul_f32 v81, s72, v81
  v_mfma_f32_32x32x16_bf16 v[144:159], a[84:87], a[0:3], v[144:159]
  ds_read_b64_tr_b16 a[68:69], v197 offset:8192
  ds_read_b64_tr_b16 a[70:71], v197 offset:8704
  ds_read_b64_tr_b16 a[234:235], v214 offset:35840
  v_mul_f32 v82, s72, v82
  v_mul_f32 v83, s72, v83
  v_exp_f32 v80, v80
  v_mfma_f32_32x32x16_bf16 v[128:143], a[88:91], a[4:7], v[128:143]
  ds_read_b64_tr_b16 a[72:73], v196 offset:10240
  ds_read_b64_tr_b16 a[74:75], v196 offset:10752
  ds_read_b64_tr_b16 a[236:237], v215 offset:34816
  v_exp_f32 v81, v81
  v_exp_f32 v82, v82
  v_mfma_f32_32x32x16_bf16 v[144:159], a[92:95], a[4:7], v[144:159]
  s_waitcnt lgkmcnt(10)
  ds_read_b64_tr_b16 a[76:77], v197 offset:10240
  ds_read_b64_tr_b16 a[78:79], v197 offset:10752
  ds_read_b64_tr_b16 a[238:239], v215 offset:35840
  v_exp_f32 v83, v83
  v_add_f32 v80, 1.0, v80
  v_add_f32 v81, 1.0, v81
  v_mfma_f32_32x32x16_bf16 v[128:143], a[96:99], a[8:11], v[128:143]
  s_add_u32 s1, s1, 63488
  ds_read_b64_tr_b16 a[80:81], v196 offset:12288
  ds_read_b64_tr_b16 a[82:83], v196 offset:12800
  buffer_load_dwordx4 v210, s[52:55], s1 offen offset:2048 lds
  v_add_f32 v82, 1.0, v82
  v_add_f32 v83, 1.0, v83
  v_rcp_f32 v80, v80
  v_mfma_f32_32x32x16_bf16 v[144:159], a[100:103], a[8:11], v[144:159]
  ds_read_b64_tr_b16 a[84:85], v197 offset:12288
  ds_read_b64_tr_b16 a[86:87], v197 offset:12800
  v_rcp_f32 v81, v81
  v_rcp_f32 v82, v82
  v_mfma_f32_32x32x16_bf16 v[128:143], a[104:107], a[12:15], v[128:143]
  ds_read_b64_tr_b16 a[88:89], v196 offset:14336
  ds_read_b64_tr_b16 a[90:91], v196 offset:14848
  buffer_load_dwordx4 v211, s[52:55], s1 offen offset:3072 lds
  v_rcp_f32 v83, v83
  v_mul_f32 v112, v80, v112
  v_mul_f32 v113, v81, v113
  v_mfma_f32_32x32x16_bf16 v[144:159], a[108:111], a[12:15], v[144:159]
  s_waitcnt lgkmcnt(7)
  ds_read_b64_tr_b16 a[92:93], v197 offset:14336
  ds_read_b64_tr_b16 a[94:95], v197 offset:14848
  v_mul_f32 v114, v82, v114
  v_mul_f32 v115, v83, v115
  v_cvt_pk_bf16_f32 v248, v112, v113
  v_cvt_pk_bf16_f32 v249, v114, v115
  v_mul_f32 v84, s72, v84
  v_mfma_f32_32x32x16_bf16 v[128:143], a[64:67], a[16:19], v[128:143]
  s_waitcnt vmcnt(10)
  s_barrier
  s_add_u32 m0, s65, 49152
  ds_read_b64_tr_b16 a[96:97], v192 offset:0
  ds_read_b64_tr_b16 a[98:99], v192 offset:512
  buffer_load_dwordx4 v205, s[28:31], s85 offen lds
  v_mul_f32 v85, s72, v85
  v_mul_f32 v86, s72, v86
  v_mul_f32 v87, s72, v87
  v_mfma_f32_32x32x16_bf16 v[144:159], a[68:71], a[16:19], v[144:159]
  ds_read_b64_tr_b16 a[100:101], v193 offset:0
  ds_read_b64_tr_b16 a[102:103], v193 offset:512
  v_exp_f32 v84, v84
  v_exp_f32 v85, v85
  v_mfma_f32_32x32x16_bf16 v[128:143], a[72:75], a[20:23], v[128:143]
  ds_read_b64_tr_b16 a[104:105], v192 offset:2048
  ds_read_b64_tr_b16 a[106:107], v192 offset:2560
  v_exp_f32 v86, v86
  v_exp_f32 v87, v87
  v_add_f32 v84, 1.0, v84
  v_mfma_f32_32x32x16_bf16 v[144:159], a[76:79], a[20:23], v[144:159]
  s_waitcnt lgkmcnt(6)
  ds_read_b64_tr_b16 a[108:109], v193 offset:2048
  ds_read_b64_tr_b16 a[110:111], v193 offset:2560
  buffer_load_dwordx4 v206, s[28:31], s85 offen offset:1024 lds
  v_add_f32 v85, 1.0, v85
  v_add_f32 v86, 1.0, v86
  v_add_f32 v87, 1.0, v87
  v_mfma_f32_32x32x16_bf16 v[128:143], a[80:83], a[24:27], v[128:143]
  ds_read_b64_tr_b16 a[64:65], v192 offset:4096
  ds_read_b64_tr_b16 a[66:67], v192 offset:4608
  ds_read_b64_tr_b16 a[240:241], v216 offset:16384
  v_rcp_f32 v84, v84
  v_rcp_f32 v85, v85
  v_mfma_f32_32x32x16_bf16 v[144:159], a[84:87], a[24:27], v[144:159]
  ds_read_b64_tr_b16 a[68:69], v193 offset:4096
  ds_read_b64_tr_b16 a[70:71], v193 offset:4608
  ds_read_b64_tr_b16 a[242:243], v216 offset:17408
  buffer_load_dwordx4 v205, s[32:35], s85 offen offset:2048 lds
  v_rcp_f32 v86, v86
  v_rcp_f32 v87, v87
  v_mfma_f32_32x32x16_bf16 v[128:143], a[88:91], a[28:31], v[128:143]
  ds_read_b64_tr_b16 a[72:73], v192 offset:6144
  ds_read_b64_tr_b16 a[74:75], v192 offset:6656
  ds_read_b64_tr_b16 a[244:245], v217 offset:16384
  v_mul_f32 v116, v84, v116
  v_mul_f32 v117, v85, v117
  v_mul_f32 v118, v86, v118
  v_mul_f32 v119, v87, v119
  v_mfma_f32_32x32x16_bf16 v[144:159], a[92:95], a[28:31], v[144:159]
  s_waitcnt lgkmcnt(9)
  ds_read_b64_tr_b16 a[76:77], v193 offset:6144
  ds_read_b64_tr_b16 a[78:79], v193 offset:6656
  ds_read_b64_tr_b16 a[246:247], v217 offset:17408
  buffer_load_dwordx4 v206, s[32:35], s85 offen offset:3072 lds
  v_cvt_pk_bf16_f32 v250, v116, v117
  v_cvt_pk_bf16_f32 v251, v118, v119
  v_mfma_f32_32x32x16_bf16 v[128:143], a[96:99], a[32:35], v[128:143]
  ds_read_b64_tr_b16 a[80:81], v192 offset:8192
  ds_read_b64_tr_b16 a[82:83], v192 offset:8704
  ds_read_b64_tr_b16 a[248:249], v216 offset:18432
  buffer_store_dwordx4 v[248:251], v200, s[44:47], s69 offen offset:2048 sc1
  v_mul_f32 v88, s72, v88
  v_mul_f32 v89, s72, v89
  v_mfma_f32_32x32x16_bf16 v[144:159], a[100:103], a[32:35], v[144:159]
  ds_read_b64_tr_b16 a[84:85], v193 offset:8192
  ds_read_b64_tr_b16 a[86:87], v193 offset:8704
  ds_read_b64_tr_b16 a[250:251], v216 offset:19456
  v_mul_f32 v90, s72, v90
  v_mul_f32 v91, s72, v91
  v_exp_f32 v88, v88
  v_mfma_f32_32x32x16_bf16 v[128:143], a[104:107], a[36:39], v[128:143]
  ds_read_b64_tr_b16 a[88:89], v192 offset:10240
  ds_read_b64_tr_b16 a[90:91], v192 offset:10752
  ds_read_b64_tr_b16 a[252:253], v217 offset:18432
  v_exp_f32 v89, v89
  v_exp_f32 v90, v90
  v_mfma_f32_32x32x16_bf16 v[144:159], a[108:111], a[36:39], v[144:159]
  s_waitcnt lgkmcnt(10)
  s_add_u32 m0, s65, 65536
  s_add_u32 s1, s15, 0
  s_and_b32 s1, s1, 524287
  s_add_u32 s1, s1, 1310720
  ds_read_b64_tr_b16 a[92:93], v193 offset:10240
  ds_read_b64_tr_b16 a[94:95], v193 offset:10752
  ds_read_b64_tr_b16 a[254:255], v217 offset:19456
  buffer_load_dwordx4 v210, s[52:55], s1 offen lds
  v_exp_f32 v91, v91
  v_add_f32 v88, 1.0, v88
  v_add_f32 v89, 1.0, v89
  v_mfma_f32_32x32x16_bf16 v[128:143], a[64:67], a[40:43], v[128:143]
  ds_read_b64_tr_b16 a[96:97], v192 offset:12288
  ds_read_b64_tr_b16 a[98:99], v192 offset:12800
  buffer_load_dwordx4 v211, s[52:55], s1 offen offset:1024 lds
  v_add_f32 v90, 1.0, v90
  v_add_f32 v91, 1.0, v91
  v_rcp_f32 v88, v88
  v_mfma_f32_32x32x16_bf16 v[144:159], a[68:71], a[40:43], v[144:159]
  ds_read_b64_tr_b16 a[100:101], v193 offset:12288
  ds_read_b64_tr_b16 a[102:103], v193 offset:12800
  v_rcp_f32 v89, v89
  v_rcp_f32 v90, v90
  v_mfma_f32_32x32x16_bf16 v[128:143], a[72:75], a[44:47], v[128:143]
  s_add_u32 s1, s1, 63488
  ds_read_b64_tr_b16 a[104:105], v192 offset:14336
  ds_read_b64_tr_b16 a[106:107], v192 offset:14848
  buffer_load_dwordx4 v210, s[52:55], s1 offen offset:2048 lds
  v_rcp_f32 v91, v91
  v_mul_f32 v120, v88, v120
  v_mul_f32 v121, v89, v121
  v_mfma_f32_32x32x16_bf16 v[144:159], a[76:79], a[44:47], v[144:159]
  s_waitcnt lgkmcnt(7)
  ds_read_b64_tr_b16 a[108:109], v193 offset:14336
  ds_read_b64_tr_b16 a[110:111], v193 offset:14848
  v_mul_f32 v122, v90, v122
  v_mul_f32 v123, v91, v123
  v_cvt_pk_bf16_f32 v240, v120, v121
  v_cvt_pk_bf16_f32 v241, v122, v123
  v_mul_f32 v92, s72, v92
  v_mfma_f32_32x32x16_bf16 v[128:143], a[80:83], a[48:51], v[128:143]
  s_waitcnt vmcnt(13)
  s_barrier
  s_add_u32 m0, s65, 131072
  ds_read_b64_tr_b16 a[64:65], v192 offset:16384
  ds_read_b64_tr_b16 a[66:67], v192 offset:16896
  buffer_load_dwordx4 v205, s[28:31], s86 offen lds
  v_mul_f32 v93, s72, v93
  v_mul_f32 v94, s72, v94
  v_mul_f32 v95, s72, v95
  v_mfma_f32_32x32x16_bf16 v[144:159], a[84:87], a[48:51], v[144:159]
  ds_read_b64_tr_b16 a[68:69], v193 offset:16384
  ds_read_b64_tr_b16 a[70:71], v193 offset:16896
  v_exp_f32 v92, v92
  v_exp_f32 v93, v93
  v_mfma_f32_32x32x16_bf16 v[128:143], a[88:91], a[52:55], v[128:143]
  ds_read_b64_tr_b16 a[72:73], v192 offset:18432
  ds_read_b64_tr_b16 a[74:75], v192 offset:18944
  buffer_load_dwordx4 v206, s[28:31], s86 offen offset:1024 lds
  v_exp_f32 v94, v94
  v_exp_f32 v95, v95
  v_mfma_f32_32x32x16_bf16 v[144:159], a[92:95], a[52:55], v[144:159]
  s_waitcnt lgkmcnt(6)
  ds_read_b64_tr_b16 a[76:77], v193 offset:18432
  ds_read_b64_tr_b16 a[78:79], v193 offset:18944
  v_add_f32 v92, 1.0, v92
  v_add_f32 v93, 1.0, v93
  v_add_f32 v94, 1.0, v94
  v_add_f32 v95, 1.0, v95
  v_mfma_f32_32x32x16_bf16 v[128:143], a[96:99], a[56:59], v[128:143]
  ds_read_b64_tr_b16 a[80:81], v192 offset:20480
  ds_read_b64_tr_b16 a[82:83], v192 offset:20992
  buffer_load_dwordx4 v205, s[32:35], s86 offen offset:2048 lds
  v_rcp_f32 v92, v92
  v_rcp_f32 v93, v93
  v_mfma_f32_32x32x16_bf16 v[144:159], a[100:103], a[56:59], v[144:159]
  ds_read_b64_tr_b16 a[84:85], v193 offset:20480
  ds_read_b64_tr_b16 a[86:87], v193 offset:20992
  v_rcp_f32 v94, v94
  v_rcp_f32 v95, v95
  v_mul_f32 v124, v92, v124
  v_mfma_f32_32x32x16_bf16 v[128:143], a[104:107], a[60:63], v[128:143]
  ds_read_b64_tr_b16 a[88:89], v192 offset:22528
  ds_read_b64_tr_b16 a[90:91], v192 offset:23040
  buffer_load_dwordx4 v206, s[32:35], s86 offen offset:3072 lds
  v_mul_f32 v125, v93, v125
  v_mul_f32 v126, v94, v126
  v_mul_f32 v127, v95, v127
  v_cvt_pk_bf16_f32 v242, v124, v125
  v_mfma_f32_32x32x16_bf16 v[144:159], a[108:111], a[60:63], v[144:159]
  s_waitcnt lgkmcnt(6)
  ds_read_b64_tr_b16 a[92:93], v193 offset:22528
  ds_read_b64_tr_b16 a[94:95], v193 offset:23040
  v_cvt_pk_bf16_f32 v243, v126, v127
  buffer_store_dwordx4 v[240:243], v200, s[44:47], s69 offen offset:3072 sc1
  v_mfma_f32_32x32x16_bf16 v[64:79], a[64:67], v[0:3], 0
  ds_read_b64_tr_b16 a[96:97], v192 offset:24576
  ds_read_b64_tr_b16 a[98:99], v192 offset:25088
  v_mfma_f32_32x32x16_bf16 v[80:95], a[68:71], v[0:3], 0
  s_add_u32 m0, s65, 65536
  ds_read_b64_tr_b16 a[100:101], v193 offset:24576
  ds_read_b64_tr_b16 a[102:103], v193 offset:25088
  buffer_load_dwordx4 v211, s[52:55], s1 offen offset:3072 lds
  v_mfma_f32_32x32x16_bf16 v[96:111], a[72:75], v[0:3], 0
  ds_read_b64_tr_b16 a[104:105], v192 offset:26624
  ds_read_b64_tr_b16 a[106:107], v192 offset:27136
  v_mul_f32 v234, s73, v128
  v_mul_f32 v235, s73, v129
  v_mul_f32 v236, s73, v130
  v_mul_f32 v237, s73, v131
  v_max_f32 v128, s75, v128
  v_mfma_f32_32x32x16_bf16 v[112:127], a[76:79], v[0:3], 0
  s_waitcnt lgkmcnt(6)
  s_add_u32 m0, s65, 81920
  s_add_u32 s1, s15, 131072
  s_and_b32 s1, s1, 524287
  s_add_u32 s1, s1, 1310720
  ds_read_b64_tr_b16 a[108:109], v193 offset:26624
  ds_read_b64_tr_b16 a[110:111], v193 offset:27136
  buffer_load_dwordx4 v210, s[52:55], s1 offen lds
  v_max_f32 v129, s75, v129
  v_max_f32 v130, s75, v130
  v_max_f32 v131, s75, v131
  v_mfma_f32_32x32x16_bf16 v[64:79], a[80:83], v[4:7], v[64:79]
  ds_read_b64_tr_b16 a[64:65], v192 offset:28672
  ds_read_b64_tr_b16 a[66:67], v192 offset:29184
  v_exp_f32_e64 v234, v234 clamp
  v_exp_f32_e64 v235, v235 clamp
  v_mfma_f32_32x32x16_bf16 v[80:95], a[84:87], v[4:7], v[80:95]
  ds_read_b64_tr_b16 a[68:69], v193 offset:28672
  ds_read_b64_tr_b16 a[70:71], v193 offset:29184
  buffer_load_dwordx4 v211, s[52:55], s1 offen offset:1024 lds
  v_exp_f32_e64 v236, v236 clamp
  v_exp_f32_e64 v237, v237 clamp
  v_mfma_f32_32x32x16_bf16 v[96:111], a[88:91], v[4:7], v[96:111]
  ds_read_b64_tr_b16 a[72:73], v192 offset:30720
  ds_read_b64_tr_b16 a[74:75], v192 offset:31232
  v_add_f32 v128, v234, v128
  v_add_f32 v129, v235, v129
  v_add_f32 v130, v236, v130
  v_add_f32 v131, v237, v131
  v_mul_f32 v234, s73, v132
  v_mfma_f32_32x32x16_bf16 v[112:127], a[92:95], v[4:7], v[112:127]
  s_waitcnt lgkmcnt(6)
  s_add_u32 s1, s1, 63488
  ds_read_b64_tr_b16 a[76:77], v193 offset:30720
  ds_read_b64_tr_b16 a[78:79], v193 offset:31232
  buffer_load_dwordx4 v210, s[52:55], s1 offen offset:2048 lds
  v_mul_f32 v235, s73, v133
  v_mul_f32 v236, s73, v134
  v_mul_f32 v237, s73, v135
  v_max_f32 v132, s75, v132
  v_mfma_f32_32x32x16_bf16 v[64:79], a[96:99], v[8:11], v[64:79]
  s_waitcnt vmcnt(13)
  s_barrier
  s_getpc_b64 s[12:13]
k_B_pc2:
  s_and_b32 s66, s20, 7
  s_lshl_b32 s66, s66, 2
  s_add_u32 s66, s66, s64
  s_lshl_b32 s66, s66, 9
  s_add_u32 s66, s66, 2048
  v_lshrrev_b32 v208, 1, v200
  v_add_u32 v208, s66, v208
  v_min_u32 v208, k_end-k_B_pc2-8, v208
  global_load_dword v208, v208, s[12:13]
  ds_read_b64_tr_b16 a[80:81], v192 offset:49152
  ds_read_b64_tr_b16 a[82:83], v192 offset:49664
  v_max_f32 v133, s75, v133
  v_max_f32 v134, s75, v134
  v_max_f32 v135, s75, v135
  v_mfma_f32_32x32x16_bf16 v[80:95], a[100:103], v[8:11], v[80:95]
  s_add_u32 m0, s65, 0
  ds_read_b64_tr_b16 a[84:85], v193 offset:49152
  ds_read_b64_tr_b16 a[86:87], v193 offset:49664
  buffer_load_dwordx4 v205, s[28:31], s87 offen lds
  v_exp_f32_e64 v234, v234 clamp
  v_exp_f32_e64 v235, v235 clamp
  v_mfma_f32_32x32x16_bf16 v[96:111], a[104:107], v[8:11], v[96:111]
  ds_read_b64_tr_b16 a[88:89], v192 offset:51200
  ds_read_b64_tr_b16 a[90:91], v192 offset:51712
  v_exp_f32_e64 v236, v236 clamp
  v_exp_f32_e64 v237, v237 clamp
  v_add_f32 v132, v234, v132
  v_mfma_f32_32x32x16_bf16 v[112:127], a[108:111], v[8:11], v[112:127]
  s_waitcnt lgkmcnt(6)
  ds_read_b64_tr_b16 a[92:93], v193 offset:51200
  ds_read_b64_tr_b16 a[94:95], v193 offset:51712
  buffer_load_dwordx4 v206, s[28:31], s87 offen offset:1024 lds
  v_add_f32 v133, v235, v133
  v_add_f32 v134, v236, v134
  v_add_f32 v135, v237, v135
  v_mul_f32 v234, s73, v136
  v_mfma_f32_32x32x16_bf16 v[64:79], a[64:67], v[12:15], v[64:79]
  ds_read_b64_tr_b16 a[96:97], v192 offset:53248
  ds_read_b64_tr_b16 a[98:99], v192 offset:53760
  v_mul_f32 v235, s73, v137
  v_mul_f32 v236, s73, v138
  v_mul_f32 v237, s73, v139
  v_max_f32 v136, s75, v136
  v_max_f32 v137, s75, v137
  v_mfma_f32_32x32x16_bf16 v[80:95], a[68:71], v[12:15], v[80:95]
  ds_read_b64_tr_b16 a[100:101], v193 offset:53248
  ds_read_b64_tr_b16 a[102:103], v193 offset:53760
  buffer_load_dwordx4 v205, s[32:35], s87 offen offset:2048 lds
  v_max_f32 v138, s75, v138
  v_max_f32 v139, s75, v139
  v_mfma_f32_32x32x16_bf16 v[96:111], a[72:75], v[12:15], v[96:111]
  ds_read_b64_tr_b16 a[104:105], v192 offset:55296
  ds_read_b64_tr_b16 a[106:107], v192 offset:55808
  v_exp_f32_e64 v234, v234 clamp
  v_exp_f32_e64 v235, v235 clamp
  v_mfma_f32_32x32x16_bf16 v[112:127], a[76:79], v[12:15], v[112:127]
  s_waitcnt lgkmcnt(6)
  ds_read_b64_tr_b16 a[108:109], v193 offset:55296
  ds_read_b64_tr_b16 a[110:111], v193 offset:55808
  buffer_load_dwordx4 v206, s[32:35], s87 offen offset:3072 lds
  v_exp_f32_e64 v236, v236 clamp
  v_mfma_f32_32x32x16_bf16 v[64:79], a[80:83], v[16:19], v[64:79]
  ds_read_b64_tr_b16 a[64:65], v192 offset:57344
  ds_read_b64_tr_b16 a[66:67], v192 offset:57856
  v_exp_f32_e64 v237, v237 clamp
  v_add_f32 v136, v234, v136
  v_add_f32 v137, v235, v137
  v_add_f32 v138, v236, v138
  v_mfma_f32_32x32x16_bf16 v[80:95], a[84:87], v[16:19], v[80:95]
  s_add_u32 m0, s65, 114688
  ds_read_b64_tr_b16 a[68:69], v193 offset:57344
  ds_read_b64_tr_b16 a[70:71], v193 offset:57856
  buffer_load_dwordx4 v205, s[28:31], s88 offen lds
  v_add_f32 v139, v237, v139
  v_mul_f32 v234, s73, v140
  v_mul_f32 v235, s73, v141
  v_mfma_f32_32x32x16_bf16 v[96:111], a[88:91], v[16:19], v[96:111]
  ds_read_b64_tr_b16 a[72:73], v192 offset:59392
  ds_read_b64_tr_b16 a[74:75], v192 offset:59904
  v_mul_f32 v236, s73, v142
  v_mul_f32 v237, s73, v143
  v_max_f32 v140, s75, v140
  v_max_f32 v141, s75, v141
  v_max_f32 v142, s75, v142
  v_mfma_f32_32x32x16_bf16 v[112:127], a[92:95], v[16:19], v[112:127]
  s_waitcnt lgkmcnt(6)
  ds_read_b64_tr_b16 a[76:77], v193 offset:59392
  ds_read_b64_tr_b16 a[78:79], v193 offset:59904
  buffer_load_dwordx4 v206, s[28:31], s88 offen offset:1024 lds
  v_max_f32 v143, s75, v143
  v_exp_f32_e64 v234, v234 clamp
  v_mfma_f32_32x32x16_bf16 v[64:79], a[96:99], v[20:23], v[64:79]
  ds_read_b64_tr_b16 a[80:81], v192 offset:61440
  ds_read_b64_tr_b16 a[82:83], v192 offset:61952
  v_exp_f32_e64 v235, v235 clamp
  v_exp_f32_e64 v236, v236 clamp
  v_mfma_f32_32x32x16_bf16 v[80:95], a[100:103], v[20:23], v[80:95]
  ds_read_b64_tr_b16 a[84:85], v193 offset:61440
  ds_read_b64_tr_b16 a[86:87], v193 offset:61952
  buffer_load_dwordx4 v205, s[32:35], s88 offen offset:2048 lds
  v_exp_f32_e64 v237, v237 clamp
  v_add_f32 v140, v234, v140
  v_mfma_f32_32x32x16_bf16 v[96:111], a[104:107], v[20:23], v[96:111]
  ds_read_b64_tr_b16 a[88:89], v192 offset:63488
  ds_read_b64_tr_b16 a[90:91], v192 offset:64000
  v_add_f32 v141, v235, v141
  v_add_f32 v142, v236, v142
  v_add_f32 v143, v237, v143
  v_cvt_pk_bf16_f32 v218, v128, v129
  v_cvt_pk_bf16_f32 v219, v130, v131
  v_mfma_f32_32x32x16_bf16 v[112:127], a[108:111], v[20:23], v[112:127]
  s_waitcnt lgkmcnt(6)
  ds_read_b64_tr_b16 a[92:93], v193 offset:63488
  ds_read_b64_tr_b16 a[94:95], v193 offset:64000
  buffer_load_dwordx4 v206, s[32:35], s88 offen offset:3072 lds
  v_cvt_pk_bf16_f32 v220, v132, v133
  v_cvt_pk_bf16_f32 v221, v134, v135
  v_cvt_pk_bf16_f32 v222, v136, v137
  v_mfma_f32_32x32x16_bf16 v[64:79], a[64:67], v[24:27], v[64:79]
  s_waitcnt vmcnt(14)
  s_barrier
  s_mul_i32 s12, s23, 147456
  ds_read_b64_tr_b16 a[96:97], v196 offset:0
  ds_read_b64_tr_b16 a[98:99], v196 offset:512
  v_cvt_pk_bf16_f32 v223, v138, v139
  v_cvt_pk_bf16_f32 v224, v140, v141
  v_cvt_pk_bf16_f32 v225, v142, v143
  v_mfma_f32_32x32x16_bf16 v[80:95], a[68:71], v[24:27], v[80:95]
  s_lshl_b32 s13, s64, 10
  ds_read_b64_tr_b16 a[100:101], v197 offset:0
  ds_read_b64_tr_b16 a[102:103], v197 offset:512
  v_mul_f32 v234, s73, v144
  v_mul_f32 v235, s73, v145
  v_mul_f32 v236, s73, v146
  v_mul_f32 v237, s73, v147
  v_mfma_f32_32x32x16_bf16 v[96:111], a[72:75], v[24:27], v[96:111]
  s_add_u32 m0, s65, 16384
  s_add_u32 s12, s12, s13
  ds_read_b64_tr_b16 a[104:105], v196 offset:2048
  ds_read_b64_tr_b16 a[106:107], v196 offset:2560
  buffer_load_dwordx4 v205, s[28:31], s89 offen lds
  v_max_f32 v144, s75, v144
  v_max_f32 v145, s75, v145
  v_max_f32 v146, s75, v146
  v_mfma_f32_32x32x16_bf16 v[112:127], a[76:79], v[24:27], v[112:127]
  s_waitcnt lgkmcnt(6)
  ds_read_b64_tr_b16 a[108:109], v197 offset:2048
  ds_read_b64_tr_b16 a[110:111], v197 offset:2560
  v_add_u32 v201, s12, v200
  v_max_f32 v147, s75, v147
  v_exp_f32_e64 v234, v234 clamp
  v_mfma_f32_32x32x16_bf16 v[64:79], a[80:83], v[28:31], v[64:79]
  s_xor_b32 s12, s23, 1
  ds_read_b64_tr_b16 a[64:65], v196 offset:4096
  ds_read_b64_tr_b16 a[66:67], v196 offset:4608
  buffer_load_dwordx4 v206, s[28:31], s89 offen offset:1024 lds
  v_exp_f32_e64 v235, v235 clamp
  v_mfma_f32_32x32x16_bf16 v[80:95], a[84:87], v[28:31], v[80:95]
  s_mul_i32 s12, s12, 147456
  ds_read_b64_tr_b16 a[68:69], v197 offset:4096
  ds_read_b64_tr_b16 a[70:71], v197 offset:4608
  v_exp_f32_e64 v236, v236 clamp
  v_exp_f32_e64 v237, v237 clamp
  v_mfma_f32_32x32x16_bf16 v[96:111], a[88:91], v[28:31], v[96:111]
  s_add_u32 s12, s12, s13
  ds_read_b64_tr_b16 a[72:73], v196 offset:6144
  ds_read_b64_tr_b16 a[74:75], v196 offset:6656
  buffer_load_dwordx4 v205, s[32:35], s89 offen offset:2048 lds
  v_add_f32 v144, v234, v144
  v_add_f32 v145, v235, v145
  v_add_f32 v146, v236, v146
  v_mfma_f32_32x32x16_bf16 v[112:127], a[92:95], v[28:31], v[112:127]
  s_waitcnt lgkmcnt(6)
  ds_read_b64_tr_b16 a[76:77], v197 offset:6144
  ds_read_b64_tr_b16 a[78:79], v197 offset:6656
  v_add_u32 v202, s12, v200
  v_add_f32 v147, v237, v147
  v_mul_f32 v234, s73, v148
  v_mul_f32 v235, s73, v149
  v_mul_f32 v236, s73, v150
  v_mfma_f32_32x32x16_bf16 v[64:79], a[96:99], v[32:35], v[64:79]
  s_waitcnt vmcnt(16)
  s_barrier
  s_add_u32 s14, s81, 65536
  v_mov_b32 v240, 1
  buffer_atomic_add v240, v209, s[44:47], s14 offen sc1
  s_lshr_b32 s12, s19, 2
  ds_read_b64_tr_b16 a[80:81], v196 offset:8192
  ds_read_b64_tr_b16 a[82:83], v196 offset:8704
  buffer_load_dwordx4 v206, s[32:35], s89 offen offset:3072 lds
  v_mul_f32 v237, s73, v151
  v_max_f32 v148, s75, v148
  v_max_f32 v149, s75, v149
  v_mfma_f32_32x32x16_bf16 v[80:95], a[100:103], v[32:35], v[80:95]
  s_and_b32 s13, s23, -2
  ds_read_b64_tr_b16 a[84:85], v197 offset:8192
  ds_read_b64_tr_b16 a[86:87], v197 offset:8704
  v_max_f32 v150, s75, v150
  v_max_f32 v151, s75, v151
  v_exp_f32_e64 v234, v234 clamp
  v_mfma_f32_32x32x16_bf16 v[96:111], a[104:107], v[32:35], v[96:111]
  s_add_u32 m0, s65, 81920
  s_add_u32 s12, s12, s13
  ds_read_b64_tr_b16 a[88:89], v196 offset:10240
  ds_read_b64_tr_b16 a[90:91], v196 offset:10752
  buffer_load_dwordx4 v211, s[52:55], s1 offen offset:3072 lds
  v_exp_f32_e64 v235, v235 clamp
  v_mfma_f32_32x32x16_bf16 v[112:127], a[108:111], v[32:35], v[112:127]
  s_waitcnt lgkmcnt(6)
  s_mul_i32 s2, s12, 147456
  ds_read_b64_tr_b16 a[92:93], v197 offset:10240
  ds_read_b64_tr_b16 a[94:95], v197 offset:10752
  v_exp_f32_e64 v236, v236 clamp
  v_exp_f32_e64 v237, v237 clamp
  v_mfma_f32_32x32x16_bf16 v[64:79], a[64:67], v[36:39], v[64:79]
  s_add_u32 m0, s65, 98304
  s_add_u32 s1, s15, 262144
  s_and_b32 s1, s1, 524287
  s_add_u32 s1, s1, 1310720
  s_and_b32 s12, s19, 3
  ds_read_b64_tr_b16 a[96:97], v196 offset:12288
  ds_read_b64_tr_b16 a[98:99], v196 offset:12800
  buffer_load_dwordx4 v210, s[52:55], s1 offen lds
  v_add_f32 v148, v234, v148
  v_add_f32 v149, v235, v149
  v_add_f32 v150, v236, v150
  v_mfma_f32_32x32x16_bf16 v[80:95], a[68:71], v[36:39], v[80:95]
  s_lshl_b32 s12, s12, 2
  ds_read_b64_tr_b16 a[100:101], v197 offset:12288
  ds_read_b64_tr_b16 a[102:103], v197 offset:12800
  buffer_load_dwordx4 v211, s[52:55], s1 offen offset:1024 lds
  v_add_f32 v151, v237, v151
  v_mul_f32 v234, s73, v152
  v_mul_f32 v235, s73, v153
  v_mfma_f32_32x32x16_bf16 v[96:111], a[72:75], v[36:39], v[96:111]
  s_add_u32 s18, s12, s64
  ds_read_b64_tr_b16 a[104:105], v196 offset:14336
  ds_read_b64_tr_b16 a[106:107], v196 offset:14848
  v_mul_f32 v236, s73, v154
  v_mul_f32 v237, s73, v155
  v_max_f32 v152, s75, v152
  v_max_f32 v153, s75, v153
  v_mfma_f32_32x32x16_bf16 v[112:127], a[76:79], v[36:39], v[112:127]
  s_waitcnt lgkmcnt(6)
  s_add_u32 s1, s1, 63488
  ds_read_b64_tr_b16 a[108:109], v197 offset:14336
  ds_read_b64_tr_b16 a[110:111], v197 offset:14848
  buffer_load_dwordx4 v210, s[52:55], s1 offen offset:2048 lds
  v_and_b32 v203, 0xf0, v200
  v_max_f32 v154, s75, v154
  v_max_f32 v155, s75, v155
  v_mfma_f32_32x32x16_bf16 v[64:79], a[80:83], v[40:43], v[64:79]
  s_waitcnt vmcnt(13)
  v_lshlrev_b32 v203, 3, v203
  v_and_b32 v204, 0x380, v203
  s_barrier
  s_add_u32 s68, s80, 0
  buffer_load_dword v207, v209, s[44:47], s68 offen sc1
  ds_read_b64_tr_b16 a[64:65], v192 offset:0
  ds_read_b64_tr_b16 a[66:67], v192 offset:512
  v_exp_f32_e64 v234, v234 clamp
  v_mfma_f32_32x32x16_bf16 v[80:95], a[84:87], v[40:43], v[80:95]
  s_add_u32 m0, s65, 49152
  ds_read_b64_tr_b16 a[68:69], v193 offset:0
  ds_read_b64_tr_b16 a[70:71], v193 offset:512
  buffer_load_dwordx4 v205, s[28:31], s90 offen lds
  v_exp_f32_e64 v235, v235 clamp
  v_mfma_f32_32x32x16_bf16 v[96:111], a[88:91], v[40:43], v[96:111]
  ds_read_b64_tr_b16 a[72:73], v192 offset:2048
  ds_read_b64_tr_b16 a[74:75], v192 offset:2560
  v_exp_f32_e64 v236, v236 clamp
  v_exp_f32_e64 v237, v237 clamp
  v_add_f32 v152, v234, v152
  v_mfma_f32_32x32x16_bf16 v[112:127], a[92:95], v[40:43], v[112:127]
  s_waitcnt lgkmcnt(6)
  ds_read_b64_tr_b16 a[76:77], v193 offset:2048
  ds_read_b64_tr_b16 a[78:79], v193 offset:2560
  v_add_f32 v153, v235, v153
  v_add_f32 v154, v236, v154
  v_add_f32 v155, v237, v155
  v_mul_f32 v234, s73, v156
  v_mul_f32 v235, s73, v157
  v_mfma_f32_32x32x16_bf16 v[64:79], a[96:99], v[44:47], v[64:79]
  ds_read_b64_tr_b16 a[80:81], v192 offset:4096
  ds_read_b64_tr_b16 a[82:83], v192 offset:4608
  buffer_load_dwordx4 v206, s[28:31], s90 offen offset:1024 lds
  v_mul_f32 v236, s73, v158
  v_mul_f32 v237, s73, v159
  v_max_f32 v156, s75, v156
  v_mfma_f32_32x32x16_bf16 v[80:95], a[100:103], v[44:47], v[80:95]
  ds_read_b64_tr_b16 a[84:85], v193 offset:4096
  ds_read_b64_tr_b16 a[86:87], v193 offset:4608
  v_max_f32 v157, s75, v157
  v_max_f32 v158, s75, v158
  v_max_f32 v159, s75, v159
  v_exp_f32_e64 v234, v234 clamp
  v_mfma_f32_32x32x16_bf16 v[96:111], a[104:107], v[44:47], v[96:111]
  ds_read_b64_tr_b16 a[88:89], v192 offset:6144
  ds_read_b64_tr_b16 a[90:91], v192 offset:6656
  buffer_load_dwordx4 v205, s[32:35], s90 offen offset:2048 lds
  v_exp_f32_e64 v235, v235 clamp
  v_mfma_f32_32x32x16_bf16 v[112:127], a[108:111], v[44:47], v[112:127]
  s_waitcnt lgkmcnt(6)
  ds_read_b64_tr_b16 a[92:93], v193 offset:6144
  ds_read_b64_tr_b16 a[94:95], v193 offset:6656
  v_exp_f32_e64 v236, v236 clamp
  v_exp_f32_e64 v237, v237 clamp
  v_add_f32 v156, v234, v156
  v_mfma_f32_32x32x16_bf16 v[64:79], a[64:67], v[48:51], v[64:79]
  ds_read_b64_tr_b16 a[96:97], v192 offset:8192
  ds_read_b64_tr_b16 a[98:99], v192 offset:8704
  buffer_load_dwordx4 v206, s[32:35], s90 offen offset:3072 lds
  v_add_f32 v157, v235, v157
  v_add_f32 v158, v236, v158
  v_add_f32 v159, v237, v159
  v_mfma_f32_32x32x16_bf16 v[80:95], a[68:71], v[48:51], v[80:95]
  ds_read_b64_tr_b16 a[100:101], v193 offset:8192
  ds_read_b64_tr_b16 a[102:103], v193 offset:8704
  v_cvt_pk_bf16_f32 v226, v144, v145
  v_cvt_pk_bf16_f32 v227, v146, v147
  v_cvt_pk_bf16_f32 v228, v148, v149
  v_cvt_pk_bf16_f32 v229, v150, v151
  v_cvt_pk_bf16_f32 v230, v152, v153
  v_mfma_f32_32x32x16_bf16 v[96:111], a[72:75], v[48:51], v[96:111]
  s_add_u32 m0, s65, 98304
  ds_read_b64_tr_b16 a[104:105], v192 offset:10240
  ds_read_b64_tr_b16 a[106:107], v192 offset:10752
  buffer_load_dwordx4 v211, s[52:55], s1 offen offset:3072 lds
  v_cvt_pk_bf16_f32 v231, v154, v155
  v_cvt_pk_bf16_f32 v232, v156, v157
  v_mfma_f32_32x32x16_bf16 v[112:127], a[76:79], v[48:51], v[112:127]
  s_waitcnt lgkmcnt(6)
  ds_read_b64_tr_b16 a[108:109], v193 offset:10240
  ds_read_b64_tr_b16 a[110:111], v193 offset:10752
  v_cvt_pk_bf16_f32 v233, v158, v159
  v_and_b32 v238, 0xf0, v200
  v_lshlrev_b32 v238, 2, v238
  v_and_b32 v239, 0x100, v200
  v_lshrrev_b32 v239, 3, v239
  v_mfma_f32_32x32x16_bf16 v[64:79], a[80:83], v[52:55], v[64:79]
  s_add_u32 m0, s65, 147456
  s_add_u32 s1, s15, 393216
  s_and_b32 s1, s1, 524287
  s_add_u32 s1, s1, 1310720
  ds_read_b64_tr_b16 a[64:65], v192 offset:12288
  ds_read_b64_tr_b16 a[66:67], v192 offset:12800
  buffer_load_dwordx4 v210, s[52:55], s1 offen lds
  v_lshrrev_b32 v240, 9, v200
  v_mfma_f32_32x32x16_bf16 v[80:95], a[84:87], v[52:55], v[80:95]
  ds_read_b64_tr_b16 a[68:69], v193 offset:12288
  ds_read_b64_tr_b16 a[70:71], v193 offset:12800
  v_lshlrev_b32 v240, 4, v240
  v_add3_u32 v254, v238, v239, v240
  v_lshrrev_b32 v254, 1, v254
  v_lshrrev_b32 v234, 1, v200
  v_mfma_f32_32x32x16_bf16 v[96:111], a[88:91], v[52:55], v[96:111]
  ds_read_b64_tr_b16 a[72:73], v192 offset:14336
  ds_read_b64_tr_b16 a[74:75], v192 offset:14848
  buffer_load_dwordx4 v211, s[52:55], s1 offen offset:1024 lds
  v_mfma_f32_32x32x16_bf16 v[112:127], a[92:95], v[52:55], v[112:127]
  s_waitcnt lgkmcnt(6)
  ds_read_b64_tr_b16 a[76:77], v193 offset:14336
  ds_read_b64_tr_b16 a[78:79], v193 offset:14848
  v_mfma_f32_32x32x16_bf16 v[64:79], a[96:99], v[56:59], v[64:79]
  s_waitcnt vmcnt(17)
  s_barrier
  s_add_u32 s68, s82, 65536
  buffer_load_dword v208, v209, s[44:47], s68 offen sc1
  s_add_u32 m0, s65, 131072
  ds_read_b64_tr_b16 a[80:81], v194 offset:49152
  ds_read_b64_tr_b16 a[82:83], v194 offset:49664
  buffer_load_dwordx4 v205, s[28:31], s91 offen lds
  v_mfma_f32_32x32x16_bf16 v[80:95], a[100:103], v[56:59], v[80:95]
  ds_read_b64_tr_b16 a[84:85], v195 offset:49152
  ds_read_b64_tr_b16 a[86:87], v195 offset:49664
  v_mfma_f32_32x32x16_bf16 v[96:111], a[104:107], v[56:59], v[96:111]
  ds_read_b64_tr_b16 a[88:89], v194 offset:51200
  ds_read_b64_tr_b16 a[90:91], v194 offset:51712
  v_mfma_f32_32x32x16_bf16 v[112:127], a[108:111], v[56:59], v[112:127]
  s_waitcnt lgkmcnt(6)
  ds_read_b64_tr_b16 a[92:93], v195 offset:51200
  ds_read_b64_tr_b16 a[94:95], v195 offset:51712
  buffer_load_dwordx4 v206, s[28:31], s91 offen offset:1024 lds
  v_mfma_f32_32x32x16_bf16 v[64:79], a[64:67], v[60:63], v[64:79]
  s_waitcnt vmcnt(10)
  v_readfirstlane_b32 s66, v207
  s_mul_i32 s67, s83, 16
  s_nop 0
  s_bfe_u32 s66, s66, 524288
  s_cmp_eq_u32 s66, s67
  s_cbranch_scc0 k_B_kv_spin
k_B_kv_ok:
  s_barrier
  ds_read_b64_tr_b16 a[96:97], v194 offset:53248
  ds_read_b64_tr_b16 a[98:99], v194 offset:53760
  v_mfma_f32_32x32x16_bf16 v[80:95], a[68:71], v[60:63], v[80:95]
  ds_read_b64_tr_b16 a[100:101], v195 offset:53248
  ds_read_b64_tr_b16 a[102:103], v195 offset:53760
  buffer_load_dwordx4 v205, s[32:35], s91 offen offset:2048 lds
  v_mfma_f32_32x32x16_bf16 v[96:111], a[72:75], v[60:63], v[96:111]
  ds_read_b64_tr_b16 a[104:105], v194 offset:55296
  ds_read_b64_tr_b16 a[106:107], v194 offset:55808
  v_mfma_f32_32x32x16_bf16 v[112:127], a[76:79], v[60:63], v[112:127]
  s_waitcnt lgkmcnt(6)
  ds_read_b64_tr_b16 a[108:109], v195 offset:55296
  ds_read_b64_tr_b16 a[110:111], v195 offset:55808
  v_mfma_f32_32x32x16_bf16 v[64:79], a[80:83], a[0:3], v[64:79]
  ds_read_b64_tr_b16 a[64:65], v194 offset:57344
  ds_read_b64_tr_b16 a[66:67], v194 offset:57856
  buffer_load_dwordx4 v206, s[32:35], s91 offen offset:3072 lds
  v_mfma_f32_32x32x16_bf16 v[80:95], a[84:87], a[0:3], v[80:95]
  ds_read_b64_tr_b16 a[68:69], v195 offset:57344
  ds_read_b64_tr_b16 a[70:71], v195 offset:57856
  v_mfma_f32_32x32x16_bf16 v[96:111], a[88:91], a[0:3], v[96:111]
  ds_read_b64_tr_b16 a[72:73], v194 offset:59392
  ds_read_b64_tr_b16 a[74:75], v194 offset:59904
  buffer_load_dwordx2 v[238:239], v254, s[44:47], s77 offen offset:0 sc1
  v_mfma_f32_32x32x16_bf16 v[112:127], a[92:95], a[0:3], v[112:127]
  s_waitcnt lgkmcnt(6)
  ds_read_b64_tr_b16 a[76:77], v195 offset:59392
  ds_read_b64_tr_b16 a[78:79], v195 offset:59904
  buffer_load_dwordx2 v[240:241], v254, s[44:47], s77 offen offset:512 sc1
  v_mfma_f32_32x32x16_bf16 v[64:79], a[96:99], a[4:7], v[64:79]
  ds_read_b64_tr_b16 a[80:81], v194 offset:61440
  ds_read_b64_tr_b16 a[82:83], v194 offset:61952
  buffer_load_dwordx2 v[242:243], v254, s[44:47], s77 offen offset:1024 sc1
  v_mfma_f32_32x32x16_bf16 v[80:95], a[100:103], a[4:7], v[80:95]
  ds_read_b64_tr_b16 a[84:85], v195 offset:61440
  ds_read_b64_tr_b16 a[86:87], v195 offset:61952
  buffer_load_dwordx2 v[244:245], v254, s[44:47], s77 offen offset:1536 sc1
  v_mfma_f32_32x32x16_bf16 v[96:111], a[104:107], a[4:7], v[96:111]
  s_add_u32 s68, s20, 0
  s_and_b32 s68, s68, 1
  s_lshl_b32 s68, s68, 12
  s_add_u32 s77, s68, s76
  ds_read_b64_tr_b16 a[88:89], v194 offset:63488
  ds_read_b64_tr_b16 a[90:91], v194 offset:64000
  buffer_load_dwordx2 v[130:131], v234, s[44:47], s77 offen offset:0 sc1
  v_mfma_f32_32x32x16_bf16 v[112:127], a[108:111], a[4:7], v[112:127]
  s_waitcnt lgkmcnt(6)
  ds_read_b64_tr_b16 a[92:93], v195 offset:63488
  ds_read_b64_tr_b16 a[94:95], v195 offset:64000
  buffer_load_dwordx2 v[134:135], v234, s[44:47], s77 offen offset:512 sc1
  v_mfma_f32_32x32x16_bf16 v[64:79], a[64:67], a[8:11], v[64:79]
  s_barrier
  ds_read_b64_tr_b16 a[96:97], v192 offset:16384
  ds_read_b64_tr_b16 a[98:99], v192 offset:16896
  buffer_load_dwordx2 v[138:139], v234, s[44:47], s77 offen offset:1024 sc1
  v_mfma_f32_32x32x16_bf16 v[80:95], a[68:71], a[8:11], v[80:95]
  ds_read_b64_tr_b16 a[100:101], v193 offset:16384
  ds_read_b64_tr_b16 a[102:103], v193 offset:16896
  buffer_load_dwordx2 v[142:143], v234, s[44:47], s77 offen offset:1536 sc1
  v_mfma_f32_32x32x16_bf16 v[96:111], a[72:75], a[8:11], v[96:111]
  ds_read_b64_tr_b16 a[104:105], v192 offset:18432
  ds_read_b64_tr_b16 a[106:107], v192 offset:18944
  buffer_load_dwordx2 v[146:147], v234, s[44:47], s77 offen offset:2048 sc1
  v_mfma_f32_32x32x16_bf16 v[112:127], a[76:79], a[8:11], v[112:127]
  s_waitcnt lgkmcnt(6)
  ds_read_b64_tr_b16 a[108:109], v193 offset:18432
  ds_read_b64_tr_b16 a[110:111], v193 offset:18944
  buffer_load_dwordx2 v[150:151], v234, s[44:47], s77 offen offset:2560 sc1
  v_mfma_f32_32x32x16_bf16 v[64:79], a[80:83], a[12:15], v[64:79]
  ds_read_b64_tr_b16 a[64:65], v192 offset:20480
  ds_read_b64_tr_b16 a[66:67], v192 offset:20992
  buffer_load_dwordx2 v[154:155], v234, s[44:47], s77 offen offset:3072 sc1
  v_mfma_f32_32x32x16_bf16 v[80:95], a[84:87], a[12:15], v[80:95]
  ds_read_b64_tr_b16 a[68:69], v193 offset:20480
  ds_read_b64_tr_b16 a[70:71], v193 offset:20992
  buffer_load_dwordx2 v[158:159], v234, s[44:47], s77 offen offset:3584 sc1
  v_mfma_f32_32x32x16_bf16 v[96:111], a[88:91], a[12:15], v[96:111]
  s_add_u32 s68, s20, 1
  s_and_b32 s68, s68, 1
  s_lshl_b32 s68, s68, 12
  s_add_u32 s77, s68, s76
  ds_read_b64_tr_b16 a[72:73], v192 offset:22528
  ds_read_b64_tr_b16 a[74:75], v192 offset:23040
  buffer_load_dwordx2 v[162:163], v234, s[44:47], s77 offen offset:0 sc1
  v_mfma_f32_32x32x16_bf16 v[112:127], a[92:95], a[12:15], v[112:127]
  s_waitcnt lgkmcnt(6)
  ds_read_b64_tr_b16 a[76:77], v193 offset:22528
  ds_read_b64_tr_b16 a[78:79], v193 offset:23040
  buffer_load_dwordx2 v[166:167], v234, s[44:47], s77 offen offset:512 sc1
  v_mfma_f32_32x32x16_bf16 v[64:79], a[96:99], a[16:19], v[64:79]
  s_waitcnt vmcnt(18)
  v_readfirstlane_b32 s66, v208
  s_mul_i32 s67, s83, 8
  s_nop 0
  s_bfe_u32 s66, s66, 524288
  s_cmp_eq_u32 s66, s67
  s_cbranch_scc0 k_B_c0_spin
k_B_c0_ok:
  s_barrier
  ds_read_b64_tr_b16 a[80:81], v192 offset:24576
  ds_read_b64_tr_b16 a[82:83], v192 offset:25088
  buffer_load_dwordx2 v[170:171], v234, s[44:47], s77 offen offset:1024 sc1
  v_mfma_f32_32x32x16_bf16 v[80:95], a[100:103], a[16:19], v[80:95]
  ds_read_b64_tr_b16 a[84:85], v193 offset:24576
  ds_read_b64_tr_b16 a[86:87], v193 offset:25088
  buffer_load_dwordx2 v[174:175], v234, s[44:47], s77 offen offset:1536 sc1
  v_mfma_f32_32x32x16_bf16 v[96:111], a[104:107], a[16:19], v[96:111]
  ds_read_b64_tr_b16 a[88:89], v192 offset:26624
  ds_read_b64_tr_b16 a[90:91], v192 offset:27136
  buffer_load_dwordx2 v[178:179], v234, s[44:47], s77 offen offset:2048 sc1
  v_mfma_f32_32x32x16_bf16 v[112:127], a[108:111], a[16:19], v[112:127]
  s_waitcnt lgkmcnt(6)
  ds_read_b64_tr_b16 a[92:93], v193 offset:26624
  ds_read_b64_tr_b16 a[94:95], v193 offset:27136
  buffer_load_dwordx2 v[182:183], v234, s[44:47], s77 offen offset:2560 sc1
  v_mfma_f32_32x32x16_bf16 v[64:79], a[64:67], a[20:23], v[64:79]
  ds_read_b64_tr_b16 a[96:97], v192 offset:28672
  ds_read_b64_tr_b16 a[98:99], v192 offset:29184
  buffer_load_dwordx2 v[186:187], v234, s[44:47], s77 offen offset:3072 sc1
  v_mfma_f32_32x32x16_bf16 v[80:95], a[68:71], a[20:23], v[80:95]
  ds_read_b64_tr_b16 a[100:101], v193 offset:28672
  ds_read_b64_tr_b16 a[102:103], v193 offset:29184
  buffer_load_dwordx2 v[190:191], v234, s[44:47], s77 offen offset:3584 sc1
  v_mfma_f32_32x32x16_bf16 v[96:111], a[72:75], a[20:23], v[96:111]
  s_lshr_b32 s3, s15, 4
  s_and_b32 s3, s3, 32767
  ds_read_b64_tr_b16 a[104:105], v192 offset:30720
  ds_read_b64_tr_b16 a[106:107], v192 offset:31232
  buffer_load_dwordx4 v[0:3], v201, s[44:47], s3 offen sc1
  v_mfma_f32_32x32x16_bf16 v[112:127], a[76:79], a[20:23], v[112:127]
  s_waitcnt lgkmcnt(6)
  ds_read_b64_tr_b16 a[108:109], v193 offset:30720
  ds_read_b64_tr_b16 a[110:111], v193 offset:31232
  buffer_load_dwordx4 v[4:7], v202, s[44:47], s3 offen sc1
  v_mfma_f32_32x32x16_bf16 v[64:79], a[80:83], a[24:27], v[64:79]
  s_barrier
  ds_read_b64_tr_b16 a[64:65], v192 offset:49152
  ds_read_b64_tr_b16 a[66:67], v192 offset:49664
  v_mfma_f32_32x32x16_bf16 v[80:95], a[84:87], a[24:27], v[80:95]
  s_add_u32 s3, s3, 4096
  s_and_b32 s3, s3, 32767
  ds_read_b64_tr_b16 a[68:69], v193 offset:49152
  ds_read_b64_tr_b16 a[70:71], v193 offset:49664
  buffer_load_dwordx4 v[8:11], v201, s[44:47], s3 offen sc1
  v_mfma_f32_32x32x16_bf16 v[96:111], a[88:91], a[24:27], v[96:111]
  s_waitcnt vmcnt(19)
  ds_read_b64_tr_b16 a[72:73], v192 offset:51200
  ds_read_b64_tr_b16 a[74:75], v192 offset:51712
  s_lshl_b32 s12, s64, 10
  s_add_u32 s12, s12, 16384
  v_add_u32 v254, s12, v200
  v_lshlrev_b32 v250, 16, v244
  v_and_b32 v251, s74, v244
  v_mfma_f32_32x32x16_bf16 v[112:127], a[92:95], a[24:27], v[112:127]
  s_waitcnt lgkmcnt(6)
  ds_read_b64_tr_b16 a[76:77], v193 offset:51200
  ds_read_b64_tr_b16 a[78:79], v193 offset:51712
  v_lshlrev_b32 v252, 16, v245
  v_and_b32 v253, s74, v245
  v_lshlrev_b32 v246, 16, v242
  v_and_b32 v247, s74, v242
  v_lshlrev_b32 v248, 16, v243
  v_mfma_f32_32x32x16_bf16 v[64:79], a[96:99], a[28:31], v[64:79]
  ds_read_b64_tr_b16 a[80:81], v192 offset:53248
  ds_read_b64_tr_b16 a[82:83], v192 offset:53760
  buffer_load_dwordx4 v[12:15], v202, s[44:47], s3 offen sc1
  v_and_b32 v249, s74, v243
  v_lshlrev_b32 v242, 16, v240
  v_and_b32 v243, s74, v240
  v_lshlrev_b32 v244, 16, v241
  v_and_b32 v245, s74, v241
  v_mfma_f32_32x32x16_bf16 v[80:95], a[100:103], a[28:31], v[80:95]
  ds_read_b64_tr_b16 a[84:85], v193 offset:53248
  ds_read_b64_tr_b16 a[86:87], v193 offset:53760
  v_and_b32 v241, s74, v239
  v_lshlrev_b32 v240, 16, v239
  v_and_b32 v239, s74, v238
  v_lshlrev_b32 v238, 16, v238
  v_add_f32 v238, v238, v242
  v_mfma_f32_32x32x16_bf16 v[96:111], a[104:107], a[28:31], v[96:111]
  s_add_u32 s3, s3, 4096
  s_and_b32 s3, s3, 32767
  ds_read_b64_tr_b16 a[88:89], v192 offset:55296
  ds_read_b64_tr_b16 a[90:91], v192 offset:55808
  buffer_load_dwordx4 v[16:19], v201, s[44:47], s3 offen sc1
  v_add_f32 v239, v239, v243
  v_add_f32 v240, v240, v244
  v_add_f32 v241, v241, v245
  v_add_f32 v246, v246, v250
  v_add_f32 v247, v247, v251
  v_mfma_f32_32x32x16_bf16 v[112:127], a[108:111], a[28:31], v[112:127]
  s_waitcnt lgkmcnt(6)
  ds_read_b64_tr_b16 a[92:93], v193 offset:55296
  ds_read_b64_tr_b16 a[94:95], v193 offset:55808
  buffer_load_dwordx4 v[20:23], v202, s[44:47], s3 offen sc1
  v_add_f32 v248, v248, v252
  v_add_f32 v249, v249, v253
  v_add_f32 v238, v238, v246
  v_add_f32 v239, v239, v247
  v_add_f32 v240, v240, v248
  v_mfma_f32_32x32x16_bf16 v[64:79], a[64:67], a[32:35], v[64:79]
  ds_read_b64_tr_b16 a[96:97], v192 offset:57344
  ds_read_b64_tr_b16 a[98:99], v192 offset:57856
  v_add_f32 v241, v241, v249
  v_add_f32_dpp v238, v238, v238 row_ror:8 row_mask:0xf bank_mask:0xf
  v_add_f32_dpp v239, v239, v239 row_ror:8 row_mask:0xf bank_mask:0xf
  v_add_f32_dpp v240, v240, v240 row_ror:8 row_mask:0xf bank_mask:0xf
  v_add_f32_dpp v241, v241, v241 row_ror:8 row_mask:0xf bank_mask:0xf
  v_mfma_f32_32x32x16_bf16 v[80:95], a[68:71], a[32:35], v[80:95]
  s_add_u32 s3, s3, 4096
  s_and_b32 s3, s3, 32767
  ds_read_b64_tr_b16 a[100:101], v193 offset:57344
  ds_read_b64_tr_b16 a[102:103], v193 offset:57856
  buffer_load_dwordx4 v[24:27], v201, s[44:47], s3 offen sc1
  v_add_f32_dpp v238, v238, v238 row_ror:4 row_mask:0xf bank_mask:0xf
  v_add_f32_dpp v239, v239, v239 row_ror:4 row_mask:0xf bank_mask:0xf
  v_add_f32_dpp v240, v240, v240 row_ror:4 row_mask:0xf bank_mask:0xf
  v_add_f32_dpp v241, v241, v241 row_ror:4 row_mask:0xf bank_mask:0xf
  v_add_f32_dpp v238, v238, v238 row_ror:2 row_mask:0xf bank_mask:0xf
  v_mfma_f32_32x32x16_bf16 v[96:111], a[72:75], a[32:35], v[96:111]
  ds_read_b64_tr_b16 a[104:105], v192 offset:59392
  ds_read_b64_tr_b16 a[106:107], v192 offset:59904
  v_add_f32_dpp v239, v239, v239 row_ror:2 row_mask:0xf bank_mask:0xf
  v_add_f32_dpp v240, v240, v240 row_ror:2 row_mask:0xf bank_mask:0xf
  v_add_f32_dpp v241, v241, v241 row_ror:2 row_mask:0xf bank_mask:0xf
  v_add_f32_dpp v238, v238, v238 row_ror:1 row_mask:0xf bank_mask:0xf
  v_add_f32_dpp v239, v239, v239 row_ror:1 row_mask:0xf bank_mask:0xf
  v_mfma_f32_32x32x16_bf16 v[112:127], a[76:79], a[32:35], v[112:127]
  s_waitcnt vmcnt(22) lgkmcnt(6)
  ds_read_b64_tr_b16 a[108:109], v193 offset:59392
  ds_read_b64_tr_b16 a[110:111], v193 offset:59904
  buffer_load_dwordx4 v[28:31], v202, s[44:47], s3 offen sc1
  v_add_f32_dpp v240, v240, v240 row_ror:1 row_mask:0xf bank_mask:0xf
  v_add_f32_dpp v241, v241, v241 row_ror:1 row_mask:0xf bank_mask:0xf
  v_lshlrev_b32 v128, 16, v130
  v_and_b32 v129, s74, v130
  v_lshlrev_b32 v130, 16, v131
  v_mfma_f32_32x32x16_bf16 v[64:79], a[80:83], a[36:39], v[64:79]
  s_waitcnt vmcnt(22)
  ds_read_b64_tr_b16 a[64:65], v192 offset:61440
  ds_read_b64_tr_b16 a[66:67], v192 offset:61952
  v_and_b32 v131, s74, v131
  v_lshlrev_b32 v132, 16, v134
  v_and_b32 v133, s74, v134
  v_lshlrev_b32 v134, 16, v135
  v_and_b32 v135, s74, v135
  v_mfma_f32_32x32x16_bf16 v[80:95], a[84:87], a[36:39], v[80:95]
  s_waitcnt vmcnt(21)
  s_add_u32 s3, s3, 4096
  s_and_b32 s3, s3, 32767
  ds_read_b64_tr_b16 a[68:69], v193 offset:61440
  ds_read_b64_tr_b16 a[70:71], v193 offset:61952
  buffer_load_dwordx4 v[32:35], v201, s[44:47], s3 offen sc1
  v_add_f32 v128, v128, v132
  v_add_f32 v129, v129, v133
  v_add_f32 v130, v130, v134
  v_add_f32 v131, v131, v135
  v_lshlrev_b32 v136, 16, v138
  v_mfma_f32_32x32x16_bf16 v[96:111], a[88:91], a[36:39], v[96:111]
  s_waitcnt vmcnt(21)
  ds_read_b64_tr_b16 a[72:73], v192 offset:63488
  ds_read_b64_tr_b16 a[74:75], v192 offset:64000
  buffer_load_dwordx4 v[36:39], v202, s[44:47], s3 offen sc1
  v_and_b32 v137, s74, v138
  v_lshlrev_b32 v138, 16, v139
  v_and_b32 v139, s74, v139
  v_lshlrev_b32 v140, 16, v142
  v_and_b32 v141, s74, v142
  v_mfma_f32_32x32x16_bf16 v[112:127], a[92:95], a[36:39], v[112:127]
  s_waitcnt lgkmcnt(6)
  ds_read_b64_tr_b16 a[76:77], v193 offset:63488
  ds_read_b64_tr_b16 a[78:79], v193 offset:64000
  v_lshlrev_b32 v142, 16, v143
  v_and_b32 v143, s74, v143
  v_add_f32 v136, v136, v140
  v_add_f32 v137, v137, v141
  v_add_f32 v138, v138, v142
  v_mfma_f32_32x32x16_bf16 v[64:79], a[96:99], a[40:43], v[64:79]
  s_barrier
  s_add_u32 s3, s3, 4096
  s_and_b32 s3, s3, 32767
  ds_read_b64_tr_b16 a[80:81], v196 offset:0
  ds_read_b64_tr_b16 a[82:83], v196 offset:512
  buffer_load_dwordx4 v[40:43], v201, s[44:47], s3 offen sc1
  v_add_f32 v139, v139, v143
  s_waitcnt vmcnt(22)
  v_lshlrev_b32 v144, 16, v146
  v_and_b32 v145, s74, v146
  v_lshlrev_b32 v146, 16, v147
  v_and_b32 v147, s74, v147
  v_mfma_f32_32x32x16_bf16 v[80:95], a[100:103], a[40:43], v[80:95]
  s_waitcnt vmcnt(21)
  ds_read_b64_tr_b16 a[84:85], v197 offset:0
  ds_read_b64_tr_b16 a[86:87], v197 offset:512
  v_lshlrev_b32 v148, 16, v150
  v_and_b32 v149, s74, v150
  v_lshlrev_b32 v150, 16, v151
  v_and_b32 v151, s74, v151
  v_add_f32 v144, v144, v148
  v_mfma_f32_32x32x16_bf16 v[96:111], a[104:107], a[40:43], v[96:111]
  s_waitcnt vmcnt(20)
  ds_read_b64_tr_b16 a[88:89], v196 offset:2048
  ds_read_b64_tr_b16 a[90:91], v196 offset:2560
  buffer_load_dwordx4 v[44:47], v202, s[44:47], s3 offen sc1
  v_add_f32 v145, v145, v149
  v_add_f32 v146, v146, v150
  v_add_f32 v147, v147, v151
  v_lshlrev_b32 v152, 16, v154
  v_and_b32 v153, s74, v154
  v_mfma_f32_32x32x16_bf16 v[112:127], a[108:111], a[40:43], v[112:127]
  s_waitcnt vmcnt(20) lgkmcnt(6)
  ds_read_b64_tr_b16 a[92:93], v197 offset:2048
  ds_read_b64_tr_b16 a[94:95], v197 offset:2560
  v_lshlrev_b32 v154, 16, v155
  v_and_b32 v155, s74, v155
  v_lshlrev_b32 v156, 16, v158
  v_and_b32 v157, s74, v158
  v_lshlrev_b32 v158, 16, v159
  v_mfma_f32_32x32x16_bf16 v[64:79], a[64:67], a[44:47], v[64:79]
  s_add_u32 s3, s3, 4096
  s_and_b32 s3, s3, 32767
  ds_read_b64_tr_b16 a[96:97], v196 offset:4096
  ds_read_b64_tr_b16 a[98:99], v196 offset:4608
  buffer_load_dwordx4 v[48:51], v201, s[44:47], s3 offen sc1
  v_and_b32 v159, s74, v159
  v_add_f32 v152, v152, v156
  v_add_f32 v153, v153, v157
  v_add_f32 v154, v154, v158
  v_add_f32 v155, v155, v159
  v_mfma_f32_32x32x16_bf16 v[80:95], a[68:71], a[44:47], v[80:95]
  s_waitcnt vmcnt(19)
  ds_read_b64_tr_b16 a[100:101], v197 offset:4096
  ds_read_b64_tr_b16 a[102:103], v197 offset:4608
  buffer_load_dwordx4 v[52:55], v202, s[44:47], s3 offen sc1
  v_lshlrev_b32 v160, 16, v162
  v_and_b32 v161, s74, v162
  v_lshlrev_b32 v162, 16, v163
  v_and_b32 v163, s74, v163
  v_lshlrev_b32 v164, 16, v166
  v_mfma_f32_32x32x16_bf16 v[96:111], a[72:75], a[44:47], v[96:111]
  ds_read_b64_tr_b16 a[104:105], v196 offset:6144
  ds_read_b64_tr_b16 a[106:107], v196 offset:6656
  v_and_b32 v165, s74, v166
  v_lshlrev_b32 v166, 16, v167
  v_and_b32 v167, s74, v167
  v_add_f32 v160, v160, v164
  v_add_f32 v161, v161, v165
  v_mfma_f32_32x32x16_bf16 v[112:127], a[76:79], a[44:47], v[112:127]
  s_waitcnt vmcnt(19) lgkmcnt(6)
  s_add_u32 s3, s3, 4096
  s_and_b32 s3, s3, 32767
  ds_read_b64_tr_b16 a[108:109], v197 offset:6144
  ds_read_b64_tr_b16 a[110:111], v197 offset:6656
  buffer_load_dwordx4 v[56:59], v201, s[44:47], s3 offen sc1
  v_add_f32 v162, v162, v166
  v_add_f32 v163, v163, v167
  v_lshlrev_b32 v168, 16, v170
  v_and_b32 v169, s74, v170
  v_lshlrev_b32 v170, 16, v171
  v_mfma_f32_32x32x16_bf16 v[64:79], a[80:83], a[48:51], v[64:79]
  s_waitcnt vmcnt(19)
  ds_read_b64_tr_b16 a[64:65], v196 offset:8192
  ds_read_b64_tr_b16 a[66:67], v196 offset:8704
  v_and_b32 v171, s74, v171
  v_lshlrev_b32 v172, 16, v174
  v_and_b32 v173, s74, v174
  v_lshlrev_b32 v174, 16, v175
  v_and_b32 v175, s74, v175
  v_mfma_f32_32x32x16_bf16 v[80:95], a[84:87], a[48:51], v[80:95]
  ds_read_b64_tr_b16 a[68:69], v197 offset:8192
  ds_read_b64_tr_b16 a[70:71], v197 offset:8704
  buffer_load_dwordx4 v[60:63], v202, s[44:47], s3 offen sc1
  v_add_f32 v168, v168, v172
  v_add_f32 v169, v169, v173
  v_add_f32 v170, v170, v174
  v_add_f32 v171, v171, v175
  v_mfma_f32_32x32x16_bf16 v[96:111], a[88:91], a[48:51], v[96:111]
  s_waitcnt vmcnt(18)
  ds_read_b64_tr_b16 a[72:73], v196 offset:10240
  ds_read_b64_tr_b16 a[74:75], v196 offset:10752
  v_lshlrev_b32 v176, 16, v178
  v_and_b32 v177, s74, v178
  v_lshlrev_b32 v178, 16, v179
  v_and_b32 v179, s74, v179
  v_lshlrev_b32 v180, 16, v182
  v_mfma_f32_32x32x16_bf16 v[112:127], a[92:95], a[48:51], v[112:127]
  s_waitcnt lgkmcnt(6)
  s_add_u32 m0, s65, 147456
  s_add_u32 s1, s1, 63488
  ds_read_b64_tr_b16 a[76:77], v197 offset:10240
  ds_read_b64_tr_b16 a[78:79], v197 offset:10752
  buffer_load_dwordx4 v210, s[52:55], s1 offen offset:2048 lds
  v_and_b32 v181, s74, v182
  v_lshlrev_b32 v182, 16, v183
  v_and_b32 v183, s74, v183
  v_add_f32 v176, v176, v180
  v_mfma_f32_32x32x16_bf16 v[64:79], a[96:99], a[52:55], v[64:79]
  s_waitcnt vmcnt(18)
  ds_read_b64_tr_b16 a[80:81], v196 offset:12288
  ds_read_b64_tr_b16 a[82:83], v196 offset:12800
  v_add_f32 v177, v177, v181
  v_add_f32 v178, v178, v182
  v_add_f32 v179, v179, v183
  v_lshlrev_b32 v184, 16, v186
  v_and_b32 v185, s74, v186
  v_mfma_f32_32x32x16_bf16 v[80:95], a[100:103], a[52:55], v[80:95]
  s_waitcnt vmcnt(17)
  ds_read_b64_tr_b16 a[84:85], v197 offset:12288
  ds_read_b64_tr_b16 a[86:87], v197 offset:12800
  buffer_load_dwordx4 v211, s[52:55], s1 offen offset:3072 lds
  v_lshlrev_b32 v186, 16, v187
  v_and_b32 v187, s74, v187
  v_lshlrev_b32 v188, 16, v190
  v_and_b32 v189, s74, v190
  v_mfma_f32_32x32x16_bf16 v[96:111], a[104:107], a[52:55], v[96:111]
  ds_read_b64_tr_b16 a[88:89], v196 offset:14336
  ds_read_b64_tr_b16 a[90:91], v196 offset:14848
  v_lshlrev_b32 v190, 16, v191
  v_and_b32 v191, s74, v191
  v_add_f32 v184, v184, v188
  v_add_f32 v185, v185, v189
  v_add_f32 v186, v186, v190
  v_mfma_f32_32x32x16_bf16 v[112:127], a[108:111], a[52:55], v[112:127]
  s_waitcnt lgkmcnt(6)
  s_add_u32 m0, s65, 0
  s_add_u32 s1, s15, 0
  s_and_b32 s1, s1, 524287
  ds_read_b64_tr_b16 a[92:93], v197 offset:14336
  ds_read_b64_tr_b16 a[94:95], v197 offset:14848
  buffer_load_dwordx4 v210, s[56:59], s1 offen lds
  v_add_f32 v187, v187, v191
  v_add_f32 v128, v128, v160
  v_add_f32 v129, v129, v161
  v_add_f32 v130, v130, v162
  v_mfma_f32_32x32x16_bf16 v[64:79], a[64:67], a[56:59], v[64:79]
  buffer_load_dwordx4 v211, s[56:59], s1 offen offset:1024 lds
  v_add_f32 v131, v131, v163
  v_add_f32 v136, v136, v168
  v_add_f32 v137, v137, v169
  v_add_f32 v138, v138, v170
  v_mfma_f32_32x32x16_bf16 v[80:95], a[68:71], a[56:59], v[80:95]
  v_add_f32 v139, v139, v171
  v_add_f32 v144, v144, v176
  v_add_f32 v145, v145, v177
  v_add_f32 v146, v146, v178
  v_add_f32 v147, v147, v179
  v_mfma_f32_32x32x16_bf16 v[96:111], a[72:75], a[56:59], v[96:111]
  v_add_f32 v152, v152, v184
  v_add_f32 v153, v153, v185
  v_add_f32 v154, v154, v186
  v_add_f32 v155, v155, v187
  v_add_f32 v128, v128, v144
  v_mfma_f32_32x32x16_bf16 v[112:127], a[76:79], a[56:59], v[112:127]
  s_waitcnt lgkmcnt(0)
  s_add_u32 s1, s1, 63488
  buffer_load_dwordx4 v210, s[56:59], s1 offen offset:2048 lds
  v_add_f32 v129, v129, v145
  v_add_f32 v130, v130, v146
  v_add_f32 v131, v131, v147
  v_mfma_f32_32x32x16_bf16 v[64:79], a[80:83], a[60:63], v[64:79]
  v_add_f32 v136, v136, v152
  v_add_f32 v137, v137, v153
  v_add_f32 v138, v138, v154
  v_add_f32 v139, v139, v155
  v_add_f32 v128, v128, v136
  v_mfma_f32_32x32x16_bf16 v[80:95], a[84:87], a[60:63], v[80:95]
  buffer_load_dwordx4 v211, s[56:59], s1 offen offset:3072 lds
  v_add_f32 v129, v129, v137
  v_add_f32 v130, v130, v138
  v_add_f32 v131, v131, v139
  v_mfma_f32_32x32x16_bf16 v[96:111], a[88:91], a[60:63], v[96:111]
  v_cvt_pk_bf16_f32 v236, v238, v239
  v_cvt_pk_bf16_f32 v237, v240, v241
  v_cvt_pk_bf16_f32 v234, v128, v129
  v_cvt_pk_bf16_f32 v235, v130, v131
  v_mfma_f32_32x32x16_bf16 v[112:127], a[92:95], a[60:63], v[112:127]
  v_mul_f32 v64, s72, v64
  v_mul_f32 v65, s72, v65
  v_mul_f32 v66, s72, v66
  v_mul_f32 v67, s72, v67
  v_permlane16_swap_b32 v234, v236
  v_permlane16_swap_b32 v235, v237
  ds_write_b128 v254, v[234:237]
  v_exp_f32 v64, v64
  v_exp_f32 v65, v65
  v_exp_f32 v66, v66
  v_exp_f32 v67, v67
  v_add_f32 v64, 1.0, v64
  v_add_f32 v65, 1.0, v65
  v_add_f32 v66, 1.0, v66
  v_add_f32 v67, 1.0, v67
  v_rcp_f32 v64, v64
  v_rcp_f32 v65, v65
  v_rcp_f32 v66, v66
  v_rcp_f32 v67, v67
  s_waitcnt lgkmcnt(0)
  s_barrier
  v_add_u32 v234, 16384, v200
  ds_read_b128 v[238:241], v234 offset:0
  ds_read_b128 v[242:245], v234 offset:1024
  ds_read_b128 v[246:249], v234 offset:2048
  ds_read_b128 v[250:253], v234 offset:3072
  v_mul_f32 v96, v64, v96
  v_mul_f32 v97, v65, v97
  v_mul_f32 v98, v66, v98
  v_mul_f32 v99, v67, v99
  v_cvt_pk_bf16_f32 v192, v96, v97
  v_cvt_pk_bf16_f32 v193, v98, v99
  v_mul_f32 v68, s72, v68
  v_mul_f32 v69, s72, v69
  v_mul_f32 v70, s72, v70
  v_mul_f32 v71, s72, v71
  v_exp_f32 v68, v68
  v_exp_f32 v69, v69
  v_exp_f32 v70, v70
  v_exp_f32 v71, v71
  v_add_f32 v68, 1.0, v68
  v_add_f32 v69, 1.0, v69
  s_waitcnt lgkmcnt(3)
  v_mfma_f32_32x32x16_bf16 v[128:143], v[238:241], v[218:221], 0
  s_waitcnt lgkmcnt(2)
  v_add_f32 v70, 1.0, v70
  v_add_f32 v71, 1.0, v71
  v_rcp_f32 v68, v68
  v_rcp_f32 v69, v69
  v_mfma_f32_32x32x16_bf16 v[144:159], v[242:245], v[222:225], 0
  s_waitcnt lgkmcnt(1)
  v_rcp_f32 v70, v70
  v_rcp_f32 v71, v71
  v_mul_f32 v100, v68, v100
  v_mul_f32 v101, v69, v101
  v_mfma_f32_32x32x16_bf16 v[160:175], v[246:249], v[226:229], 0
  s_waitcnt lgkmcnt(0)
  v_mul_f32 v102, v70, v102
  v_mul_f32 v103, v71, v103
  v_cvt_pk_bf16_f32 v194, v100, v101
  v_cvt_pk_bf16_f32 v195, v102, v103
  v_mfma_f32_32x32x16_bf16 v[176:191], v[250:253], v[230:233], 0
  buffer_store_dwordx4 v[192:195], v200, s[44:47], s71 offen offset:0 sc1
  v_mul_f32 v72, s72, v72
  v_mul_f32 v73, s72, v73
  v_mul_f32 v74, s72, v74
  v_add_f32 v136, s75, v136
  v_rcp_f32 v136, v136
  s_nop 0
  v_mul_f32 v128, v136, v128
  v_mul_f32 v129, v136, v129
  s_add_u32 m0, s65, 131072
  s_add_u32 s1, s15, 131072
  s_and_b32 s1, s1, 524287
  buffer_load_dwordx4 v210, s[56:59], s1 offen lds
  v_mul_f32 v130, v136, v130
  v_mul_f32 v131, v136, v131
  v_mul_f32 v132, v136, v132
  v_mul_f32 v133, v136, v133
  v_mul_f32 v134, v136, v134
  v_mul_f32 v135, v136, v135
  v_cvt_pk_bf16_f32 v218, v128, v129
  v_cvt_pk_bf16_f32 v219, v130, v131
  v_cvt_pk_bf16_f32 v220, v132, v133
  v_cvt_pk_bf16_f32 v221, v134, v135
  buffer_store_dwordx4 v[218:221], v200, s[44:47], s70 offen sc1
  v_add_f32 v152, s75, v152
  v_rcp_f32 v152, v152
  s_nop 0
  v_pk_mul_f32 v[144:145], v[144:145], v[152:153] op_sel_hi:[1,0]
  v_pk_mul_f32 v[146:147], v[146:147], v[152:153] op_sel_hi:[1,0]
  v_pk_mul_f32 v[148:149], v[148:149], v[152:153] op_sel_hi:[1,0]
  buffer_load_dwordx4 v211, s[56:59], s1 offen offset:1024 lds
  v_pk_mul_f32 v[150:151], v[150:151], v[152:153] op_sel_hi:[1,0]
  v_cvt_pk_bf16_f32 v222, v144, v145
  v_cvt_pk_bf16_f32 v223, v146, v147
  v_cvt_pk_bf16_f32 v224, v148, v149
  v_cvt_pk_bf16_f32 v225, v150, v151
  buffer_store_dwordx4 v[222:225], v200, s[44:47], s70 offen offset:1024 sc1
  v_add_f32 v168, s75, v168
  v_rcp_f32 v168, v168
  s_nop 0
  v_pk_mul_f32 v[160:161], v[160:161], v[168:169] op_sel_hi:[1,0]
  v_pk_mul_f32 v[162:163], v[162:163], v[168:169] op_sel_hi:[1,0]
  v_pk_mul_f32 v[164:165], v[164:165], v[168:169] op_sel_hi:[1,0]
  v_pk_mul_f32 v[166:167], v[166:167], v[168:169] op_sel_hi:[1,0]
  v_cvt_pk_bf16_f32 v226, v160, v161
  v_cvt_pk_bf16_f32 v227, v162, v163
  v_cvt_pk_bf16_f32 v228, v164, v165
  v_cvt_pk_bf16_f32 v229, v166, v167
  s_add_u32 s1, s1, 63488
  buffer_load_dwordx4 v210, s[56:59], s1 offen offset:2048 lds
  buffer_store_dwordx4 v[226:229], v200, s[44:47], s70 offen offset:2048 sc1
  v_add_f32 v184, s75, v184
  v_rcp_f32 v184, v184
  s_nop 0
  v_pk_mul_f32 v[176:177], v[176:177], v[184:185] op_sel_hi:[1,0]
  v_pk_mul_f32 v[178:179], v[178:179], v[184:185] op_sel_hi:[1,0]
  v_pk_mul_f32 v[180:181], v[180:181], v[184:185] op_sel_hi:[1,0]
  v_pk_mul_f32 v[182:183], v[182:183], v[184:185] op_sel_hi:[1,0]
  v_cvt_pk_bf16_f32 v230, v176, v177
  v_cvt_pk_bf16_f32 v231, v178, v179
  v_cvt_pk_bf16_f32 v232, v180, v181
  v_cvt_pk_bf16_f32 v233, v182, v183
  buffer_store_dwordx4 v[230:233], v200, s[44:47], s70 offen offset:3072 sc1
  v_mul_f32 v75, s72, v75
  v_exp_f32 v72, v72
  v_exp_f32 v73, v73
  v_exp_f32 v74, v74
  buffer_load_dwordx4 v211, s[56:59], s1 offen offset:3072 lds
  v_exp_f32 v75, v75
  v_add_f32 v72, 1.0, v72
  v_add_f32 v73, 1.0, v73
  v_add_f32 v74, 1.0, v74
  v_add_f32 v75, 1.0, v75
  v_rcp_f32 v72, v72
  v_rcp_f32 v73, v73
  v_rcp_f32 v74, v74
  v_rcp_f32 v75, v75
  v_mul_f32 v104, v72, v104
  v_mul_f32 v105, v73, v105
  v_mul_f32 v106, v74, v106
  s_add_u32 m0, s65, 49152
  s_add_u32 s1, s15, 262144
  s_and_b32 s1, s1, 524287
  buffer_load_dwordx4 v210, s[56:59], s1 offen lds
  v_mul_f32 v107, v75, v107
  v_cvt_pk_bf16_f32 v196, v104, v105
  v_cvt_pk_bf16_f32 v197, v106, v107
  v_pk_mul_f32 v[76:77], v[76:77], s[72:73] op_sel_hi:[1,0]
  v_pk_mul_f32 v[78:79], v[78:79], s[72:73] op_sel_hi:[1,0]
  v_exp_f32 v76, v76
  v_exp_f32 v77, v77
  v_exp_f32 v78, v78
  v_exp_f32 v79, v79
  v_pk_add_f32 v[76:77], v[76:77], 1.0 op_sel_hi:[1,0]
  v_pk_add_f32 v[78:79], v[78:79], 1.0 op_sel_hi:[1,0]
  v_rcp_f32 v76, v76
  buffer_load_dwordx4 v211, s[56:59], s1 offen offset:1024 lds
  v_rcp_f32 v77, v77
  v_rcp_f32 v78, v78
  v_rcp_f32 v79, v79
  v_pk_mul_f32 v[108:109], v[76:77], v[108:109]
  v_pk_mul_f32 v[110:111], v[78:79], v[110:111]
  v_cvt_pk_bf16_f32 v198, v108, v109
  v_cvt_pk_bf16_f32 v199, v110, v111
  buffer_store_dwordx4 v[196:199], v200, s[44:47], s71 offen offset:1024 sc1
  v_pk_mul_f32 v[80:81], v[80:81], s[72:73] op_sel_hi:[1,0]
  v_pk_mul_f32 v[82:83], v[82:83], s[72:73] op_sel_hi:[1,0]
  v_exp_f32 v80, v80
  v_exp_f32 v81, v81
  s_add_u32 s1, s1, 63488
  buffer_load_dwordx4 v210, s[56:59], s1 offen offset:2048 lds
  v_exp_f32 v82, v82
  v_exp_f32 v83, v83
  v_pk_add_f32 v[80:81], v[80:81], 1.0 op_sel_hi:[1,0]
  v_pk_add_f32 v[82:83], v[82:83], 1.0 op_sel_hi:[1,0]
  v_rcp_f32 v80, v80
  v_rcp_f32 v81, v81
  v_rcp_f32 v82, v82
  v_rcp_f32 v83, v83
  v_pk_mul_f32 v[112:113], v[80:81], v[112:113]
  v_pk_mul_f32 v[114:115], v[82:83], v[114:115]
  v_cvt_pk_bf16_f32 v192, v112, v113
  v_cvt_pk_bf16_f32 v193, v114, v115
  v_pk_mul_f32 v[84:85], v[84:85], s[72:73] op_sel_hi:[1,0]
  v_pk_mul_f32 v[86:87], v[86:87], s[72:73] op_sel_hi:[1,0]
  v_exp_f32 v84, v84
  v_exp_f32 v85, v85
  buffer_load_dwordx4 v211, s[56:59], s1 offen offset:3072 lds
  v_exp_f32 v86, v86
  v_exp_f32 v87, v87
  v_pk_add_f32 v[84:85], v[84:85], 1.0 op_sel_hi:[1,0]
  v_pk_add_f32 v[86:87], v[86:87], 1.0 op_sel_hi:[1,0]
  v_rcp_f32 v84, v84
  v_rcp_f32 v85, v85
  v_rcp_f32 v86, v86
  v_rcp_f32 v87, v87
  v_pk_mul_f32 v[116:117], v[84:85], v[116:117]
  v_pk_mul_f32 v[118:119], v[86:87], v[118:119]
  v_cvt_pk_bf16_f32 v194, v116, v117
  v_cvt_pk_bf16_f32 v195, v118, v119
  buffer_store_dwordx4 v[192:195], v200, s[44:47], s71 offen offset:2048 sc1
  v_pk_mul_f32 v[88:89], v[88:89], s[72:73] op_sel_hi:[1,0]
  v_pk_mul_f32 v[90:91], v[90:91], s[72:73] op_sel_hi:[1,0]
  v_exp_f32 v88, v88
  v_exp_f32 v89, v89
  v_exp_f32 v90, v90
  v_exp_f32 v91, v91
  v_pk_add_f32 v[88:89], v[88:89], 1.0 op_sel_hi:[1,0]
  v_pk_add_f32 v[90:91], v[90:91], 1.0 op_sel_hi:[1,0]
  v_rcp_f32 v88, v88
  v_rcp_f32 v89, v89
  v_rcp_f32 v90, v90
  v_rcp_f32 v91, v91
  v_pk_mul_f32 v[120:121], v[88:89], v[120:121]
  v_pk_mul_f32 v[122:123], v[90:91], v[122:123]
  v_cvt_pk_bf16_f32 v196, v120, v121
  v_cvt_pk_bf16_f32 v197, v122, v123
  v_pk_mul_f32 v[92:93], v[92:93], s[72:73] op_sel_hi:[1,0]
  v_pk_mul_f32 v[94:95], v[94:95], s[72:73] op_sel_hi:[1,0]
  v_exp_f32 v92, v92
  v_exp_f32 v93, v93
  v_exp_f32 v94, v94
  v_exp_f32 v95, v95
  v_pk_add_f32 v[92:93], v[92:93], 1.0 op_sel_hi:[1,0]
  v_pk_add_f32 v[94:95], v[94:95], 1.0 op_sel_hi:[1,0]
  v_rcp_f32 v92, v92
  v_rcp_f32 v93, v93
  v_rcp_f32 v94, v94
  v_rcp_f32 v95, v95
  v_pk_mul_f32 v[124:125], v[92:93], v[124:125]
  v_pk_mul_f32 v[126:127], v[94:95], v[126:127]
  v_cvt_pk_bf16_f32 v198, v124, v125
  v_cvt_pk_bf16_f32 v199, v126, v127
  buffer_store_dwordx4 v[196:199], v200, s[44:47], s71 offen offset:3072 sc1
  s_waitcnt vmcnt(36)
  v_mfma_f32_32x32x16_bf16 v[128:143], a[112:115], v[0:3], 0
  ds_read_b64_tr_b16 a[0:1], v212 offset:32768
  ds_read_b64_tr_b16 a[2:3], v212 offset:33792
  ds_read_b64_tr_b16 a[4:5], v213 offset:32768
  ds_read_b64_tr_b16 a[6:7], v213 offset:33792
  ds_read_b64_tr_b16 a[8:9], v212 offset:34816
  ds_read_b64_tr_b16 a[10:11], v212 offset:35840
  ds_read_b64_tr_b16 a[12:13], v213 offset:34816
  v_mfma_f32_32x32x16_bf16 v[144:159], a[112:115], v[4:7], 0
  ds_read_b64_tr_b16 a[14:15], v213 offset:35840
  ds_read_b64_tr_b16 a[16:17], v214 offset:0
  ds_read_b64_tr_b16 a[18:19], v214 offset:1024
  ds_read_b64_tr_b16 a[20:21], v215 offset:0
  ds_read_b64_tr_b16 a[22:23], v215 offset:1024
  ds_read_b64_tr_b16 a[24:25], v214 offset:2048
  ds_read_b64_tr_b16 a[26:27], v214 offset:3072
  v_mfma_f32_32x32x16_bf16 v[160:175], a[116:119], v[0:3], 0
  ds_read_b64_tr_b16 a[28:29], v215 offset:2048
  ds_read_b64_tr_b16 a[30:31], v215 offset:3072
  ds_read_b64_tr_b16 a[32:33], v214 offset:16384
  ds_read_b64_tr_b16 a[34:35], v214 offset:17408
  ds_read_b64_tr_b16 a[36:37], v215 offset:16384
  ds_read_b64_tr_b16 a[38:39], v215 offset:17408
  ds_read_b64_tr_b16 a[40:41], v214 offset:18432
  v_mfma_f32_32x32x16_bf16 v[176:191], a[116:119], v[4:7], 0
  s_waitcnt vmcnt(34)
  ds_read_b64_tr_b16 a[42:43], v214 offset:19456
  ds_read_b64_tr_b16 a[44:45], v215 offset:18432
  ds_read_b64_tr_b16 a[46:47], v215 offset:19456
  ds_read_b64_tr_b16 a[48:49], v214 offset:32768
  ds_read_b64_tr_b16 a[50:51], v214 offset:33792
  ds_read_b64_tr_b16 a[52:53], v215 offset:32768
  ds_read_b64_tr_b16 a[54:55], v215 offset:33792
  v_mfma_f32_32x32x16_bf16 v[128:143], a[120:123], v[8:11], v[128:143]
  s_waitcnt vmcnt(20)
  ds_read_b64_tr_b16 a[56:57], v214 offset:34816
  ds_read_b64_tr_b16 a[58:59], v214 offset:35840
  ds_read_b64_tr_b16 a[60:61], v215 offset:34816
  ds_read_b64_tr_b16 a[62:63], v215 offset:35840
  ds_read_b64_tr_b16 a[64:65], v216 offset:16384
  ds_read_b64_tr_b16 a[66:67], v216 offset:17408
  ds_read_b64_tr_b16 a[68:69], v217 offset:16384
  v_mfma_f32_32x32x16_bf16 v[144:159], a[120:123], v[12:15], v[144:159]
  ds_read_b64_tr_b16 a[70:71], v217 offset:17408
  ds_read_b64_tr_b16 a[72:73], v216 offset:18432
  ds_read_b64_tr_b16 a[74:75], v216 offset:19456
  ds_read_b64_tr_b16 a[76:77], v217 offset:18432
  ds_read_b64_tr_b16 a[78:79], v217 offset:19456
  v_subrev_u32 v218, s65, v212
  v_add_u32 v219, 65536, v218
  v_mfma_f32_32x32x16_bf16 v[160:175], a[124:127], v[8:11], v[160:175]
  v_add_u32 v220, 131072, v218
  v_mfma_f32_32x32x16_bf16 v[176:191], a[124:127], v[12:15], v[176:191]
  s_and_b32 s12, s64, 1
  s_lshl_b32 s12, s12, 12
  v_add_u32 v221, s12, v200
  v_add_u32 v222, 65536, v221
  v_add_u32 v223, 131072, v221
  v_mfma_f32_32x32x16_bf16 v[128:143], a[128:131], v[16:19], v[128:143]
  s_xor_b32 s12, s64, 1
  s_lshl_b32 s12, s12, 12
  s_add_u32 s12, s12, 0
  v_add_u32 v224, s12, v200
  v_mfma_f32_32x32x16_bf16 v[144:159], a[128:131], v[20:23], v[144:159]
  s_add_u32 s12, s65, 0
  v_add_u32 v227, s12, v200
  v_mfma_f32_32x32x16_bf16 v[160:175], a[132:135], v[16:19], v[160:175]
  s_xor_b32 s12, s64, 2
  s_lshl_b32 s12, s12, 12
  s_add_u32 s12, s12, 131072
  v_add_u32 v225, s12, v200
  v_mfma_f32_32x32x16_bf16 v[176:191], a[132:135], v[20:23], v[176:191]
  s_add_u32 s12, s65, 131072
  v_add_u32 v228, s12, v200
  v_mfma_f32_32x32x16_bf16 v[128:143], a[136:139], v[24:27], v[128:143]
  s_xor_b32 s12, s64, 3
  s_lshl_b32 s12, s12, 12
  s_add_u32 s12, s12, 49152
  v_add_u32 v226, s12, v200
  v_mfma_f32_32x32x16_bf16 v[144:159], a[136:139], v[28:31], v[144:159]
  s_add_u32 s12, s65, 49152
  v_add_u32 v229, s12, v200
  v_mfma_f32_32x32x16_bf16 v[160:175], a[140:143], v[24:27], v[160:175]
  s_lshl_b32 s12, s23, 15
  s_lshl_b32 s13, s19, 7
  s_add_u32 s12, s12, s13
  s_lshr_b32 s13, s64, 1
  s_lshl_b32 s14, s13, 6
  s_add_u32 s12, s12, s14
  v_and_b32 v231, 0xf0, v200
  v_mfma_f32_32x32x16_bf16 v[176:191], a[140:143], v[28:31], v[176:191]
  s_add_u32 s68, s82, 0
  buffer_load_dword v207, v209, s[44:47], s68 offen sc1
  v_lshlrev_b32 v231, 6, v231
  v_lshrrev_b32 v232, 4, v200
  v_and_b32 v232, 48, v232
  v_add3_u32 v231, v231, v232, s12
  v_mfma_f32_32x32x16_bf16 v[128:143], a[144:147], v[32:35], v[128:143]
  v_add_u32 v232, 16384, v231
  v_mfma_f32_32x32x16_bf16 v[144:159], a[144:147], v[36:39], v[144:159]
  s_mul_i32 s100, s23, 147456
  s_lshl_b32 s13, s13, 12
  s_add_u32 s100, s100, s13
  s_add_u32 s100, s100, 114688
  buffer_load_dwordx4 v[112:115], v231, s[24:27], 0 offen
  buffer_load_dwordx4 v[116:119], v232, s[24:27], 0 offen
  v_mfma_f32_32x32x16_bf16 v[160:175], a[148:151], v[32:35], v[160:175]
  v_mfma_f32_32x32x16_bf16 v[176:191], a[148:151], v[36:39], v[176:191]
  v_mfma_f32_32x32x16_bf16 v[128:143], a[152:155], v[40:43], v[128:143]
  v_mfma_f32_32x32x16_bf16 v[144:159], a[152:155], v[44:47], v[144:159]
  v_mfma_f32_32x32x16_bf16 v[160:175], a[156:159], v[40:43], v[160:175]
  v_mfma_f32_32x32x16_bf16 v[176:191], a[156:159], v[44:47], v[176:191]
  s_waitcnt vmcnt(3)
  s_barrier
  s_add_u32 s68, s81, 65536
  v_mov_b32 v233, 65536
  buffer_atomic_add v233, v209, s[44:47], s68 offen sc1
  s_add_u32 m0, s65, 16384
  s_add_u32 s1, s15, 393216
  s_and_b32 s1, s1, 524287
  buffer_load_dwordx4 v210, s[56:59], s1 offen lds
  v_mfma_f32_32x32x16_bf16 v[128:143], a[160:163], v[48:51], v[128:143]
  buffer_load_dwordx4 v211, s[56:59], s1 offen offset:1024 lds
  v_mfma_f32_32x32x16_bf16 v[144:159], a[160:163], v[52:55], v[144:159]
  s_add_u32 s1, s1, 63488
  buffer_load_dwordx4 v210, s[56:59], s1 offen offset:2048 lds
  v_mfma_f32_32x32x16_bf16 v[160:175], a[164:167], v[48:51], v[160:175]
  buffer_load_dwordx4 v211, s[56:59], s1 offen offset:3072 lds
  v_mfma_f32_32x32x16_bf16 v[176:191], a[164:167], v[52:55], v[176:191]
  s_waitcnt vmcnt(7)
  v_readfirstlane_b32 s66, v207
  s_mul_i32 s67, s83, 8
  s_nop 0
  s_bfe_u32 s66, s66, 524288
  s_cmp_eq_u32 s66, s67
  s_cbranch_scc0 k_B2_c1_spin
k_B2_c1_ok:
  s_barrier
  s_add_u32 s68, s82, 0
  buffer_load_dword v207, v209, s[44:47], s68 offen sc1
  s_lshr_b32 s3, s15, 4
  v_add_u32 v201, 32768, v201
  v_add_u32 v202, 32768, v202
  s_and_b32 s3, s3, 32767
  buffer_load_dwordx4 v[80:83], v201, s[44:47], s3 offen sc1
  buffer_load_dwordx4 v[84:87], v202, s[44:47], s3 offen sc1
  s_add_u32 s3, s3, 4096
  s_and_b32 s3, s3, 32767
  buffer_load_dwordx4 v[88:91], v201, s[44:47], s3 offen sc1
  buffer_load_dwordx4 v[92:95], v202, s[44:47], s3 offen sc1
  s_add_u32 s3, s3, 4096
  s_and_b32 s3, s3, 32767
  buffer_load_dwordx4 v[96:99], v201, s[44:47], s3 offen sc1
  buffer_load_dwordx4 v[100:103], v202, s[44:47], s3 offen sc1
  v_mfma_f32_32x32x16_bf16 v[128:143], a[168:171], v[56:59], v[128:143]
  s_add_u32 s3, s3, 4096
  s_and_b32 s3, s3, 32767
  buffer_load_dwordx4 v[104:107], v201, s[44:47], s3 offen sc1
  v_mfma_f32_32x32x16_bf16 v[144:159], a[168:171], v[60:63], v[144:159]
  buffer_load_dwordx4 v[108:111], v202, s[44:47], s3 offen sc1
  v_mfma_f32_32x32x16_bf16 v[160:175], a[172:175], v[56:59], v[160:175]
  s_add_u32 s3, s3, 4096
  s_and_b32 s3, s3, 32767
  buffer_load_dwordx4 v[0:3], v201, s[44:47], s3 offen sc1
  v_mfma_f32_32x32x16_bf16 v[176:191], a[172:175], v[60:63], v[176:191]
  s_waitcnt vmcnt(10)
  s_barrier
  s_waitcnt vmcnt(7)
  ds_read_b64_tr_b16 a[80:81], v218 offset:0
  ds_read_b64_tr_b16 a[82:83], v218 offset:1024
  ds_read_b64_tr_b16 a[84:85], v218 offset:4096
  ds_read_b64_tr_b16 a[86:87], v218 offset:5120
  buffer_load_dwordx4 v[4:7], v202, s[44:47], s3 offen sc1
  v_mfma_f32_32x32x16_bf16 v[128:143], a[176:179], v[80:83], v[128:143]
  s_add_u32 s3, s3, 4096
  s_and_b32 s3, s3, 32767
  ds_read_b64_tr_b16 a[88:89], v218 offset:8192
  ds_read_b64_tr_b16 a[90:91], v218 offset:9216
  ds_read_b64_tr_b16 a[92:93], v218 offset:12288
  buffer_load_dwordx4 v[8:11], v201, s[44:47], s3 offen sc1
  v_mfma_f32_32x32x16_bf16 v[144:159], a[176:179], v[84:87], v[144:159]
  ds_read_b64_tr_b16 a[94:95], v218 offset:13312
  ds_read_b64_tr_b16 a[96:97], v218 offset:2048
  ds_read_b64_tr_b16 a[98:99], v218 offset:3072
  ds_read_b64_tr_b16 a[100:101], v218 offset:6144
  ds_read_b64_tr_b16 a[102:103], v218 offset:7168
  buffer_load_dwordx4 v[12:15], v202, s[44:47], s3 offen sc1
  v_mfma_f32_32x32x16_bf16 v[160:175], a[180:183], v[80:83], v[160:175]
  s_add_u32 s3, s3, 4096
  s_and_b32 s3, s3, 32767
  ds_read_b64_tr_b16 a[104:105], v218 offset:10240
  ds_read_b64_tr_b16 a[106:107], v218 offset:11264
  ds_read_b64_tr_b16 a[108:109], v218 offset:14336
  buffer_load_dwordx4 v[16:19], v201, s[44:47], s3 offen sc1
  v_mfma_f32_32x32x16_bf16 v[176:191], a[180:183], v[84:87], v[176:191]
  s_waitcnt vmcnt(9)
  ds_read_b64_tr_b16 a[110:111], v218 offset:15360
  ds_read_b64_tr_b16 a[112:113], v220 offset:0
  ds_read_b64_tr_b16 a[114:115], v220 offset:1024
  ds_read_b64_tr_b16 a[116:117], v220 offset:4096
  ds_read_b64_tr_b16 a[118:119], v220 offset:5120
  buffer_load_dwordx4 v[20:23], v202, s[44:47], s3 offen sc1
  v_mfma_f32_32x32x16_bf16 v[128:143], a[184:187], v[88:91], v[128:143]
  ds_read_b64_tr_b16 a[120:121], v220 offset:8192
  ds_read_b64_tr_b16 a[122:123], v220 offset:9216
  ds_read_b64_tr_b16 a[124:125], v220 offset:12288
  ds_read_b64_tr_b16 a[126:127], v220 offset:13312
  ds_read_b64_tr_b16 a[128:129], v220 offset:2048
  ds_read_b64_tr_b16 a[130:131], v220 offset:3072
  ds_read_b64_tr_b16 a[132:133], v220 offset:6144
  v_mfma_f32_32x32x16_bf16 v[144:159], a[184:187], v[92:95], v[144:159]
  s_add_u32 s3, s3, 4096
  s_and_b32 s3, s3, 32767
  ds_read_b64_tr_b16 a[134:135], v220 offset:7168
  ds_read_b64_tr_b16 a[136:137], v220 offset:10240
  ds_read_b64_tr_b16 a[138:139], v220 offset:11264
  buffer_load_dwordx4 v[24:27], v201, s[44:47], s3 offen sc1
  v_mfma_f32_32x32x16_bf16 v[160:175], a[188:191], v[88:91], v[160:175]
  ds_read_b64_tr_b16 a[140:141], v220 offset:14336
  ds_read_b64_tr_b16 a[142:143], v220 offset:15360
  ds_read_b64_tr_b16 a[144:145], v218 offset:49152
  ds_read_b64_tr_b16 a[146:147], v218 offset:50176
  ds_read_b64_tr_b16 a[148:149], v218 offset:53248
  buffer_load_dwordx4 v[28:31], v202, s[44:47], s3 offen sc1
  v_mfma_f32_32x32x16_bf16 v[176:191], a[188:191], v[92:95], v[176:191]
  v_readfirstlane_b32 s66, v207
  s_mul_i32 s67, s83, 8
  s_nop 0
  s_bfe_u32 s66, s66, 524296
  s_cmp_eq_u32 s66, s67
  s_cbranch_scc0 k_B2_cH_spin
k_B2_cH_ok:
  s_barrier
  s_waitcnt vmcnt(10)
  s_lshr_b32 s3, s15, 4
  s_and_b32 s3, s3, 16383
  v_add_u32 v201, 32768, v201
  v_add_u32 v202, 32768, v202
  buffer_load_dwordx4 v[32:35], v201, s[44:47], s3 offen sc1
  v_mfma_f32_32x32x16_bf16 v[128:143], a[192:195], v[96:99], v[128:143]
  ds_read_b64_tr_b16 a[150:151], v218 offset:54272
  ds_read_b64_tr_b16 a[152:153], v218 offset:57344
  ds_read_b64_tr_b16 a[154:155], v218 offset:58368
  ds_read_b64_tr_b16 a[156:157], v218 offset:61440
  ds_read_b64_tr_b16 a[158:159], v218 offset:62464
  buffer_load_dwordx4 v[36:39], v202, s[44:47], s3 offen sc1
  v_mfma_f32_32x32x16_bf16 v[144:159], a[192:195], v[100:103], v[144:159]
  s_add_u32 s3, s3, 4096
  s_and_b32 s3, s3, 16383
  ds_read_b64_tr_b16 a[160:161], v218 offset:51200
  ds_read_b64_tr_b16 a[162:163], v218 offset:52224
  ds_read_b64_tr_b16 a[164:165], v218 offset:55296
  buffer_load_dwordx4 v[40:43], v201, s[44:47], s3 offen sc1
  v_mfma_f32_32x32x16_bf16 v[160:175], a[196:199], v[96:99], v[160:175]
  ds_read_b64_tr_b16 a[166:167], v218 offset:56320
  ds_read_b64_tr_b16 a[168:169], v218 offset:59392
  ds_read_b64_tr_b16 a[170:171], v218 offset:60416
  ds_read_b64_tr_b16 a[172:173], v218 offset:63488
  ds_read_b64_tr_b16 a[174:175], v218 offset:64512
  buffer_load_dwordx4 v[44:47], v202, s[44:47], s3 offen sc1
  v_mfma_f32_32x32x16_bf16 v[176:191], a[196:199], v[100:103], v[176:191]
  s_waitcnt vmcnt(12)
  s_add_u32 s68, s82, 65536
  buffer_load_dword v208, v209, s[44:47], s68 offen sc1
  s_add_u32 s3, s3, 4096
  s_and_b32 s3, s3, 16383
  buffer_load_dwordx4 v[48:51], v201, s[44:47], s3 offen sc1
  v_mfma_f32_32x32x16_bf16 v[128:143], a[200:203], v[104:107], v[128:143]
  ds_read_b64_tr_b16 a[176:177], v218 offset:16384
  ds_read_b64_tr_b16 a[178:179], v218 offset:17408
  ds_read_b64_tr_b16 a[180:181], v218 offset:20480
  ds_read_b64_tr_b16 a[182:183], v218 offset:21504
  ds_read_b64_tr_b16 a[184:185], v218 offset:24576
  buffer_load_dwordx4 v[52:55], v202, s[44:47], s3 offen sc1
  v_mfma_f32_32x32x16_bf16 v[144:159], a[200:203], v[108:111], v[144:159]
  s_add_u32 s3, s3, 4096
  s_and_b32 s3, s3, 16383
  ds_read_b64_tr_b16 a[186:187], v218 offset:25600
  ds_read_b64_tr_b16 a[188:189], v218 offset:28672
  ds_read_b64_tr_b16 a[190:191], v218 offset:29696
  buffer_load_dwordx4 v[56:59], v201, s[44:47], s3 offen sc1
  v_mfma_f32_32x32x16_bf16 v[160:175], a[204:207], v[104:107], v[160:175]
  ds_read_b64_tr_b16 a[192:193], v218 offset:18432
  ds_read_b64_tr_b16 a[194:195], v218 offset:19456
  ds_read_b64_tr_b16 a[196:197], v218 offset:22528
  ds_read_b64_tr_b16 a[198:199], v218 offset:23552
  buffer_load_dwordx4 v[60:63], v202, s[44:47], s3 offen sc1
  v_mfma_f32_32x32x16_bf16 v[176:191], a[204:207], v[108:111], v[176:191]
  s_waitcnt vmcnt(15)
  v_mfma_f32_32x32x16_bf16 v[128:143], a[208:211], v[0:3], v[128:143]
  ds_read_b64_tr_b16 a[200:201], v218 offset:26624
  ds_read_b64_tr_b16 a[202:203], v218 offset:27648
  ds_read_b64_tr_b16 a[204:205], v218 offset:30720
  ds_read_b64_tr_b16 a[206:207], v218 offset:31744
  v_permlane16_swap_b32 v112, v116
  v_permlane16_swap_b32 v113, v117
  v_permlane16_swap_b32 v114, v118
  v_mfma_f32_32x32x16_bf16 v[144:159], a[208:211], v[4:7], v[144:159]
  v_permlane16_swap_b32 v115, v119
  v_lshlrev_b32 v238, 16, v112
  v_and_b32 v239, s74, v112
  v_lshlrev_b32 v240, 16, v113
  v_and_b32 v241, s74, v113
  v_lshlrev_b32 v242, 16, v114
  v_and_b32 v243, s74, v114
  v_mfma_f32_32x32x16_bf16 v[160:175], a[212:215], v[0:3], v[160:175]
  v_lshlrev_b32 v244, 16, v115
  v_and_b32 v245, s74, v115
  v_lshlrev_b32 v246, 16, v116
  v_and_b32 v247, s74, v116
  v_lshlrev_b32 v248, 16, v117
  v_and_b32 v249, s74, v117
  v_lshlrev_b32 v250, 16, v118
  v_mfma_f32_32x32x16_bf16 v[176:191], a[212:215], v[4:7], v[176:191]
  s_waitcnt vmcnt(13)
  v_and_b32 v251, s74, v118
  v_lshlrev_b32 v252, 16, v119
  v_and_b32 v253, s74, v119
  v_mfma_f32_32x32x16_bf16 v[128:143], a[216:219], v[8:11], v[128:143]
  v_mfma_f32_32x32x16_bf16 v[144:159], a[216:219], v[12:15], v[144:159]
  v_mfma_f32_32x32x16_bf16 v[160:175], a[220:223], v[8:11], v[160:175]
  v_mfma_f32_32x32x16_bf16 v[176:191], a[220:223], v[12:15], v[176:191]
  s_waitcnt vmcnt(4)
  v_readfirstlane_b32 s66, v208
  s_mul_i32 s67, s83, 8
  s_nop 0
  s_bfe_u32 s66, s66, 524304
  s_cmp_eq_u32 s66, s67
  s_cbranch_scc0 k_B2_cO_spin
k_B2_cO_ok:
  s_barrier
  s_lshr_b32 s3, s15, 4
  s_and_b32 s3, s3, 32767
  v_add_u32 v201, 16384, v201
  v_add_u32 v202, 16384, v202
  buffer_load_dwordx4 v[80:83], v201, s[44:47], s3 offen sc1
  v_mfma_f32_32x32x16_bf16 v[128:143], a[224:227], v[16:19], v[128:143]
  buffer_load_dwordx4 v[84:87], v202, s[44:47], s3 offen sc1
  v_mfma_f32_32x32x16_bf16 v[144:159], a[224:227], v[20:23], v[144:159]
  s_add_u32 s3, s3, 4096
  s_and_b32 s3, s3, 32767
  buffer_load_dwordx4 v[88:91], v201, s[44:47], s3 offen sc1
  v_mfma_f32_32x32x16_bf16 v[160:175], a[228:231], v[16:19], v[160:175]
  buffer_load_dwordx4 v[92:95], v202, s[44:47], s3 offen sc1
  v_mfma_f32_32x32x16_bf16 v[176:191], a[228:231], v[20:23], v[176:191]
  s_add_u32 s3, s3, 4096
  s_and_b32 s3, s3, 32767
  buffer_load_dwordx4 v[96:99], v201, s[44:47], s3 offen sc1
  v_mfma_f32_32x32x16_bf16 v[128:143], a[232:235], v[24:27], v[128:143]
  buffer_load_dwordx4 v[100:103], v202, s[44:47], s3 offen sc1
  v_mfma_f32_32x32x16_bf16 v[144:159], a[232:235], v[28:31], v[144:159]
  v_mfma_f32_32x32x16_bf16 v[160:175], a[236:239], v[24:27], v[160:175]
  s_add_u32 s3, s3, 4096
  s_and_b32 s3, s3, 32767
  buffer_load_dwordx4 v[104:107], v201, s[44:47], s3 offen sc1
  v_mfma_f32_32x32x16_bf16 v[176:191], a[236:239], v[28:31], v[176:191]
  buffer_load_dwordx4 v[108:111], v202, s[44:47], s3 offen sc1
  v_mfma_f32_32x32x16_bf16 v[128:143], a[240:243], v[32:35], v[128:143]
  s_add_u32 s3, s3, 4096
  s_and_b32 s3, s3, 32767
  buffer_load_dwordx4 v[0:3], v201, s[44:47], s3 offen sc1
  v_mfma_f32_32x32x16_bf16 v[144:159], a[240:243], v[36:39], v[144:159]
  buffer_load_dwordx4 v[4:7], v202, s[44:47], s3 offen sc1
  v_mfma_f32_32x32x16_bf16 v[160:175], a[244:247], v[32:35], v[160:175]
  s_add_u32 s3, s3, 4096
  s_and_b32 s3, s3, 32767
  buffer_load_dwordx4 v[8:11], v201, s[44:47], s3 offen sc1
  v_mfma_f32_32x32x16_bf16 v[176:191], a[244:247], v[36:39], v[176:191]
  v_mfma_f32_32x32x16_bf16 v[128:143], a[248:251], v[40:43], v[128:143]
  buffer_load_dwordx4 v[12:15], v202, s[44:47], s3 offen sc1
  v_mfma_f32_32x32x16_bf16 v[144:159], a[248:251], v[44:47], v[144:159]
  s_add_u32 s3, s3, 4096
  s_and_b32 s3, s3, 32767
  buffer_load_dwordx4 v[16:19], v201, s[44:47], s3 offen sc1
  v_mfma_f32_32x32x16_bf16 v[160:175], a[252:255], v[40:43], v[160:175]
  buffer_load_dwordx4 v[20:23], v202, s[44:47], s3 offen sc1
  v_mfma_f32_32x32x16_bf16 v[176:191], a[252:255], v[44:47], v[176:191]
  s_waitcnt vmcnt(16) lgkmcnt(15)
  s_add_u32 s3, s3, 4096
  s_and_b32 s3, s3, 32767
  buffer_load_dwordx4 v[24:27], v201, s[44:47], s3 offen sc1
  v_mfma_f32_32x32x16_bf16 v[128:143], a[0:3], v[48:51], v[128:143]
  v_mfma_f32_32x32x16_bf16 v[144:159], a[0:3], v[52:55], v[144:159]
  buffer_load_dwordx4 v[28:31], v202, s[44:47], s3 offen sc1
  v_mfma_f32_32x32x16_bf16 v[160:175], a[4:7], v[48:51], v[160:175]
  s_add_u32 m0, s65, 32768
  s_lshr_b32 s0, s15, 4
  s_add_u32 s0, s0, 0
  s_and_b32 s0, s0, 32767
  s_add_u32 s0, s0, s100
  buffer_load_dwordx4 v200, s[44:47], s0 offen sc1 lds
  v_mfma_f32_32x32x16_bf16 v[176:191], a[4:7], v[52:55], v[176:191]
  s_waitcnt vmcnt(17)
  buffer_load_dwordx4 v200, s[44:47], s0 offen offset:1024 sc1 lds
  v_mfma_f32_32x32x16_bf16 v[128:143], a[8:11], v[56:59], v[128:143]
  buffer_load_dwordx4 v200, s[44:47], s0 offen offset:2048 sc1 lds
  v_mfma_f32_32x32x16_bf16 v[144:159], a[8:11], v[60:63], v[144:159]
  buffer_load_dwordx4 v200, s[44:47], s0 offen offset:3072 sc1 lds
  v_mfma_f32_32x32x16_bf16 v[160:175], a[12:15], v[56:59], v[160:175]
  s_add_u32 m0, s65, 65536
  s_lshr_b32 s0, s15, 4
  s_add_u32 s0, s0, 8192
  s_and_b32 s0, s0, 32767
  s_add_u32 s0, s0, s100
  buffer_load_dwordx4 v200, s[44:47], s0 offen sc1 lds
  v_mfma_f32_32x32x16_bf16 v[176:191], a[12:15], v[60:63], v[176:191]
  s_waitcnt vmcnt(19)
  v_mfma_f32_32x32x16_bf16 v[128:143], a[16:19], v[80:83], v[128:143]
  buffer_load_dwordx4 v200, s[44:47], s0 offen offset:1024 sc1 lds
  v_mfma_f32_32x32x16_bf16 v[144:159], a[16:19], v[84:87], v[144:159]
  buffer_load_dwordx4 v200, s[44:47], s0 offen offset:2048 sc1 lds
  v_mfma_f32_32x32x16_bf16 v[160:175], a[20:23], v[80:83], v[160:175]
  buffer_load_dwordx4 v200, s[44:47], s0 offen offset:3072 sc1 lds
  v_mfma_f32_32x32x16_bf16 v[176:191], a[20:23], v[84:87], v[176:191]
  s_waitcnt vmcnt(20)
  s_add_u32 m0, s65, 81920
  s_lshr_b32 s0, s15, 4
  s_add_u32 s0, s0, 16384
  s_and_b32 s0, s0, 32767
  s_add_u32 s0, s0, s100
  buffer_load_dwordx4 v200, s[44:47], s0 offen sc1 lds
  v_mfma_f32_32x32x16_bf16 v[128:143], a[24:27], v[88:91], v[128:143]
  buffer_load_dwordx4 v200, s[44:47], s0 offen offset:1024 sc1 lds
  v_mfma_f32_32x32x16_bf16 v[144:159], a[24:27], v[92:95], v[144:159]
  buffer_load_dwordx4 v200, s[44:47], s0 offen offset:2048 sc1 lds
  v_mfma_f32_32x32x16_bf16 v[160:175], a[28:31], v[88:91], v[160:175]
  v_mfma_f32_32x32x16_bf16 v[176:191], a[28:31], v[92:95], v[176:191]
  s_waitcnt vmcnt(21)
  buffer_load_dwordx4 v200, s[44:47], s0 offen offset:3072 sc1 lds
  v_mfma_f32_32x32x16_bf16 v[128:143], a[32:35], v[96:99], v[128:143]
  s_add_u32 m0, s65, 98304
  s_lshr_b32 s0, s15, 4
  s_add_u32 s0, s0, 24576
  s_and_b32 s0, s0, 32767
  s_add_u32 s0, s0, s100
  buffer_load_dwordx4 v200, s[44:47], s0 offen sc1 lds
  v_mfma_f32_32x32x16_bf16 v[144:159], a[32:35], v[100:103], v[144:159]
  buffer_load_dwordx4 v200, s[44:47], s0 offen offset:1024 sc1 lds
  v_mfma_f32_32x32x16_bf16 v[160:175], a[36:39], v[96:99], v[160:175]
  buffer_load_dwordx4 v200, s[44:47], s0 offen offset:2048 sc1 lds
  v_mfma_f32_32x32x16_bf16 v[176:191], a[36:39], v[100:103], v[176:191]
  s_waitcnt vmcnt(23)
  buffer_load_dwordx4 v200, s[44:47], s0 offen offset:3072 sc1 lds
  v_mfma_f32_32x32x16_bf16 v[128:143], a[40:43], v[104:107], v[128:143]
  v_mfma_f32_32x32x16_bf16 v[144:159], a[40:43], v[108:111], v[144:159]
  v_mfma_f32_32x32x16_bf16 v[160:175], a[44:47], v[104:107], v[160:175]
  v_mfma_f32_32x32x16_bf16 v[176:191], a[44:47], v[108:111], v[176:191]
  s_waitcnt vmcnt(22)
  v_mfma_f32_32x32x16_bf16 v[128:143], a[48:51], v[0:3], v[128:143]
  v_mfma_f32_32x32x16_bf16 v[144:159], a[48:51], v[4:7], v[144:159]
  v_mfma_f32_32x32x16_bf16 v[160:175], a[52:55], v[0:3], v[160:175]
  v_mfma_f32_32x32x16_bf16 v[176:191], a[52:55], v[4:7], v[176:191]
  s_waitcnt lgkmcnt(0)
  s_barrier
  s_waitcnt vmcnt(20)
  v_mfma_f32_32x32x16_bf16 v[176:191], a[60:63], v[12:15], v[176:191]
  s_waitcnt vmcnt(18)
  v_mfma_f32_32x32x16_bf16 v[176:191], a[68:71], v[20:23], v[176:191]
  s_waitcnt vmcnt(16)
  v_mfma_f32_32x32x16_bf16 v[176:191], a[76:79], v[28:31], v[176:191]
  v_mfma_f32_32x32x16_bf16 v[160:175], a[60:63], v[8:11], v[160:175]
  v_mfma_f32_32x32x16_bf16 v[160:175], a[68:71], v[16:19], v[160:175]
  v_mfma_f32_32x32x16_bf16 v[160:175], a[76:79], v[24:27], v[160:175]
  s_nop 8
  ds_write_b128 v226, v[176:179] offset:0
  v_mfma_f32_32x32x16_bf16 v[144:159], a[56:59], v[12:15], v[144:159]
  v_mfma_f32_32x32x16_bf16 v[144:159], a[64:67], v[20:23], v[144:159]
  ds_write_b128 v226, v[180:183] offset:1024
  v_mfma_f32_32x32x16_bf16 v[144:159], a[72:75], v[28:31], v[144:159]
  v_mfma_f32_32x32x16_bf16 v[128:143], a[56:59], v[8:11], v[128:143]
  ds_write_b128 v226, v[184:187] offset:2048
  v_mfma_f32_32x32x16_bf16 v[128:143], a[64:67], v[16:19], v[128:143]
  v_mfma_f32_32x32x16_bf16 v[128:143], a[72:75], v[24:27], v[128:143]
  s_waitcnt vmcnt(8)
  ds_write_b128 v226, v[188:191] offset:3072
  s_barrier
  ds_read_b128 v[0:3], v221 offset:32768
  ds_read_b128 v[4:7], v221 offset:33792
  ds_read_b128 v[8:11], v221 offset:34816
  ds_read_b128 v[12:15], v221 offset:35840
  s_waitcnt lgkmcnt(3)
  v_mfma_f32_32x32x16_bf16 v[64:79], a[80:83], v[0:3], 0
  s_waitcnt lgkmcnt(2)
  ds_read_b128 v[16:19], v221 offset:40960
  ds_write_b128 v225, v[160:163] offset:0
  v_mfma_f32_32x32x16_bf16 v[64:79], a[84:87], v[4:7], v[64:79]
  s_waitcnt lgkmcnt(2)
  ds_read_b128 v[20:23], v221 offset:41984
  ds_write_b128 v225, v[164:167] offset:1024
  v_mfma_f32_32x32x16_bf16 v[64:79], a[88:91], v[8:11], v[64:79]
  ds_read_b128 v[24:27], v221 offset:43008
  ds_write_b128 v225, v[168:171] offset:2048
  v_mfma_f32_32x32x16_bf16 v[64:79], a[92:95], v[12:15], v[64:79]
  s_waitcnt lgkmcnt(3)
  ds_read_b128 v[28:31], v221 offset:44032
  ds_write_b128 v225, v[172:175] offset:3072
  v_mfma_f32_32x32x16_bf16 v[64:79], a[96:99], v[16:19], v[64:79]
  ds_read_b128 v[0:3], v222 offset:0
  ds_write_b128 v224, v[144:147] offset:0
  v_mfma_f32_32x32x16_bf16 v[64:79], a[100:103], v[20:23], v[64:79]
  s_waitcnt lgkmcnt(3)
  ds_read_b128 v[4:7], v222 offset:1024
  ds_write_b128 v224, v[148:151] offset:1024
  v_mfma_f32_32x32x16_bf16 v[64:79], a[104:107], v[24:27], v[64:79]
  ds_read_b128 v[8:11], v222 offset:2048
  ds_write_b128 v224, v[152:155] offset:2048
  v_mfma_f32_32x32x16_bf16 v[64:79], a[108:111], v[28:31], v[64:79]
  s_waitcnt lgkmcnt(3)
  ds_read_b128 v[12:15], v222 offset:3072
  ds_write_b128 v224, v[156:159] offset:3072
  v_mfma_f32_32x32x16_bf16 v[64:79], a[112:115], v[0:3], v[64:79]
  s_waitcnt vmcnt(0) lgkmcnt(0)
  s_barrier
  ds_read_b128 v[16:19], v222 offset:8192
  ds_read_b128 v[144:147], v227 offset:0
  ds_read_b128 v[148:151], v227 offset:1024
  ds_read_b128 v[152:155], v227 offset:2048
  ds_read_b128 v[156:159], v227 offset:3072
  ds_read_b128 v[160:163], v228 offset:0
  ds_read_b128 v[164:167], v228 offset:1024
  ds_read_b128 v[168:171], v228 offset:2048
  ds_read_b128 v[172:175], v228 offset:3072
  v_mfma_f32_32x32x16_bf16 v[64:79], a[116:119], v[4:7], v[64:79]
  ds_read_b128 v[20:23], v222 offset:9216
  ds_read_b128 v[176:179], v229 offset:0
  ds_read_b128 v[180:183], v229 offset:1024
  ds_read_b128 v[184:187], v229 offset:2048
  ds_read_b128 v[188:191], v229 offset:3072
  v_mfma_f32_32x32x16_bf16 v[64:79], a[120:123], v[8:11], v[64:79]
  s_waitcnt lgkmcnt(11)
  ds_read_b128 v[24:27], v222 offset:10240
  v_add_f32 v128, v128, v144
  v_add_f32 v129, v129, v145
  v_add_f32 v130, v130, v146
  v_add_f32 v131, v131, v147
  v_add_f32 v132, v132, v148
  v_add_f32 v133, v133, v149
  v_add_f32 v134, v134, v150
  v_add_f32 v135, v135, v151
  v_mfma_f32_32x32x16_bf16 v[64:79], a[124:127], v[12:15], v[64:79]
  s_waitcnt lgkmcnt(5)
  ds_read_b128 v[28:31], v222 offset:11264
  v_add_f32 v136, v136, v152
  v_add_f32 v137, v137, v153
  v_add_f32 v138, v138, v154
  v_add_f32 v139, v139, v155
  v_add_f32 v140, v140, v156
  v_add_f32 v141, v141, v157
  v_add_f32 v142, v142, v158
  v_add_f32 v143, v143, v159
  v_mfma_f32_32x32x16_bf16 v[64:79], a[128:131], v[16:19], v[64:79]
  s_waitcnt lgkmcnt(4)
  ds_read_b128 v[0:3], v222 offset:16384
  v_add_f32 v160, v160, v176
  v_add_f32 v161, v161, v177
  v_add_f32 v162, v162, v178
  v_add_f32 v163, v163, v179
  v_add_f32 v164, v164, v180
  v_add_f32 v165, v165, v181
  v_add_f32 v166, v166, v182
  v_add_f32 v167, v167, v183
  v_mfma_f32_32x32x16_bf16 v[64:79], a[132:135], v[20:23], v[64:79]
  s_waitcnt lgkmcnt(1)
  ds_read_b128 v[4:7], v222 offset:17408
  v_add_f32 v168, v168, v184
  v_add_f32 v169, v169, v185
  v_add_f32 v170, v170, v186
  v_add_f32 v171, v171, v187
  v_add_f32 v172, v172, v188
  v_add_f32 v173, v173, v189
  v_add_f32 v174, v174, v190
  v_add_f32 v175, v175, v191
  v_mfma_f32_32x32x16_bf16 v[64:79], a[136:139], v[24:27], v[64:79]
  ds_read_b128 v[8:11], v222 offset:18432
  v_add_f32 v128, v128, v160
  v_add_f32 v129, v129, v161
  v_add_f32 v130, v130, v162
  v_add_f32 v131, v131, v163
  v_mul_f32 v144, s72, v128
  v_mul_f32 v145, s72, v129
  v_mul_f32 v146, s72, v130
  v_mul_f32 v147, s72, v131
  v_mfma_f32_32x32x16_bf16 v[64:79], a[140:143], v[28:31], v[64:79]
  s_waitcnt lgkmcnt(1)
  ds_read_b128 v[12:15], v222 offset:19456
  v_exp_f32 v144, v144
  v_exp_f32 v145, v145
  v_exp_f32 v146, v146
  v_exp_f32 v147, v147
  v_mfma_f32_32x32x16_bf16 v[64:79], a[144:147], v[0:3], v[64:79]
  ds_read_b128 v[16:19], v222 offset:24576
  v_add_f32 v144, 1.0, v144
  v_add_f32 v145, 1.0, v145
  v_add_f32 v146, 1.0, v146
  v_add_f32 v147, 1.0, v147
  v_rcp_f32 v144, v144
  v_mfma_f32_32x32x16_bf16 v[64:79], a[148:151], v[4:7], v[64:79]
  s_waitcnt lgkmcnt(1)
  ds_read_b128 v[20:23], v222 offset:25600
  v_rcp_f32 v145, v145
  v_rcp_f32 v146, v146
  v_rcp_f32 v147, v147
  v_mul_f32 v128, v128, v144
  v_mul_f32 v129, v129, v145
  v_mfma_f32_32x32x16_bf16 v[64:79], a[152:155], v[8:11], v[64:79]
  ds_read_b128 v[24:27], v222 offset:26624
  v_mul_f32 v130, v130, v146
  v_mul_f32 v131, v131, v147
  v_add_f32 v132, v132, v164
  v_add_f32 v133, v133, v165
  v_add_f32 v134, v134, v166
  v_add_f32 v135, v135, v167
  v_mul_f32 v148, s72, v132
  v_mfma_f32_32x32x16_bf16 v[64:79], a[156:159], v[12:15], v[64:79]
  s_waitcnt lgkmcnt(1)
  ds_read_b128 v[28:31], v222 offset:27648
  v_mul_f32 v149, s72, v133
  v_mul_f32 v150, s72, v134
  v_mul_f32 v151, s72, v135
  v_exp_f32 v148, v148
  v_exp_f32 v149, v149
  v_mfma_f32_32x32x16_bf16 v[64:79], a[160:163], v[16:19], v[64:79]
  ds_read_b128 v[0:3], v222 offset:32768
  v_exp_f32 v150, v150
  v_exp_f32 v151, v151
  v_add_f32 v148, 1.0, v148
  v_add_f32 v149, 1.0, v149
  v_add_f32 v150, 1.0, v150
  v_mfma_f32_32x32x16_bf16 v[64:79], a[164:167], v[20:23], v[64:79]
  s_waitcnt lgkmcnt(1)
  ds_read_b128 v[4:7], v222 offset:33792
  v_add_f32 v151, 1.0, v151
  v_rcp_f32 v148, v148
  v_rcp_f32 v149, v149
  v_rcp_f32 v150, v150
  v_mfma_f32_32x32x16_bf16 v[64:79], a[168:171], v[24:27], v[64:79]
  ds_read_b128 v[8:11], v222 offset:34816
  v_rcp_f32 v151, v151
  v_mul_f32 v132, v132, v148
  v_mul_f32 v133, v133, v149
  v_mul_f32 v134, v134, v150
  v_mul_f32 v135, v135, v151
  v_add_f32 v136, v136, v168
  v_mfma_f32_32x32x16_bf16 v[64:79], a[172:175], v[28:31], v[64:79]
  s_waitcnt lgkmcnt(1)
  ds_read_b128 v[12:15], v222 offset:35840
  v_add_f32 v137, v137, v169
  v_add_f32 v138, v138, v170
  v_add_f32 v139, v139, v171
  v_mul_f32 v152, s72, v136
  v_mul_f32 v153, s72, v137
  v_mul_f32 v154, s72, v138
  v_mul_f32 v155, s72, v139
  v_mfma_f32_32x32x16_bf16 v[64:79], a[176:179], v[0:3], v[64:79]
  ds_read_b128 v[16:19], v222 offset:40960
  v_exp_f32 v152, v152
  v_exp_f32 v153, v153
  v_exp_f32 v154, v154
  v_mfma_f32_32x32x16_bf16 v[64:79], a[180:183], v[4:7], v[64:79]
  s_waitcnt lgkmcnt(1)
  ds_read_b128 v[20:23], v222 offset:41984
  v_exp_f32 v155, v155
  v_add_f32 v152, 1.0, v152
  v_add_f32 v153, 1.0, v153
  v_add_f32 v154, 1.0, v154
  v_add_f32 v155, 1.0, v155
  v_rcp_f32 v152, v152
  v_mfma_f32_32x32x16_bf16 v[64:79], a[184:187], v[8:11], v[64:79]
  ds_read_b128 v[24:27], v222 offset:43008
  v_rcp_f32 v153, v153
  v_rcp_f32 v154, v154
  v_rcp_f32 v155, v155
  v_mul_f32 v136, v136, v152
  v_mfma_f32_32x32x16_bf16 v[64:79], a[188:191], v[12:15], v[64:79]
  s_waitcnt lgkmcnt(1)
  ds_read_b128 v[28:31], v222 offset:44032
  v_mul_f32 v137, v137, v153
  v_mul_f32 v138, v138, v154
  v_mul_f32 v139, v139, v155
  v_add_f32 v140, v140, v172
  v_add_f32 v141, v141, v173
  v_add_f32 v142, v142, v174
  v_add_f32 v143, v143, v175
  v_mfma_f32_32x32x16_bf16 v[64:79], a[192:195], v[16:19], v[64:79]
  v_mul_f32 v156, s72, v140
  v_mul_f32 v157, s72, v141
  v_mul_f32 v158, s72, v142
  v_mul_f32 v159, s72, v143
  v_exp_f32 v156, v156
  v_mfma_f32_32x32x16_bf16 v[64:79], a[196:199], v[20:23], v[64:79]
  s_waitcnt lgkmcnt(0)
  v_exp_f32 v157, v157
  v_exp_f32 v158, v158
  v_exp_f32 v159, v159
  v_add_f32 v156, 1.0, v156
  v_add_f32 v157, 1.0, v157
  v_mfma_f32_32x32x16_bf16 v[64:79], a[200:203], v[24:27], v[64:79]
  v_add_f32 v158, 1.0, v158
  v_add_f32 v159, 1.0, v159
  v_rcp_f32 v156, v156
  v_rcp_f32 v157, v157
  v_mfma_f32_32x32x16_bf16 v[64:79], a[204:207], v[28:31], v[64:79]
  v_rcp_f32 v158, v158
  v_rcp_f32 v159, v159
  v_mul_f32 v140, v140, v156
  v_mul_f32 v141, v141, v157
  v_mul_f32 v142, v142, v158
  v_mul_f32 v143, v143, v159
  s_nop 5
  v_pk_fma_f32 v[238:239], v[64:65], v[128:129], v[238:239]
  v_pk_fma_f32 v[240:241], v[66:67], v[130:131], v[240:241]
  v_pk_fma_f32 v[242:243], v[68:69], v[132:133], v[242:243]
  v_pk_fma_f32 v[244:245], v[70:71], v[134:135], v[244:245]
  v_cvt_pk_bf16_f32 v112, v238, v239
  v_cvt_pk_bf16_f32 v113, v240, v241
  v_cvt_pk_bf16_f32 v114, v242, v243
  v_cvt_pk_bf16_f32 v115, v244, v245
  v_pk_fma_f32 v[246:247], v[72:73], v[136:137], v[246:247]
  v_pk_fma_f32 v[248:249], v[74:75], v[138:139], v[248:249]
  v_pk_fma_f32 v[250:251], v[76:77], v[140:141], v[250:251]
  v_pk_fma_f32 v[252:253], v[78:79], v[142:143], v[252:253]
  v_cvt_pk_bf16_f32 v116, v246, v247
  v_cvt_pk_bf16_f32 v117, v248, v249
  v_cvt_pk_bf16_f32 v118, v250, v251
  v_cvt_pk_bf16_f32 v119, v252, v253
  v_permlane16_swap_b32 v112, v116
  v_permlane16_swap_b32 v113, v117
  v_permlane16_swap_b32 v114, v118
  v_permlane16_swap_b32 v115, v119
  buffer_store_dwordx4 v[112:115], v231, s[60:63], 0 offen sc0 sc1
  buffer_store_dwordx4 v[116:119], v232, s[60:63], 0 offen sc0 sc1
  s_endpgm
k_A_main:
  s_lshr_b32 s18, s20, 1
  s_lshl_b32 s18, s18, 3
  s_and_b32 s67, s20, 1
  s_add_u32 s18, s18, s67
  s_mov_b32 s50, 256
  s_mov_b32 s51, 0x20000
  s_mov_b32 s54, 1835008
  s_mov_b32 s55, 0x20000
  s_mov_b32 s58, 524288
  s_mov_b32 s59, 0x20000
  s_mov_b32 s62, 2097152
  s_mov_b32 s63, 0x20000
  s_add_u32 s66, s101, 0
  s_and_b32 s66, s66, 7
  s_mul_i32 s84, s66, 229376
  s_mul_i32 s92, s66, 196608
  s_add_u32 s66, s101, 1
  s_and_b32 s66, s66, 7
  s_mul_i32 s85, s66, 229376
  s_mul_i32 s93, s66, 196608
  s_add_u32 s66, s101, 2
  s_and_b32 s66, s66, 7
  s_mul_i32 s86, s66, 229376
  s_mul_i32 s94, s66, 196608
  s_add_u32 s66, s101, 3
  s_and_b32 s66, s66, 7
  s_mul_i32 s87, s66, 229376
  s_mul_i32 s95, s66, 196608
  s_add_u32 s66, s101, 4
  s_and_b32 s66, s66, 7
  s_mul_i32 s88, s66, 229376
  s_mul_i32 s96, s66, 196608
  s_add_u32 s66, s101, 5
  s_and_b32 s66, s66, 7
  s_mul_i32 s89, s66, 229376
  s_mul_i32 s97, s66, 196608
  s_add_u32 s66, s101, 6
  s_and_b32 s66, s66, 7
  s_mul_i32 s90, s66, 229376
  s_mul_i32 s98, s66, 196608
  s_add_u32 s66, s101, 7
  s_and_b32 s66, s66, 7
  s_mul_i32 s91, s66, 229376
  s_mul_i32 s99, s66, 196608
  s_mov_b32 s72, 3216550459
  s_mov_b32 s73, 1069066811
  s_mov_b32 s74, 0xffff0000
  s_mov_b32 s75, 0x358637bd
  s_mov_b32 s78, 0xffff0000
  s_mov_b32 s79, 0xffff0000
  s_lshr_b32 s66, s2, 3
  s_lshr_b32 s19, s66, 2
  s_and_b32 s66, s66, 3
  s_and_b32 s23, s2, 7
  s_lshl_b32 s23, s23, 2
  s_add_u32 s23, s23, s66
  s_add_u32 s15, s66, s19
  s_and_b32 s15, s15, 0
  s_lshl_b32 s15, s15, 17
  s_lshl_b32 s80, s21, 12
  s_add_u32 s80, s80, 11534336
  s_lshl_b32 s81, s20, 12
  s_add_u32 s81, s81, 11567104
  s_lshr_b32 s82, s23, 1
  s_lshl_b32 s82, s82, 12
  s_add_u32 s82, s82, 11567104
  s_cmp_eq_u32 s64, 0
  s_cselect_b32 s83, 1, 0
  v_cmp_eq_u32 vcc, 0, v0
  v_mov_b32 v209, 2130706432
  s_nop 0
  v_cndmask_b32 v209, v209, 0, vcc
  v_lshlrev_b32 v221, 7, v200
  v_add_u32 v221, s77, v221
  v_lshl_add_u32 v210, v218, 10, v219
  s_lshl_b32 s66, s19, 7
  s_lshl_b32 s67, s64, 14
  s_add_u32 s66, s66, s67
  v_add_u32 v210, s66, v210
  v_add_u32 v211, 7168, v210
  v_lshrrev_b32 v239, 5, v200
  v_lshlrev_b32 v239, 3, v239
  v_bfe_u32 v240, v200, 2, 2
  v_add_u32 v239, v239, v240
  v_and_b32 v240, 16, v200
  v_lshlrev_b32 v240, 1, v240
  v_and_b32 v241, 3, v200
  v_lshl_add_u32 v240, v241, 3, v240
  v_lshl_add_u32 v198, v239, 6, v240
  v_lshl_add_u32 v192, v239, 7, v240
  v_and_b32 v241, 8, v200
  v_lshlrev_b32 v241, 3, v241
  v_xor_b32 v192, v192, v241
  v_xor_b32 v193, 64, v192
  v_add_u32 v194, 65536, v192
  v_add_u32 v195, 65536, v193
  v_add_u32 v196, 131072, v192
  v_add_u32 v197, 131072, v193
  v_lshrrev_b32 v239, 5, v200
  v_lshlrev_b32 v239, 2, v239
  v_bfe_u32 v240, v200, 2, 2
  v_add_u32 v239, v239, v240
  v_lshlrev_b32 v239, 7, v239
  v_and_b32 v240, 1, v200
  v_lshl_add_u32 v239, v240, 5, v239
  v_and_b32 v240, 16, v200
  v_add_u32 v239, v239, v240
  v_and_b32 v240, 2, v200
  v_lshl_add_u32 v239, v240, 2, v239
  v_xor_b32 v239, v239, v241
  s_lshr_b32 s66, s64, 1
  s_lshl_b32 s66, s66, 6
  s_add_u32 s66, s66, s65
  v_xor_b32 v212, s66, v239
  v_xor_b32 v213, 64, v212
  v_add_u32 v214, 65536, v212
  v_add_u32 v215, 65536, v213
  v_add_u32 v216, 131072, v212
  v_add_u32 v217, 131072, v213
  v_bfe_u32 v239, v200, 1, 3
  v_lshrrev_b32 v240, 5, v200
  v_xor_b32 v239, v239, v240
  v_lshlrev_b32 v239, 4, v239
  v_and_b32 v240, 31, v200
  v_lshl_add_u32 v239, v240, 7, v239
  v_add_u32 v226, s65, v239
  v_xor_b32 v227, 32, v226
  v_xor_b32 v228, 64, v226
  v_xor_b32 v229, 96, v226
  v_add_u32 v230, 0x10000, v226
  v_add_u32 v231, 0x10000, v227
  v_add_u32 v232, 0x10000, v228
  v_add_u32 v233, 0x10000, v229
  v_mov_b32 v234, 0
  v_mov_b32 v235, 0
  v_mov_b32 v236, 0
  v_mov_b32 v237, 0
  s_lshl_b32 s66, s23, 1
  s_and_b32 s67, s64, 1
  s_add_u32 s23, s66, s67
  s_lshl_b32 s66, s21, 7
  s_add_u32 s66, s66, 1024
  s_lshl_b32 s67, s64, 4
  v_add_u32 v220, s67, v218
  v_mul_u32_u24 v220, 3584, v220
  v_add3_u32 v203, v220, v219, s66
  v_add_u32 v204, 27648, v203
  s_lshl_b32 s66, s21, 6
  s_add_u32 s66, s66, 2048
  v_lshrrev_b32 v218, 2, v200
  v_and_b32 v219, 3, v200
  v_lshlrev_b32 v219, 4, v219
  s_and_b32 s67, s64, 1
  s_lshl_b32 s67, s67, 5
  v_add_u32 v220, s67, v218
  v_mul_u32_u24 v220, 3584, v220
  v_add3_u32 v205, v220, v219, s66
  v_add_u32 v206, 56320, v205
  s_lshl_b32 s66, s21, 12
  s_add_u32 s66, s66, s76
  s_add_u32 s70, s66, 32768
  s_lshl_b32 s66, s21, 11
  s_add_u32 s66, s66, s76
  s_add_u32 s71, s66, 65536
  s_lshl_b32 s66, s21, 2
  s_add_u32 s66, s66, s64
  s_lshl_b32 s66, s66, 4
  s_add_u32 s66, s66, s20
  s_lshl_b32 s76, s66, 9
  s_add_u32 s76, s76, 10485760
  s_lshl_b32 s77, s21, 14
  s_lshl_b32 s66, s20, 2
  s_add_u32 s66, s66, s64
  s_lshl_b32 s66, s66, 5
  s_add_u32 s77, s77, s66
  s_add_u32 s77, s77, 11010048
  v_add_u32 v199, 131072, v198
  v_add_u32 v198, 0, v198
  v_lshlrev_b32 v200, 4, v200
  s_waitcnt vmcnt(11)
  ds_read_b128 v[0:3], v226 offset:0
  ds_read_b128 v[4:7], v227 offset:0
  ds_read_b128 v[8:11], v228 offset:0
  ds_read_b128 v[12:15], v229 offset:0
  s_add_u32 s66, s101, 3
  s_and_b32 s66, s66, 7
  s_lshl_b32 s66, s66, 7
  s_add_u32 m0, s65, 49152
  s_add_u32 s66, s66, s100
  buffer_load_dwordx4 v222, s[24:27], s66 offen lds
  buffer_load_dwordx4 v223, s[24:27], s66 offen offset:1024 lds
  buffer_load_dwordx4 v224, s[24:27], s66 offen offset:2048 lds
  buffer_load_dwordx4 v225, s[24:27], s66 offen offset:3072 lds
  s_mov_b32 s68, 0x3f803f80
  s_waitcnt lgkmcnt(3)
  v_dot2c_f32_bf16 v234, s68, v0
  v_dot2c_f32_bf16 v236, v0, v0
  v_dot2c_f32_bf16 v235, s68, v1
  v_dot2c_f32_bf16 v237, v1, v1
  v_dot2c_f32_bf16 v234, s68, v2
  v_dot2c_f32_bf16 v236, v2, v2
  v_dot2c_f32_bf16 v235, s68, v3
  v_dot2c_f32_bf16 v237, v3, v3
  s_waitcnt lgkmcnt(2)
  v_dot2c_f32_bf16 v234, s68, v4
  v_dot2c_f32_bf16 v236, v4, v4
  v_dot2c_f32_bf16 v235, s68, v5
  v_dot2c_f32_bf16 v237, v5, v5
  v_dot2c_f32_bf16 v234, s68, v6
  v_dot2c_f32_bf16 v236, v6, v6
  v_dot2c_f32_bf16 v235, s68, v7
  v_dot2c_f32_bf16 v237, v7, v7
  s_waitcnt lgkmcnt(1)
  v_dot2c_f32_bf16 v234, s68, v8
  v_dot2c_f32_bf16 v236, v8, v8
  v_dot2c_f32_bf16 v235, s68, v9
  v_dot2c_f32_bf16 v237, v9, v9
  v_dot2c_f32_bf16 v234, s68, v10
  v_dot2c_f32_bf16 v236, v10, v10
  v_dot2c_f32_bf16 v235, s68, v11
  v_dot2c_f32_bf16 v237, v11, v11
  s_waitcnt lgkmcnt(0)
  v_dot2c_f32_bf16 v234, s68, v12
  v_dot2c_f32_bf16 v236, v12, v12
  v_dot2c_f32_bf16 v235, s68, v13
  v_dot2c_f32_bf16 v237, v13, v13
  v_dot2c_f32_bf16 v234, s68, v14
  v_dot2c_f32_bf16 v236, v14, v14
  v_dot2c_f32_bf16 v235, s68, v15
  v_dot2c_f32_bf16 v237, v15, v15
  s_waitcnt vmcnt(11)
  ds_read_b128 v[16:19], v226 offset:16384
  ds_read_b128 v[20:23], v227 offset:16384
  ds_read_b128 v[24:27], v228 offset:16384
  ds_read_b128 v[28:31], v229 offset:16384
  s_add_u32 s66, s101, 4
  s_and_b32 s66, s66, 7
  s_lshl_b32 s66, s66, 7
  s_add_u32 m0, s65, 65536
  s_add_u32 s66, s66, s100
  buffer_load_dwordx4 v222, s[24:27], s66 offen lds
  buffer_load_dwordx4 v223, s[24:27], s66 offen offset:1024 lds
  buffer_load_dwordx4 v224, s[24:27], s66 offen offset:2048 lds
  buffer_load_dwordx4 v225, s[24:27], s66 offen offset:3072 lds
  s_mov_b32 s68, 0x3f803f80
  s_waitcnt lgkmcnt(3)
  v_dot2c_f32_bf16 v234, s68, v16
  v_dot2c_f32_bf16 v236, v16, v16
  v_dot2c_f32_bf16 v235, s68, v17
  v_dot2c_f32_bf16 v237, v17, v17
  v_dot2c_f32_bf16 v234, s68, v18
  v_dot2c_f32_bf16 v236, v18, v18
  v_dot2c_f32_bf16 v235, s68, v19
  v_dot2c_f32_bf16 v237, v19, v19
  s_waitcnt vmcnt(9)
  ds_read_b128 v[32:35], v226 offset:32768
  ds_read_b128 v[36:39], v227 offset:32768
  ds_read_b128 v[40:43], v228 offset:32768
  ds_read_b128 v[44:47], v229 offset:32768
  s_waitcnt lgkmcnt(6)
  v_dot2c_f32_bf16 v234, s68, v20
  v_dot2c_f32_bf16 v236, v20, v20
  v_dot2c_f32_bf16 v235, s68, v21
  v_dot2c_f32_bf16 v237, v21, v21
  v_dot2c_f32_bf16 v234, s68, v22
  v_dot2c_f32_bf16 v236, v22, v22
  v_dot2c_f32_bf16 v235, s68, v23
  v_dot2c_f32_bf16 v237, v23, v23
  s_waitcnt lgkmcnt(5)
  v_dot2c_f32_bf16 v234, s68, v24
  v_dot2c_f32_bf16 v236, v24, v24
  v_dot2c_f32_bf16 v235, s68, v25
  v_dot2c_f32_bf16 v237, v25, v25
  v_dot2c_f32_bf16 v234, s68, v26
  v_dot2c_f32_bf16 v236, v26, v26
  v_dot2c_f32_bf16 v235, s68, v27
  v_dot2c_f32_bf16 v237, v27, v27
  s_waitcnt lgkmcnt(4)
  v_dot2c_f32_bf16 v234, s68, v28
  v_dot2c_f32_bf16 v236, v28, v28
  v_dot2c_f32_bf16 v235, s68, v29
  v_dot2c_f32_bf16 v237, v29, v29
  v_dot2c_f32_bf16 v234, s68, v30
  v_dot2c_f32_bf16 v236, v30, v30
  v_dot2c_f32_bf16 v235, s68, v31
  v_dot2c_f32_bf16 v237, v31, v31
  s_add_u32 s66, s101, 5
  s_and_b32 s66, s66, 7
  s_lshl_b32 s66, s66, 7
  s_add_u32 m0, s65, 81920
  s_add_u32 s66, s66, s100
  buffer_load_dwordx4 v222, s[24:27], s66 offen lds
  buffer_load_dwordx4 v223, s[24:27], s66 offen offset:1024 lds
  buffer_load_dwordx4 v224, s[24:27], s66 offen offset:2048 lds
  buffer_load_dwordx4 v225, s[24:27], s66 offen offset:3072 lds
  s_mov_b32 s68, 0x3f803f80
  s_waitcnt lgkmcnt(3)
  v_dot2c_f32_bf16 v234, s68, v32
  v_dot2c_f32_bf16 v236, v32, v32
  v_dot2c_f32_bf16 v235, s68, v33
  v_dot2c_f32_bf16 v237, v33, v33
  v_dot2c_f32_bf16 v234, s68, v34
  v_dot2c_f32_bf16 v236, v34, v34
  v_dot2c_f32_bf16 v235, s68, v35
  v_dot2c_f32_bf16 v237, v35, v35
  s_waitcnt vmcnt(8)
  ds_read_b128 v[48:51], v226 offset:49152
  ds_read_b128 v[52:55], v227 offset:49152
  ds_read_b128 v[56:59], v228 offset:49152
  ds_read_b128 v[60:63], v229 offset:49152
  s_waitcnt lgkmcnt(6)
  v_dot2c_f32_bf16 v234, s68, v36
  v_dot2c_f32_bf16 v236, v36, v36
  v_dot2c_f32_bf16 v235, s68, v37
  v_dot2c_f32_bf16 v237, v37, v37
  v_dot2c_f32_bf16 v234, s68, v38
  v_dot2c_f32_bf16 v236, v38, v38
  v_dot2c_f32_bf16 v235, s68, v39
  v_dot2c_f32_bf16 v237, v39, v39
  s_waitcnt lgkmcnt(5)
  v_dot2c_f32_bf16 v234, s68, v40
  v_dot2c_f32_bf16 v236, v40, v40
  v_dot2c_f32_bf16 v235, s68, v41
  v_dot2c_f32_bf16 v237, v41, v41
  v_dot2c_f32_bf16 v234, s68, v42
  v_dot2c_f32_bf16 v236, v42, v42
  v_dot2c_f32_bf16 v235, s68, v43
  v_dot2c_f32_bf16 v237, v43, v43
  s_waitcnt lgkmcnt(4)
  v_dot2c_f32_bf16 v234, s68, v44
  v_dot2c_f32_bf16 v236, v44, v44
  v_dot2c_f32_bf16 v235, s68, v45
  v_dot2c_f32_bf16 v237, v45, v45
  v_dot2c_f32_bf16 v234, s68, v46
  v_dot2c_f32_bf16 v236, v46, v46
  v_dot2c_f32_bf16 v235, s68, v47
  v_dot2c_f32_bf16 v237, v47, v47
  s_add_u32 s66, s101, 6
  s_and_b32 s66, s66, 7
  s_lshl_b32 s66, s66, 7
  s_add_u32 m0, s65, 98304
  s_add_u32 s66, s66, s100
  buffer_load_dwordx4 v222, s[24:27], s66 offen lds
  buffer_load_dwordx4 v223, s[24:27], s66 offen offset:1024 lds
  buffer_load_dwordx4 v224, s[24:27], s66 offen offset:2048 lds
  buffer_load_dwordx4 v225, s[24:27], s66 offen offset:3072 lds
  s_mov_b32 s68, 0x3f803f80
  s_waitcnt lgkmcnt(3)
  v_dot2c_f32_bf16 v234, s68, v48
  v_dot2c_f32_bf16 v236, v48, v48
  v_dot2c_f32_bf16 v235, s68, v49
  v_dot2c_f32_bf16 v237, v49, v49
  v_dot2c_f32_bf16 v234, s68, v50
  v_dot2c_f32_bf16 v236, v50, v50
  v_dot2c_f32_bf16 v235, s68, v51
  v_dot2c_f32_bf16 v237, v51, v51
  s_waitcnt vmcnt(8)
  ds_read_b128 v[128:131], v230 offset:0
  ds_read_b128 v[132:135], v231 offset:0
  ds_read_b128 v[136:139], v232 offset:0
  ds_read_b128 v[140:143], v233 offset:0
  s_waitcnt lgkmcnt(6)
  v_dot2c_f32_bf16 v234, s68, v52
  v_dot2c_f32_bf16 v236, v52, v52
  v_dot2c_f32_bf16 v235, s68, v53
  v_dot2c_f32_bf16 v237, v53, v53
  v_dot2c_f32_bf16 v234, s68, v54
  v_dot2c_f32_bf16 v236, v54, v54
  v_dot2c_f32_bf16 v235, s68, v55
  v_dot2c_f32_bf16 v237, v55, v55
  s_waitcnt lgkmcnt(5)
  v_dot2c_f32_bf16 v234, s68, v56
  v_dot2c_f32_bf16 v236, v56, v56
  v_dot2c_f32_bf16 v235, s68, v57
  v_dot2c_f32_bf16 v237, v57, v57
  v_dot2c_f32_bf16 v234, s68, v58
  v_dot2c_f32_bf16 v236, v58, v58
  v_dot2c_f32_bf16 v235, s68, v59
  v_dot2c_f32_bf16 v237, v59, v59
  s_waitcnt lgkmcnt(4)
  v_dot2c_f32_bf16 v234, s68, v60
  v_dot2c_f32_bf16 v236, v60, v60
  v_dot2c_f32_bf16 v235, s68, v61
  v_dot2c_f32_bf16 v237, v61, v61
  v_dot2c_f32_bf16 v234, s68, v62
  v_dot2c_f32_bf16 v236, v62, v62
  v_dot2c_f32_bf16 v235, s68, v63
  v_dot2c_f32_bf16 v237, v63, v63
  v_mov_b32 v218, 1
  buffer_store_dword v218, v221, s[48:51], 0 offen sc1
  s_add_u32 s66, s101, 7
  s_and_b32 s66, s66, 7
  s_lshl_b32 s66, s66, 7
  s_add_u32 m0, s65, 114688
  s_add_u32 s66, s66, s100
  buffer_load_dwordx4 v222, s[24:27], s66 offen lds
  buffer_load_dwordx4 v223, s[24:27], s66 offen offset:1024 lds
  buffer_load_dwordx4 v224, s[24:27], s66 offen offset:2048 lds
  buffer_load_dwordx4 v225, s[24:27], s66 offen offset:3072 lds
  s_mov_b32 s68, 0x3f803f80
  s_waitcnt lgkmcnt(3)
  v_dot2c_f32_bf16 v234, s68, v128
  v_dot2c_f32_bf16 v236, v128, v128
  v_dot2c_f32_bf16 v235, s68, v129
  v_dot2c_f32_bf16 v237, v129, v129
  v_dot2c_f32_bf16 v234, s68, v130
  v_dot2c_f32_bf16 v236, v130, v130
  v_dot2c_f32_bf16 v235, s68, v131
  v_dot2c_f32_bf16 v237, v131, v131
  s_waitcnt vmcnt(9)
  ds_read_b128 v[144:147], v230 offset:16384
  ds_read_b128 v[148:151], v231 offset:16384
  ds_read_b128 v[152:155], v232 offset:16384
  ds_read_b128 v[156:159], v233 offset:16384
  s_waitcnt lgkmcnt(6)
  v_dot2c_f32_bf16 v234, s68, v132
  v_dot2c_f32_bf16 v236, v132, v132
  v_dot2c_f32_bf16 v235, s68, v133
  v_dot2c_f32_bf16 v237, v133, v133
  v_dot2c_f32_bf16 v234, s68, v134
  v_dot2c_f32_bf16 v236, v134, v134
  v_dot2c_f32_bf16 v235, s68, v135
  v_dot2c_f32_bf16 v237, v135, v135
  s_waitcnt lgkmcnt(5)
  v_dot2c_f32_bf16 v234, s68, v136
  v_dot2c_f32_bf16 v236, v136, v136
  v_dot2c_f32_bf16 v235, s68, v137
  v_dot2c_f32_bf16 v237, v137, v137
  v_dot2c_f32_bf16 v234, s68, v138
  v_dot2c_f32_bf16 v236, v138, v138
  v_dot2c_f32_bf16 v235, s68, v139
  v_dot2c_f32_bf16 v237, v139, v139
  s_waitcnt lgkmcnt(4)
  v_dot2c_f32_bf16 v234, s68, v140
  v_dot2c_f32_bf16 v236, v140, v140
  v_dot2c_f32_bf16 v235, s68, v141
  v_dot2c_f32_bf16 v237, v141, v141
  v_dot2c_f32_bf16 v234, s68, v142
  v_dot2c_f32_bf16 v236, v142, v142
  v_dot2c_f32_bf16 v235, s68, v143
  v_dot2c_f32_bf16 v237, v143, v143
  s_barrier
  s_add_u32 m0, s65, 131072
  s_nop 0
  buffer_load_dwordx4 v201, s[36:39], s92 offen lds
  buffer_load_dwordx4 v202, s[36:39], s92 offen offset:1024 lds
  buffer_load_dwordx4 v201, s[40:43], s92 offen offset:2048 lds
  buffer_load_dwordx4 v202, s[40:43], s92 offen offset:3072 lds
  s_mov_b32 s68, 0x3f803f80
  s_waitcnt lgkmcnt(3)
  v_dot2c_f32_bf16 v234, s68, v144
  v_dot2c_f32_bf16 v236, v144, v144
  v_dot2c_f32_bf16 v235, s68, v145
  v_dot2c_f32_bf16 v237, v145, v145
  v_dot2c_f32_bf16 v234, s68, v146
  v_dot2c_f32_bf16 v236, v146, v146
  v_dot2c_f32_bf16 v235, s68, v147
  v_dot2c_f32_bf16 v237, v147, v147
  s_waitcnt vmcnt(9)
  ds_read_b128 v[160:163], v230 offset:32768
  ds_read_b128 v[164:167], v231 offset:32768
  ds_read_b128 v[168:171], v232 offset:32768
  ds_read_b128 v[172:175], v233 offset:32768
  s_waitcnt lgkmcnt(6)
  v_dot2c_f32_bf16 v234, s68, v148
  v_dot2c_f32_bf16 v236, v148, v148
  v_dot2c_f32_bf16 v235, s68, v149
  v_dot2c_f32_bf16 v237, v149, v149
  v_dot2c_f32_bf16 v234, s68, v150
  v_dot2c_f32_bf16 v236, v150, v150
  v_dot2c_f32_bf16 v235, s68, v151
  v_dot2c_f32_bf16 v237, v151, v151
  s_waitcnt lgkmcnt(5)
  v_dot2c_f32_bf16 v234, s68, v152
  v_dot2c_f32_bf16 v236, v152, v152
  v_dot2c_f32_bf16 v235, s68, v153
  v_dot2c_f32_bf16 v237, v153, v153
  v_dot2c_f32_bf16 v234, s68, v154
  v_dot2c_f32_bf16 v236, v154, v154
  v_dot2c_f32_bf16 v235, s68, v155
  v_dot2c_f32_bf16 v237, v155, v155
  s_waitcnt lgkmcnt(4)
  v_dot2c_f32_bf16 v234, s68, v156
  v_dot2c_f32_bf16 v236, v156, v156
  v_dot2c_f32_bf16 v235, s68, v157
  v_dot2c_f32_bf16 v237, v157, v157
  v_dot2c_f32_bf16 v234, s68, v158
  v_dot2c_f32_bf16 v236, v158, v158
  v_dot2c_f32_bf16 v235, s68, v159
  v_dot2c_f32_bf16 v237, v159, v159
  s_add_u32 m0, s65, 147456
  s_nop 0
  buffer_load_dwordx4 v201, s[36:39], s93 offen lds
  buffer_load_dwordx4 v202, s[36:39], s93 offen offset:1024 lds
  buffer_load_dwordx4 v201, s[40:43], s93 offen offset:2048 lds
  buffer_load_dwordx4 v202, s[40:43], s93 offen offset:3072 lds
  s_mov_b32 s68, 0x3f803f80
  s_waitcnt lgkmcnt(3)
  v_dot2c_f32_bf16 v234, s68, v160
  v_dot2c_f32_bf16 v236, v160, v160
  v_dot2c_f32_bf16 v235, s68, v161
  v_dot2c_f32_bf16 v237, v161, v161
  v_dot2c_f32_bf16 v234, s68, v162
  v_dot2c_f32_bf16 v236, v162, v162
  v_dot2c_f32_bf16 v235, s68, v163
  v_dot2c_f32_bf16 v237, v163, v163
  s_waitcnt vmcnt(8)
  ds_read_b128 v[176:179], v230 offset:49152
  ds_read_b128 v[180:183], v231 offset:49152
  ds_read_b128 v[184:187], v232 offset:49152
  ds_read_b128 v[188:191], v233 offset:49152
  s_waitcnt lgkmcnt(6)
  v_dot2c_f32_bf16 v234, s68, v164
  v_dot2c_f32_bf16 v236, v164, v164
  v_dot2c_f32_bf16 v235, s68, v165
  v_dot2c_f32_bf16 v237, v165, v165
  v_dot2c_f32_bf16 v234, s68, v166
  v_dot2c_f32_bf16 v236, v166, v166
  v_dot2c_f32_bf16 v235, s68, v167
  v_dot2c_f32_bf16 v237, v167, v167
  s_waitcnt lgkmcnt(5)
  v_dot2c_f32_bf16 v234, s68, v168
  v_dot2c_f32_bf16 v236, v168, v168
  v_dot2c_f32_bf16 v235, s68, v169
  v_dot2c_f32_bf16 v237, v169, v169
  v_dot2c_f32_bf16 v234, s68, v170
  v_dot2c_f32_bf16 v236, v170, v170
  v_dot2c_f32_bf16 v235, s68, v171
  v_dot2c_f32_bf16 v237, v171, v171
  s_waitcnt lgkmcnt(4)
  v_dot2c_f32_bf16 v234, s68, v172
  v_dot2c_f32_bf16 v236, v172, v172
  v_dot2c_f32_bf16 v235, s68, v173
  v_dot2c_f32_bf16 v237, v173, v173
  v_dot2c_f32_bf16 v234, s68, v174
  v_dot2c_f32_bf16 v236, v174, v174
  v_dot2c_f32_bf16 v235, s68, v175
  v_dot2c_f32_bf16 v237, v175, v175
  s_add_u32 m0, s65, 0
  s_nop 0
  buffer_load_dwordx4 v201, s[36:39], s94 offen lds
  buffer_load_dwordx4 v202, s[36:39], s94 offen offset:1024 lds
  buffer_load_dwordx4 v201, s[40:43], s94 offen offset:2048 lds
  buffer_load_dwordx4 v202, s[40:43], s94 offen offset:3072 lds
  s_mov_b32 s68, 0x3f803f80
  s_waitcnt lgkmcnt(3)
  v_dot2c_f32_bf16 v234, s68, v176
  v_dot2c_f32_bf16 v236, v176, v176
  v_dot2c_f32_bf16 v235, s68, v177
  v_dot2c_f32_bf16 v237, v177, v177
  v_dot2c_f32_bf16 v234, s68, v178
  v_dot2c_f32_bf16 v236, v178, v178
  v_dot2c_f32_bf16 v235, s68, v179
  v_dot2c_f32_bf16 v237, v179, v179
  s_waitcnt lgkmcnt(2)
  v_dot2c_f32_bf16 v234, s68, v180
  v_dot2c_f32_bf16 v236, v180, v180
  v_dot2c_f32_bf16 v235, s68, v181
  v_dot2c_f32_bf16 v237, v181, v181
  v_dot2c_f32_bf16 v234, s68, v182
  v_dot2c_f32_bf16 v236, v182, v182
  v_dot2c_f32_bf16 v235, s68, v183
  v_dot2c_f32_bf16 v237, v183, v183
  s_waitcnt lgkmcnt(1)
  v_dot2c_f32_bf16 v234, s68, v184
  v_dot2c_f32_bf16 v236, v184, v184
  v_dot2c_f32_bf16 v235, s68, v185
  v_dot2c_f32_bf16 v237, v185, v185
  v_dot2c_f32_bf16 v234, s68, v186
  v_dot2c_f32_bf16 v236, v186, v186
  v_dot2c_f32_bf16 v235, s68, v187
  v_dot2c_f32_bf16 v237, v187, v187
  s_waitcnt lgkmcnt(0)
  v_dot2c_f32_bf16 v234, s68, v188
  v_dot2c_f32_bf16 v236, v188, v188
  v_dot2c_f32_bf16 v235, s68, v189
  v_dot2c_f32_bf16 v237, v189, v189
  v_dot2c_f32_bf16 v234, s68, v190
  v_dot2c_f32_bf16 v236, v190, v190
  v_dot2c_f32_bf16 v235, s68, v191
  v_dot2c_f32_bf16 v237, v191, v191
  s_waitcnt vmcnt(8)
  s_barrier
  ds_read_b64_tr_b16 a[64:65], v196 offset:0
  ds_read_b64_tr_b16 a[66:67], v196 offset:512
  ds_read_b64_tr_b16 a[68:69], v197 offset:0
  ds_read_b64_tr_b16 a[70:71], v197 offset:512
  ds_read_b64_tr_b16 a[72:73], v196 offset:2048
  ds_read_b64_tr_b16 a[74:75], v196 offset:2560
  ds_read_b64_tr_b16 a[76:77], v197 offset:2048
  ds_read_b64_tr_b16 a[78:79], v197 offset:2560
  ds_read_b64_tr_b16 a[80:81], v196 offset:4096
  ds_read_b64_tr_b16 a[82:83], v196 offset:4608
  ds_read_b64_tr_b16 a[84:85], v197 offset:4096
  ds_read_b64_tr_b16 a[86:87], v197 offset:4608
  ds_read_b64_tr_b16 a[88:89], v196 offset:6144
  ds_read_b64_tr_b16 a[90:91], v196 offset:6656
  ds_read_b64_tr_b16 a[92:93], v197 offset:6144
  ds_read_b64_tr_b16 a[94:95], v197 offset:6656
  s_and_b32 s66, s2, 1
  s_lshl_b32 s100, s66, 7
  v_add_f32 v234, v234, v235
  v_add_f32 v236, v236, v237
  v_mov_b32 v235, v234
  v_mov_b32 v237, v236
  s_nop 0
  v_permlane32_swap_b32 v234, v235
  v_permlane32_swap_b32 v236, v237
  v_add_f32 v234, v234, v235
  v_add_f32 v236, v236, v237
  v_mul_f32 v234, 0x3b000000, v234
  v_mul_f32 v236, 0x3b000000, v236
  v_fma_f32 v236, -v234, v234, v236
  v_max_f32 v236, 0, v236
  v_cvt_pk_bf16_f32 v234, v234, v236
  v_and_b32 v236, s74, v234
  v_lshlrev_b32 v234, 16, v234
  v_add_f32 v236, 0x3727c5ac, v236
  v_cvt_pk_bf16_f32 v236, v236, v236
  v_and_b32 v236, s74, v236
  v_sqrt_f32 v236, v236
  s_nop 0
  v_cvt_pk_bf16_f32 v236, v236, v236
  v_and_b32 v236, s74, v236
  v_rcp_f32 v208, v236
  s_nop 0
  v_mul_f32_e64 v207, -v234, v208
  v_lshlrev_b32 v238, 16, v0
  v_and_b32 v239, s74, v0
  v_lshlrev_b32 v240, 16, v1
  v_and_b32 v241, s74, v1
  v_lshlrev_b32 v242, 16, v2
  v_and_b32 v243, s74, v2
  v_lshlrev_b32 v244, 16, v3
  v_and_b32 v245, s74, v3
  v_fma_f32 v238, v238, v208, v207
  v_fma_f32 v239, v239, v208, v207
  v_fma_f32 v240, v240, v208, v207
  v_fma_f32 v241, v241, v208, v207
  v_fma_f32 v242, v242, v208, v207
  v_fma_f32 v243, v243, v208, v207
  v_fma_f32 v244, v244, v208, v207
  v_fma_f32 v245, v245, v208, v207
  v_cvt_pk_bf16_f32 v0, v238, v239
  v_cvt_pk_bf16_f32 v1, v240, v241
  v_cvt_pk_bf16_f32 v2, v242, v243
  v_cvt_pk_bf16_f32 v3, v244, v245
  v_lshlrev_b32 v246, 16, v4
  v_and_b32 v247, s74, v4
  v_lshlrev_b32 v248, 16, v5
  v_and_b32 v249, s74, v5
  s_waitcnt lgkmcnt(8)
  v_mfma_f32_32x32x16_bf16 v[64:79], v[0:3], a[64:67], 0
  s_add_u32 m0, s65, 16384
  ds_read_b64_tr_b16 a[96:97], v196 offset:8192
  ds_read_b64_tr_b16 a[98:99], v196 offset:8704
  buffer_load_dwordx4 v201, s[36:39], s95 offen lds
  v_lshlrev_b32 v250, 16, v6
  v_and_b32 v251, s74, v6
  v_lshlrev_b32 v252, 16, v7
  v_and_b32 v253, s74, v7
  v_fma_f32 v246, v246, v208, v207
  v_mfma_f32_32x32x16_bf16 v[80:95], v[0:3], a[68:71], 0
  ds_read_b64_tr_b16 a[100:101], v197 offset:8192
  ds_read_b64_tr_b16 a[102:103], v197 offset:8704
  buffer_load_dwordx4 v202, s[36:39], s95 offen offset:1024 lds
  v_fma_f32 v247, v247, v208, v207
  v_fma_f32 v248, v248, v208, v207
  v_fma_f32 v249, v249, v208, v207
  v_fma_f32 v250, v250, v208, v207
  v_fma_f32 v251, v251, v208, v207
  v_mfma_f32_32x32x16_bf16 v[96:111], v[0:3], a[72:75], 0
  ds_read_b64_tr_b16 a[104:105], v196 offset:10240
  ds_read_b64_tr_b16 a[106:107], v196 offset:10752
  buffer_load_dwordx4 v201, s[40:43], s95 offen offset:2048 lds
  v_fma_f32 v252, v252, v208, v207
  v_fma_f32 v253, v253, v208, v207
  v_cvt_pk_bf16_f32 v4, v246, v247
  v_cvt_pk_bf16_f32 v5, v248, v249
  v_cvt_pk_bf16_f32 v6, v250, v251
  v_mfma_f32_32x32x16_bf16 v[112:127], v[0:3], a[76:79], 0
  s_waitcnt lgkmcnt(6)
  ds_read_b64_tr_b16 a[108:109], v197 offset:10240
  ds_read_b64_tr_b16 a[110:111], v197 offset:10752
  buffer_load_dwordx4 v202, s[40:43], s95 offen offset:3072 lds
  v_cvt_pk_bf16_f32 v7, v252, v253
  v_lshlrev_b32 v238, 16, v8
  v_and_b32 v239, s74, v8
  v_lshlrev_b32 v240, 16, v9
  v_and_b32 v241, s74, v9
  v_mfma_f32_32x32x16_bf16 v[64:79], v[4:7], a[80:83], v[64:79]
  s_add_u32 m0, s65, 32768
  s_add_u32 s0, s15, 0
  s_and_b32 s0, s0, 524287
  ds_read_b64_tr_b16 a[64:65], v196 offset:12288
  ds_read_b64_tr_b16 a[66:67], v196 offset:12800
  buffer_load_dwordx4 v210, s[52:55], s0 offen lds
  v_lshlrev_b32 v242, 16, v10
  v_and_b32 v243, s74, v10
  v_lshlrev_b32 v244, 16, v11
  v_and_b32 v245, s74, v11
  v_fma_f32 v238, v238, v208, v207
  v_mfma_f32_32x32x16_bf16 v[80:95], v[4:7], a[84:87], v[80:95]
  ds_read_b64_tr_b16 a[68:69], v197 offset:12288
  ds_read_b64_tr_b16 a[70:71], v197 offset:12800
  buffer_load_dwordx4 v211, s[52:55], s0 offen offset:1024 lds
  v_fma_f32 v239, v239, v208, v207
  v_fma_f32 v240, v240, v208, v207
  v_fma_f32 v241, v241, v208, v207
  v_fma_f32 v242, v242, v208, v207
  v_fma_f32 v243, v243, v208, v207
  v_mfma_f32_32x32x16_bf16 v[96:111], v[4:7], a[88:91], v[96:111]
  s_add_u32 s0, s0, 63488
  ds_read_b64_tr_b16 a[72:73], v196 offset:14336
  ds_read_b64_tr_b16 a[74:75], v196 offset:14848
  buffer_load_dwordx4 v210, s[52:55], s0 offen offset:2048 lds
  v_fma_f32 v244, v244, v208, v207
  v_fma_f32 v245, v245, v208, v207
  v_cvt_pk_bf16_f32 v8, v238, v239
  v_cvt_pk_bf16_f32 v9, v240, v241
  v_cvt_pk_bf16_f32 v10, v242, v243
  v_mfma_f32_32x32x16_bf16 v[112:127], v[4:7], a[92:95], v[112:127]
  s_waitcnt lgkmcnt(6)
  ds_read_b64_tr_b16 a[76:77], v197 offset:14336
  ds_read_b64_tr_b16 a[78:79], v197 offset:14848
  buffer_load_dwordx4 v211, s[52:55], s0 offen offset:3072 lds
  v_cvt_pk_bf16_f32 v11, v244, v245
  v_lshlrev_b32 v246, 16, v12
  v_and_b32 v247, s74, v12
  v_lshlrev_b32 v248, 16, v13
  v_and_b32 v249, s74, v13
  v_mfma_f32_32x32x16_bf16 v[64:79], v[8:11], a[96:99], v[64:79]
  s_mul_i32 s66, s2, 2048
  s_lshl_b32 s67, s64, 7
  s_mul_i32 s67, s67, 4
  s_add_u32 s66, s66, s67
  s_add_u32 s66, s66, 0
  v_min_u32 v235, 48, v200
  v_lshlrev_b32 v235, 3, v235
  buffer_load_dword a232, v235, s[52:55], s66 offen offset:0
  s_mul_i32 s66, s2, 2048
  s_lshl_b32 s67, s64, 7
  s_mul_i32 s67, s67, 4
  s_add_u32 s66, s66, s67
  s_add_u32 s66, s66, 524288
  v_min_u32 v235, 48, v200
  v_lshlrev_b32 v235, 3, v235
  buffer_load_dword a233, v235, s[52:55], s66 offen offset:0
  s_mul_i32 s66, s2, 3072
  s_lshl_b32 s67, s64, 7
  s_mul_i32 s67, s67, 6
  s_add_u32 s66, s66, s67
  s_add_u32 s66, s66, 1048576
  v_min_u32 v235, 80, v200
  v_lshlrev_b32 v235, 3, v235
  buffer_load_dword a234, v235, s[52:55], s66 offen offset:0
  s_mul_i32 s66, s2, 2048
  s_lshl_b32 s67, s64, 7
  s_mul_i32 s67, s67, 4
  s_add_u32 s66, s66, s67
  s_add_u32 s66, s66, 0
  v_min_u32 v235, 48, v200
  v_lshlrev_b32 v235, 3, v235
  buffer_load_dword a235, v235, s[56:59], s66 offen offset:0
  s_waitcnt vmcnt(16)
  s_barrier
  ds_read_b64_tr_b16 a[80:81], v196 offset:16384
  ds_read_b64_tr_b16 a[82:83], v196 offset:16896
  v_lshlrev_b32 v250, 16, v14
  v_and_b32 v251, s74, v14
  v_lshlrev_b32 v252, 16, v15
  v_and_b32 v253, s74, v15
  v_fma_f32 v246, v246, v208, v207
  v_mfma_f32_32x32x16_bf16 v[80:95], v[8:11], a[100:103], v[80:95]
  s_add_u32 m0, s65, 49152
  ds_read_b64_tr_b16 a[84:85], v197 offset:16384
  ds_read_b64_tr_b16 a[86:87], v197 offset:16896
  buffer_load_dwordx4 v201, s[36:39], s96 offen lds
  v_fma_f32 v247, v247, v208, v207
  v_fma_f32 v248, v248, v208, v207
  v_fma_f32 v249, v249, v208, v207
  v_fma_f32 v250, v250, v208, v207
  v_fma_f32 v251, v251, v208, v207
  v_mfma_f32_32x32x16_bf16 v[96:111], v[8:11], a[104:107], v[96:111]
  ds_read_b64_tr_b16 a[88:89], v196 offset:18432
  ds_read_b64_tr_b16 a[90:91], v196 offset:18944
  v_fma_f32 v252, v252, v208, v207
  v_fma_f32 v253, v253, v208, v207
  v_cvt_pk_bf16_f32 v12, v246, v247
  v_cvt_pk_bf16_f32 v13, v248, v249
  v_cvt_pk_bf16_f32 v14, v250, v251
  v_mfma_f32_32x32x16_bf16 v[112:127], v[8:11], a[108:111], v[112:127]
  s_waitcnt lgkmcnt(6)
  ds_read_b64_tr_b16 a[92:93], v197 offset:18432
  ds_read_b64_tr_b16 a[94:95], v197 offset:18944
  buffer_load_dwordx4 v202, s[36:39], s96 offen offset:1024 lds
  v_cvt_pk_bf16_f32 v15, v252, v253
  v_lshlrev_b32 v238, 16, v16
  v_and_b32 v239, s74, v16
  v_lshlrev_b32 v240, 16, v17
  v_and_b32 v241, s74, v17
  v_mfma_f32_32x32x16_bf16 v[64:79], v[12:15], a[64:67], v[64:79]
  ds_read_b64_tr_b16 a[96:97], v196 offset:20480
  ds_read_b64_tr_b16 a[98:99], v196 offset:20992
  v_lshlrev_b32 v242, 16, v18
  v_and_b32 v243, s74, v18
  v_lshlrev_b32 v244, 16, v19
  v_and_b32 v245, s74, v19
  v_fma_f32 v238, v238, v208, v207
  v_mfma_f32_32x32x16_bf16 v[80:95], v[12:15], a[68:71], v[80:95]
  ds_read_b64_tr_b16 a[100:101], v197 offset:20480
  ds_read_b64_tr_b16 a[102:103], v197 offset:20992
  buffer_load_dwordx4 v201, s[40:43], s96 offen offset:2048 lds
  v_fma_f32 v239, v239, v208, v207
  v_fma_f32 v240, v240, v208, v207
  v_fma_f32 v241, v241, v208, v207
  v_fma_f32 v242, v242, v208, v207
  v_fma_f32 v243, v243, v208, v207
  v_mfma_f32_32x32x16_bf16 v[96:111], v[12:15], a[72:75], v[96:111]
  ds_read_b64_tr_b16 a[104:105], v196 offset:22528
  ds_read_b64_tr_b16 a[106:107], v196 offset:23040
  v_fma_f32 v244, v244, v208, v207
  v_fma_f32 v245, v245, v208, v207
  v_cvt_pk_bf16_f32 v16, v238, v239
  v_cvt_pk_bf16_f32 v17, v240, v241
  v_cvt_pk_bf16_f32 v18, v242, v243
  v_mfma_f32_32x32x16_bf16 v[112:127], v[12:15], a[76:79], v[112:127]
  s_waitcnt lgkmcnt(6)
  ds_read_b64_tr_b16 a[108:109], v197 offset:22528
  ds_read_b64_tr_b16 a[110:111], v197 offset:23040
  buffer_load_dwordx4 v202, s[40:43], s96 offen offset:3072 lds
  v_cvt_pk_bf16_f32 v19, v244, v245
  v_lshlrev_b32 v246, 16, v20
  v_and_b32 v247, s74, v20
  v_lshlrev_b32 v248, 16, v21
  v_and_b32 v249, s74, v21
  v_mfma_f32_32x32x16_bf16 v[64:79], v[16:19], a[80:83], v[64:79]
  ds_read_b64_tr_b16 a[64:65], v196 offset:24576
  ds_read_b64_tr_b16 a[66:67], v196 offset:25088
  v_lshlrev_b32 v250, 16, v22
  v_and_b32 v251, s74, v22
  v_lshlrev_b32 v252, 16, v23
  v_and_b32 v253, s74, v23
  v_fma_f32 v246, v246, v208, v207
  v_mfma_f32_32x32x16_bf16 v[80:95], v[16:19], a[84:87], v[80:95]
  s_add_u32 m0, s65, 65536
  s_add_u32 s0, s15, 131072
  s_and_b32 s0, s0, 524287
  ds_read_b64_tr_b16 a[68:69], v197 offset:24576
  ds_read_b64_tr_b16 a[70:71], v197 offset:25088
  buffer_load_dwordx4 v210, s[52:55], s0 offen lds
  v_fma_f32 v247, v247, v208, v207
  v_fma_f32 v248, v248, v208, v207
  v_fma_f32 v249, v249, v208, v207
  v_fma_f32 v250, v250, v208, v207
  v_fma_f32 v251, v251, v208, v207
  v_mfma_f32_32x32x16_bf16 v[96:111], v[16:19], a[88:91], v[96:111]
  ds_read_b64_tr_b16 a[72:73], v196 offset:26624
  ds_read_b64_tr_b16 a[74:75], v196 offset:27136
  v_fma_f32 v252, v252, v208, v207
  v_fma_f32 v253, v253, v208, v207
  v_cvt_pk_bf16_f32 v20, v246, v247
  v_cvt_pk_bf16_f32 v21, v248, v249
  v_cvt_pk_bf16_f32 v22, v250, v251
  v_mfma_f32_32x32x16_bf16 v[112:127], v[16:19], a[92:95], v[112:127]
  s_waitcnt lgkmcnt(6)
  ds_read_b64_tr_b16 a[76:77], v197 offset:26624
  ds_read_b64_tr_b16 a[78:79], v197 offset:27136
  buffer_load_dwordx4 v211, s[52:55], s0 offen offset:1024 lds
  v_cvt_pk_bf16_f32 v23, v252, v253
  v_lshlrev_b32 v238, 16, v24
  v_and_b32 v239, s74, v24
  v_lshlrev_b32 v240, 16, v25
  v_and_b32 v241, s74, v25
  v_mfma_f32_32x32x16_bf16 v[64:79], v[20:23], a[96:99], v[64:79]
  ds_read_b64_tr_b16 a[80:81], v196 offset:28672
  ds_read_b64_tr_b16 a[82:83], v196 offset:29184
  v_lshlrev_b32 v242, 16, v26
  v_and_b32 v243, s74, v26
  v_lshlrev_b32 v244, 16, v27
  v_and_b32 v245, s74, v27
  v_fma_f32 v238, v238, v208, v207
  v_mfma_f32_32x32x16_bf16 v[80:95], v[20:23], a[100:103], v[80:95]
  s_add_u32 s0, s0, 63488
  ds_read_b64_tr_b16 a[84:85], v197 offset:28672
  ds_read_b64_tr_b16 a[86:87], v197 offset:29184
  buffer_load_dwordx4 v210, s[52:55], s0 offen offset:2048 lds
  v_fma_f32 v239, v239, v208, v207
  v_fma_f32 v240, v240, v208, v207
  v_fma_f32 v241, v241, v208, v207
  v_fma_f32 v242, v242, v208, v207
  v_fma_f32 v243, v243, v208, v207
  v_mfma_f32_32x32x16_bf16 v[96:111], v[20:23], a[104:107], v[96:111]
  ds_read_b64_tr_b16 a[88:89], v196 offset:30720
  ds_read_b64_tr_b16 a[90:91], v196 offset:31232
  v_fma_f32 v244, v244, v208, v207
  v_fma_f32 v245, v245, v208, v207
  v_cvt_pk_bf16_f32 v24, v238, v239
  v_cvt_pk_bf16_f32 v25, v240, v241
  v_cvt_pk_bf16_f32 v26, v242, v243
  v_mfma_f32_32x32x16_bf16 v[112:127], v[20:23], a[108:111], v[112:127]
  s_waitcnt lgkmcnt(6)
  ds_read_b64_tr_b16 a[92:93], v197 offset:30720
  ds_read_b64_tr_b16 a[94:95], v197 offset:31232
  buffer_load_dwordx4 v211, s[52:55], s0 offen offset:3072 lds
  v_cvt_pk_bf16_f32 v27, v244, v245
  v_lshlrev_b32 v246, 16, v28
  v_and_b32 v247, s74, v28
  v_lshlrev_b32 v248, 16, v29
  v_and_b32 v249, s74, v29
  v_mfma_f32_32x32x16_bf16 v[64:79], v[24:27], a[64:67], v[64:79]
  s_waitcnt vmcnt(20)
  s_barrier
  ds_read_b64_tr_b16 a[96:97], v192 offset:0
  ds_read_b64_tr_b16 a[98:99], v192 offset:512
  v_lshlrev_b32 v250, 16, v30
  v_and_b32 v251, s74, v30
  v_lshlrev_b32 v252, 16, v31
  v_and_b32 v253, s74, v31
  v_fma_f32 v246, v246, v208, v207
  v_mfma_f32_32x32x16_bf16 v[80:95], v[24:27], a[68:71], v[80:95]
  s_add_u32 m0, s65, 131072
  ds_read_b64_tr_b16 a[100:101], v193 offset:0
  ds_read_b64_tr_b16 a[102:103], v193 offset:512
  buffer_load_dwordx4 v201, s[36:39], s97 offen lds
  v_fma_f32 v247, v247, v208, v207
  v_fma_f32 v248, v248, v208, v207
  v_fma_f32 v249, v249, v208, v207
  v_fma_f32 v250, v250, v208, v207
  v_fma_f32 v251, v251, v208, v207
  v_mfma_f32_32x32x16_bf16 v[96:111], v[24:27], a[72:75], v[96:111]
  ds_read_b64_tr_b16 a[104:105], v192 offset:2048
  ds_read_b64_tr_b16 a[106:107], v192 offset:2560
  v_fma_f32 v252, v252, v208, v207
  v_fma_f32 v253, v253, v208, v207
  v_cvt_pk_bf16_f32 v28, v246, v247
  v_cvt_pk_bf16_f32 v29, v248, v249
  v_cvt_pk_bf16_f32 v30, v250, v251
  v_mfma_f32_32x32x16_bf16 v[112:127], v[24:27], a[76:79], v[112:127]
  s_waitcnt lgkmcnt(6)
  ds_read_b64_tr_b16 a[108:109], v193 offset:2048
  ds_read_b64_tr_b16 a[110:111], v193 offset:2560
  buffer_load_dwordx4 v202, s[36:39], s97 offen offset:1024 lds
  v_cvt_pk_bf16_f32 v31, v252, v253
  v_lshlrev_b32 v238, 16, v32
  v_and_b32 v239, s74, v32
  v_lshlrev_b32 v240, 16, v33
  v_and_b32 v241, s74, v33
  v_mfma_f32_32x32x16_bf16 v[64:79], v[28:31], a[80:83], v[64:79]
  ds_read_b64_tr_b16 a[64:65], v192 offset:4096
  ds_read_b64_tr_b16 a[66:67], v192 offset:4608
  v_lshlrev_b32 v242, 16, v34
  v_and_b32 v243, s74, v34
  v_lshlrev_b32 v244, 16, v35
  v_and_b32 v245, s74, v35
  v_fma_f32 v238, v238, v208, v207
  v_mfma_f32_32x32x16_bf16 v[80:95], v[28:31], a[84:87], v[80:95]
  ds_read_b64_tr_b16 a[68:69], v193 offset:4096
  ds_read_b64_tr_b16 a[70:71], v193 offset:4608
  buffer_load_dwordx4 v201, s[40:43], s97 offen offset:2048 lds
  v_fma_f32 v239, v239, v208, v207
  v_fma_f32 v240, v240, v208, v207
  v_fma_f32 v241, v241, v208, v207
  v_fma_f32 v242, v242, v208, v207
  v_fma_f32 v243, v243, v208, v207
  v_mfma_f32_32x32x16_bf16 v[96:111], v[28:31], a[88:91], v[96:111]
  ds_read_b64_tr_b16 a[72:73], v192 offset:6144
  ds_read_b64_tr_b16 a[74:75], v192 offset:6656
  v_fma_f32 v244, v244, v208, v207
  v_fma_f32 v245, v245, v208, v207
  v_cvt_pk_bf16_f32 v32, v238, v239
  v_cvt_pk_bf16_f32 v33, v240, v241
  v_cvt_pk_bf16_f32 v34, v242, v243
  v_mfma_f32_32x32x16_bf16 v[112:127], v[28:31], a[92:95], v[112:127]
  s_waitcnt lgkmcnt(6)
  ds_read_b64_tr_b16 a[76:77], v193 offset:6144
  ds_read_b64_tr_b16 a[78:79], v193 offset:6656
  buffer_load_dwordx4 v202, s[40:43], s97 offen offset:3072 lds
  v_cvt_pk_bf16_f32 v35, v244, v245
  v_lshlrev_b32 v246, 16, v36
  v_and_b32 v247, s74, v36
  v_lshlrev_b32 v248, 16, v37
  v_and_b32 v249, s74, v37
  v_mfma_f32_32x32x16_bf16 v[64:79], v[32:35], a[96:99], v[64:79]
  s_add_u32 m0, s65, 81920
  s_add_u32 s0, s15, 262144
  s_and_b32 s0, s0, 524287
  ds_read_b64_tr_b16 a[80:81], v192 offset:8192
  ds_read_b64_tr_b16 a[82:83], v192 offset:8704
  buffer_load_dwordx4 v210, s[52:55], s0 offen lds
  v_lshlrev_b32 v250, 16, v38
  v_and_b32 v251, s74, v38
  v_lshlrev_b32 v252, 16, v39
  v_and_b32 v253, s74, v39
  v_fma_f32 v246, v246, v208, v207
  v_mfma_f32_32x32x16_bf16 v[80:95], v[32:35], a[100:103], v[80:95]
  ds_read_b64_tr_b16 a[84:85], v193 offset:8192
  ds_read_b64_tr_b16 a[86:87], v193 offset:8704
  v_fma_f32 v247, v247, v208, v207
  v_fma_f32 v248, v248, v208, v207
  v_fma_f32 v249, v249, v208, v207
  v_fma_f32 v250, v250, v208, v207
  v_fma_f32 v251, v251, v208, v207
  v_mfma_f32_32x32x16_bf16 v[96:111], v[32:35], a[104:107], v[96:111]
  ds_read_b64_tr_b16 a[88:89], v192 offset:10240
  ds_read_b64_tr_b16 a[90:91], v192 offset:10752
  buffer_load_dwordx4 v211, s[52:55], s0 offen offset:1024 lds
  v_fma_f32 v252, v252, v208, v207
  v_fma_f32 v253, v253, v208, v207
  v_cvt_pk_bf16_f32 v36, v246, v247
  v_cvt_pk_bf16_f32 v37, v248, v249
  v_cvt_pk_bf16_f32 v38, v250, v251
  v_mfma_f32_32x32x16_bf16 v[112:127], v[32:35], a[108:111], v[112:127]
  s_waitcnt lgkmcnt(6)
  ds_read_b64_tr_b16 a[92:93], v193 offset:10240
  ds_read_b64_tr_b16 a[94:95], v193 offset:10752
  v_cvt_pk_bf16_f32 v39, v252, v253
  v_lshlrev_b32 v238, 16, v40
  v_and_b32 v239, s74, v40
  v_lshlrev_b32 v240, 16, v41
  v_and_b32 v241, s74, v41
  v_mfma_f32_32x32x16_bf16 v[64:79], v[36:39], a[64:67], v[64:79]
  s_add_u32 s0, s0, 63488
  ds_read_b64_tr_b16 a[96:97], v192 offset:12288
  ds_read_b64_tr_b16 a[98:99], v192 offset:12800
  buffer_load_dwordx4 v210, s[52:55], s0 offen offset:2048 lds
  v_lshlrev_b32 v242, 16, v42
  v_and_b32 v243, s74, v42
  v_lshlrev_b32 v244, 16, v43
  v_and_b32 v245, s74, v43
  v_fma_f32 v238, v238, v208, v207
  v_mfma_f32_32x32x16_bf16 v[80:95], v[36:39], a[68:71], v[80:95]
  ds_read_b64_tr_b16 a[100:101], v193 offset:12288
  ds_read_b64_tr_b16 a[102:103], v193 offset:12800
  v_fma_f32 v239, v239, v208, v207
  v_fma_f32 v240, v240, v208, v207
  v_fma_f32 v241, v241, v208, v207
  v_fma_f32 v242, v242, v208, v207
  v_fma_f32 v243, v243, v208, v207
  v_mfma_f32_32x32x16_bf16 v[96:111], v[36:39], a[72:75], v[96:111]
  ds_read_b64_tr_b16 a[104:105], v192 offset:14336
  ds_read_b64_tr_b16 a[106:107], v192 offset:14848
  buffer_load_dwordx4 v211, s[52:55], s0 offen offset:3072 lds
  v_fma_f32 v244, v244, v208, v207
  v_fma_f32 v245, v245, v208, v207
  v_cvt_pk_bf16_f32 v40, v238, v239
  v_cvt_pk_bf16_f32 v41, v240, v241
  v_cvt_pk_bf16_f32 v42, v242, v243
  v_mfma_f32_32x32x16_bf16 v[112:127], v[36:39], a[76:79], v[112:127]
  s_waitcnt lgkmcnt(6)
  ds_read_b64_tr_b16 a[108:109], v193 offset:14336
  ds_read_b64_tr_b16 a[110:111], v193 offset:14848
  v_cvt_pk_bf16_f32 v43, v244, v245
  v_lshlrev_b32 v246, 16, v44
  v_and_b32 v247, s74, v44
  v_lshlrev_b32 v248, 16, v45
  v_and_b32 v249, s74, v45
  v_mfma_f32_32x32x16_bf16 v[64:79], v[40:43], a[80:83], v[64:79]
  s_waitcnt vmcnt(24)
  s_barrier
  buffer_load_dword v221, v209, s[48:51], s100 offen sc1
  s_add_u32 m0, s65, 147456
  ds_read_b64_tr_b16 a[64:65], v192 offset:16384
  ds_read_b64_tr_b16 a[66:67], v192 offset:16896
  buffer_load_dwordx4 v201, s[36:39], s98 offen lds
  v_lshlrev_b32 v250, 16, v46
  v_and_b32 v251, s74, v46
  v_lshlrev_b32 v252, 16, v47
  v_and_b32 v253, s74, v47
  v_fma_f32 v246, v246, v208, v207
  v_mfma_f32_32x32x16_bf16 v[80:95], v[40:43], a[84:87], v[80:95]
  ds_read_b64_tr_b16 a[68:69], v193 offset:16384
  ds_read_b64_tr_b16 a[70:71], v193 offset:16896
  buffer_load_dwordx4 v202, s[36:39], s98 offen offset:1024 lds
  v_fma_f32 v247, v247, v208, v207
  v_fma_f32 v248, v248, v208, v207
  v_fma_f32 v249, v249, v208, v207
  v_fma_f32 v250, v250, v208, v207
  v_fma_f32 v251, v251, v208, v207
  v_mfma_f32_32x32x16_bf16 v[96:111], v[40:43], a[88:91], v[96:111]
  ds_read_b64_tr_b16 a[72:73], v192 offset:18432
  ds_read_b64_tr_b16 a[74:75], v192 offset:18944
  v_fma_f32 v252, v252, v208, v207
  v_fma_f32 v253, v253, v208, v207
  v_cvt_pk_bf16_f32 v44, v246, v247
  v_cvt_pk_bf16_f32 v45, v248, v249
  v_cvt_pk_bf16_f32 v46, v250, v251
  v_mfma_f32_32x32x16_bf16 v[112:127], v[40:43], a[92:95], v[112:127]
  s_waitcnt lgkmcnt(6)
  ds_read_b64_tr_b16 a[76:77], v193 offset:18432
  ds_read_b64_tr_b16 a[78:79], v193 offset:18944
  buffer_load_dwordx4 v201, s[40:43], s98 offen offset:2048 lds
  v_cvt_pk_bf16_f32 v47, v252, v253
  v_lshlrev_b32 v238, 16, v48
  v_and_b32 v239, s74, v48
  v_lshlrev_b32 v240, 16, v49
  v_and_b32 v241, s74, v49
  v_mfma_f32_32x32x16_bf16 v[64:79], v[44:47], a[96:99], v[64:79]
  s_waitcnt vmcnt(24)
  ds_read_b64_tr_b16 a[80:81], v192 offset:20480
  ds_read_b64_tr_b16 a[82:83], v192 offset:20992
  ds_read_b64_tr_b16 a[112:113], v212 offset:32768
  v_lshlrev_b32 v242, 16, v50
  v_and_b32 v243, s74, v50
  v_lshlrev_b32 v244, 16, v51
  v_and_b32 v245, s74, v51
  v_fma_f32 v238, v238, v208, v207
  v_mfma_f32_32x32x16_bf16 v[80:95], v[44:47], a[100:103], v[80:95]
  ds_read_b64_tr_b16 a[84:85], v193 offset:20480
  ds_read_b64_tr_b16 a[86:87], v193 offset:20992
  ds_read_b64_tr_b16 a[114:115], v212 offset:33792
  buffer_load_dwordx4 v202, s[40:43], s98 offen offset:3072 lds
  v_fma_f32 v239, v239, v208, v207
  v_fma_f32 v240, v240, v208, v207
  v_fma_f32 v241, v241, v208, v207
  v_fma_f32 v242, v242, v208, v207
  v_fma_f32 v243, v243, v208, v207
  v_mfma_f32_32x32x16_bf16 v[96:111], v[44:47], a[104:107], v[96:111]
  ds_read_b64_tr_b16 a[88:89], v192 offset:22528
  ds_read_b64_tr_b16 a[90:91], v192 offset:23040
  ds_read_b64_tr_b16 a[116:117], v213 offset:32768
  v_fma_f32 v244, v244, v208, v207
  v_fma_f32 v245, v245, v208, v207
  v_cvt_pk_bf16_f32 v48, v238, v239
  v_cvt_pk_bf16_f32 v49, v240, v241
  v_cvt_pk_bf16_f32 v50, v242, v243
  v_mfma_f32_32x32x16_bf16 v[112:127], v[44:47], a[108:111], v[112:127]
  s_waitcnt lgkmcnt(9)
  s_add_u32 m0, s65, 98304
  s_add_u32 s0, s15, 393216
  s_and_b32 s0, s0, 524287
  ds_read_b64_tr_b16 a[92:93], v193 offset:22528
  ds_read_b64_tr_b16 a[94:95], v193 offset:23040
  ds_read_b64_tr_b16 a[118:119], v213 offset:33792
  buffer_load_dwordx4 v210, s[52:55], s0 offen lds
  v_cvt_pk_bf16_f32 v51, v244, v245
  v_lshlrev_b32 v246, 16, v52
  v_and_b32 v247, s74, v52
  v_lshlrev_b32 v248, 16, v53
  v_and_b32 v249, s74, v53
  v_mfma_f32_32x32x16_bf16 v[64:79], v[48:51], a[64:67], v[64:79]
  ds_read_b64_tr_b16 a[96:97], v192 offset:24576
  ds_read_b64_tr_b16 a[98:99], v192 offset:25088
  ds_read_b64_tr_b16 a[120:121], v212 offset:34816
  buffer_load_dwordx4 v211, s[52:55], s0 offen offset:1024 lds
  v_lshlrev_b32 v250, 16, v54
  v_and_b32 v251, s74, v54
  v_lshlrev_b32 v252, 16, v55
  v_and_b32 v253, s74, v55
  v_fma_f32 v246, v246, v208, v207
  v_mfma_f32_32x32x16_bf16 v[80:95], v[48:51], a[68:71], v[80:95]
  ds_read_b64_tr_b16 a[100:101], v193 offset:24576
  ds_read_b64_tr_b16 a[102:103], v193 offset:25088
  ds_read_b64_tr_b16 a[122:123], v212 offset:35840
  v_fma_f32 v247, v247, v208, v207
  v_fma_f32 v248, v248, v208, v207
  v_fma_f32 v249, v249, v208, v207
  v_fma_f32 v250, v250, v208, v207
  v_fma_f32 v251, v251, v208, v207
  v_mfma_f32_32x32x16_bf16 v[96:111], v[48:51], a[72:75], v[96:111]
  s_add_u32 s0, s0, 63488
  ds_read_b64_tr_b16 a[104:105], v192 offset:26624
  ds_read_b64_tr_b16 a[106:107], v192 offset:27136
  ds_read_b64_tr_b16 a[124:125], v213 offset:34816
  buffer_load_dwordx4 v210, s[52:55], s0 offen offset:2048 lds
  v_fma_f32 v252, v252, v208, v207
  v_fma_f32 v253, v253, v208, v207
  v_cvt_pk_bf16_f32 v52, v246, v247
  v_cvt_pk_bf16_f32 v53, v248, v249
  v_cvt_pk_bf16_f32 v54, v250, v251
  v_mfma_f32_32x32x16_bf16 v[112:127], v[48:51], a[76:79], v[112:127]
  s_waitcnt lgkmcnt(10)
  ds_read_b64_tr_b16 a[108:109], v193 offset:26624
  ds_read_b64_tr_b16 a[110:111], v193 offset:27136
  ds_read_b64_tr_b16 a[126:127], v213 offset:35840
  buffer_load_dwordx4 v211, s[52:55], s0 offen offset:3072 lds
  v_cvt_pk_bf16_f32 v55, v252, v253
  v_lshlrev_b32 v238, 16, v56
  v_and_b32 v239, s74, v56
  v_lshlrev_b32 v240, 16, v57
  v_and_b32 v241, s74, v57
  v_mfma_f32_32x32x16_bf16 v[64:79], v[52:55], a[80:83], v[64:79]
  ds_read_b64_tr_b16 a[64:65], v192 offset:28672
  ds_read_b64_tr_b16 a[66:67], v192 offset:29184
  v_lshlrev_b32 v242, 16, v58
  v_and_b32 v243, s74, v58
  v_lshlrev_b32 v244, 16, v59
  v_and_b32 v245, s74, v59
  v_fma_f32 v238, v238, v208, v207
  v_mfma_f32_32x32x16_bf16 v[80:95], v[52:55], a[84:87], v[80:95]
  ds_read_b64_tr_b16 a[68:69], v193 offset:28672
  ds_read_b64_tr_b16 a[70:71], v193 offset:29184
  v_fma_f32 v239, v239, v208, v207
  v_fma_f32 v240, v240, v208, v207
  v_fma_f32 v241, v241, v208, v207
  v_fma_f32 v242, v242, v208, v207
  v_fma_f32 v243, v243, v208, v207
  v_mfma_f32_32x32x16_bf16 v[96:111], v[52:55], a[88:91], v[96:111]
  ds_read_b64_tr_b16 a[72:73], v192 offset:30720
  ds_read_b64_tr_b16 a[74:75], v192 offset:31232
  v_fma_f32 v244, v244, v208, v207
  v_fma_f32 v245, v245, v208, v207
  v_cvt_pk_bf16_f32 v56, v238, v239
  v_cvt_pk_bf16_f32 v57, v240, v241
  v_cvt_pk_bf16_f32 v58, v242, v243
  v_mfma_f32_32x32x16_bf16 v[112:127], v[52:55], a[92:95], v[112:127]
  s_waitcnt lgkmcnt(7)
  ds_read_b64_tr_b16 a[76:77], v193 offset:30720
  ds_read_b64_tr_b16 a[78:79], v193 offset:31232
  v_cvt_pk_bf16_f32 v59, v244, v245
  v_lshlrev_b32 v246, 16, v60
  v_and_b32 v247, s74, v60
  v_lshlrev_b32 v248, 16, v61
  v_and_b32 v249, s74, v61
  v_mfma_f32_32x32x16_bf16 v[64:79], v[56:59], a[96:99], v[64:79]
  s_waitcnt vmcnt(21)
  s_barrier
  s_add_u32 m0, s65, 0
  ds_read_b64_tr_b16 a[80:81], v192 offset:49152
  ds_read_b64_tr_b16 a[82:83], v192 offset:49664
  buffer_load_dwordx4 v201, s[36:39], s99 offen lds
  v_lshlrev_b32 v250, 16, v62
  v_and_b32 v251, s74, v62
  v_lshlrev_b32 v252, 16, v63
  v_and_b32 v253, s74, v63
  v_fma_f32 v246, v246, v208, v207
  v_mfma_f32_32x32x16_bf16 v[80:95], v[56:59], a[100:103], v[80:95]
  ds_read_b64_tr_b16 a[84:85], v193 offset:49152
  ds_read_b64_tr_b16 a[86:87], v193 offset:49664
  buffer_load_dwordx4 v202, s[36:39], s99 offen offset:1024 lds
  v_fma_f32 v247, v247, v208, v207
  v_fma_f32 v248, v248, v208, v207
  v_fma_f32 v249, v249, v208, v207
  v_fma_f32 v250, v250, v208, v207
  v_fma_f32 v251, v251, v208, v207
  v_mfma_f32_32x32x16_bf16 v[96:111], v[56:59], a[104:107], v[96:111]
  ds_read_b64_tr_b16 a[88:89], v192 offset:51200
  ds_read_b64_tr_b16 a[90:91], v192 offset:51712
  buffer_load_dwordx4 v201, s[40:43], s99 offen offset:2048 lds
  v_fma_f32 v252, v252, v208, v207
  v_fma_f32 v253, v253, v208, v207
  v_cvt_pk_bf16_f32 v60, v246, v247
  v_cvt_pk_bf16_f32 v61, v248, v249
  v_cvt_pk_bf16_f32 v62, v250, v251
  v_mfma_f32_32x32x16_bf16 v[112:127], v[56:59], a[108:111], v[112:127]
  s_waitcnt lgkmcnt(6)
  ds_read_b64_tr_b16 a[92:93], v193 offset:51200
  ds_read_b64_tr_b16 a[94:95], v193 offset:51712
  buffer_load_dwordx4 v202, s[40:43], s99 offen offset:3072 lds
  v_cvt_pk_bf16_f32 v63, v252, v253
  v_lshlrev_b32 v238, 16, v128
  v_and_b32 v239, s74, v128
  v_lshlrev_b32 v240, 16, v129
  v_and_b32 v241, s74, v129
  v_mfma_f32_32x32x16_bf16 v[64:79], v[60:63], a[64:67], v[64:79]
  s_waitcnt vmcnt(21)
  ds_read_b64_tr_b16 a[96:97], v192 offset:53248
  ds_read_b64_tr_b16 a[98:99], v192 offset:53760
  ds_read_b64_tr_b16 a[128:129], v214 offset:0
  v_lshlrev_b32 v242, 16, v130
  v_and_b32 v243, s74, v130
  v_lshlrev_b32 v244, 16, v131
  v_and_b32 v245, s74, v131
  v_fma_f32 v238, v238, v208, v207
  v_mfma_f32_32x32x16_bf16 v[80:95], v[60:63], a[68:71], v[80:95]
  s_add_u32 m0, s65, 32768
  s_add_u32 s0, s15, 0
  s_and_b32 s0, s0, 524287
  s_add_u32 s0, s0, 524288
  ds_read_b64_tr_b16 a[100:101], v193 offset:53248
  ds_read_b64_tr_b16 a[102:103], v193 offset:53760
  ds_read_b64_tr_b16 a[130:131], v214 offset:1024
  buffer_load_dwordx4 v210, s[52:55], s0 offen lds
  v_fma_f32 v239, v239, v208, v207
  v_fma_f32 v240, v240, v208, v207
  v_fma_f32 v241, v241, v208, v207
  v_fma_f32 v242, v242, v208, v207
  v_fma_f32 v243, v243, v208, v207
  v_mfma_f32_32x32x16_bf16 v[96:111], v[60:63], a[72:75], v[96:111]
  ds_read_b64_tr_b16 a[104:105], v192 offset:55296
  ds_read_b64_tr_b16 a[106:107], v192 offset:55808
  ds_read_b64_tr_b16 a[132:133], v215 offset:0
  v_fma_f32 v244, v244, v208, v207
  v_fma_f32 v245, v245, v208, v207
  v_cvt_pk_bf16_f32 v128, v238, v239
  v_cvt_pk_bf16_f32 v129, v240, v241
  v_cvt_pk_bf16_f32 v130, v242, v243
  v_mfma_f32_32x32x16_bf16 v[112:127], v[60:63], a[76:79], v[112:127]
  s_waitcnt lgkmcnt(9)
  ds_read_b64_tr_b16 a[108:109], v193 offset:55296
  ds_read_b64_tr_b16 a[110:111], v193 offset:55808
  ds_read_b64_tr_b16 a[134:135], v215 offset:1024
  buffer_load_dwordx4 v211, s[52:55], s0 offen offset:1024 lds
  v_cvt_pk_bf16_f32 v131, v244, v245
  v_lshlrev_b32 v246, 16, v132
  v_and_b32 v247, s74, v132
  v_lshlrev_b32 v248, 16, v133
  v_and_b32 v249, s74, v133
  v_mfma_f32_32x32x16_bf16 v[64:79], v[128:131], a[80:83], v[64:79]
  ds_read_b64_tr_b16 a[64:65], v192 offset:57344
  ds_read_b64_tr_b16 a[66:67], v192 offset:57856
  ds_read_b64_tr_b16 a[136:137], v214 offset:2048
  v_lshlrev_b32 v250, 16, v134
  v_and_b32 v251, s74, v134
  v_lshlrev_b32 v252, 16, v135
  v_and_b32 v253, s74, v135
  v_fma_f32 v246, v246, v208, v207
  v_fma_f32 v247, v247, v208, v207
  v_mfma_f32_32x32x16_bf16 v[80:95], v[128:131], a[84:87], v[80:95]
  s_add_u32 s0, s0, 63488
  ds_read_b64_tr_b16 a[68:69], v193 offset:57344
  ds_read_b64_tr_b16 a[70:71], v193 offset:57856
  ds_read_b64_tr_b16 a[138:139], v214 offset:3072
  buffer_load_dwordx4 v210, s[52:55], s0 offen offset:2048 lds
  v_fma_f32 v248, v248, v208, v207
  v_fma_f32 v249, v249, v208, v207
  v_fma_f32 v250, v250, v208, v207
  v_fma_f32 v251, v251, v208, v207
  v_fma_f32 v252, v252, v208, v207
  v_fma_f32 v253, v253, v208, v207
  v_mfma_f32_32x32x16_bf16 v[96:111], v[128:131], a[88:91], v[96:111]
  ds_read_b64_tr_b16 a[72:73], v192 offset:59392
  ds_read_b64_tr_b16 a[74:75], v192 offset:59904
  ds_read_b64_tr_b16 a[140:141], v215 offset:2048
  v_cvt_pk_bf16_f32 v132, v246, v247
  v_cvt_pk_bf16_f32 v133, v248, v249
  v_cvt_pk_bf16_f32 v134, v250, v251
  v_cvt_pk_bf16_f32 v135, v252, v253
  v_accvgpr_write_b32 a0, v128
  v_accvgpr_write_b32 a1, v129
  v_mfma_f32_32x32x16_bf16 v[112:127], v[128:131], a[92:95], v[112:127]
  s_waitcnt lgkmcnt(10)
  ds_read_b64_tr_b16 a[76:77], v193 offset:59392
  ds_read_b64_tr_b16 a[78:79], v193 offset:59904
  ds_read_b64_tr_b16 a[142:143], v215 offset:3072
  buffer_load_dwordx4 v211, s[52:55], s0 offen offset:3072 lds
  v_accvgpr_write_b32 a2, v130
  v_accvgpr_write_b32 a3, v131
  v_lshlrev_b32 v238, 16, v136
  v_and_b32 v239, s74, v136
  v_lshlrev_b32 v240, 16, v137
  v_and_b32 v241, s74, v137
  v_mfma_f32_32x32x16_bf16 v[64:79], v[132:135], a[96:99], v[64:79]
  s_mul_i32 s66, s18, 28672
  ds_read_b64_tr_b16 a[80:81], v192 offset:61440
  ds_read_b64_tr_b16 a[82:83], v192 offset:61952
  buffer_load_dword a252, v203, s[28:31], s66 offen
  v_lshlrev_b32 v242, 16, v138
  v_and_b32 v243, s74, v138
  v_lshlrev_b32 v244, 16, v139
  v_and_b32 v245, s74, v139
  v_fma_f32 v238, v238, v208, v207
  v_fma_f32 v239, v239, v208, v207
  v_mfma_f32_32x32x16_bf16 v[80:95], v[132:135], a[100:103], v[80:95]
  ds_read_b64_tr_b16 a[84:85], v193 offset:61440
  ds_read_b64_tr_b16 a[86:87], v193 offset:61952
  buffer_load_dword a253, v203, s[32:35], s66 offen offset:2048
  v_fma_f32 v240, v240, v208, v207
  v_fma_f32 v241, v241, v208, v207
  v_fma_f32 v242, v242, v208, v207
  v_fma_f32 v243, v243, v208, v207
  v_fma_f32 v244, v244, v208, v207
  v_fma_f32 v245, v245, v208, v207
  v_mfma_f32_32x32x16_bf16 v[96:111], v[132:135], a[104:107], v[96:111]
  ds_read_b64_tr_b16 a[88:89], v192 offset:63488
  ds_read_b64_tr_b16 a[90:91], v192 offset:64000
  v_cvt_pk_bf16_f32 v136, v238, v239
  v_cvt_pk_bf16_f32 v137, v240, v241
  v_cvt_pk_bf16_f32 v138, v242, v243
  v_cvt_pk_bf16_f32 v139, v244, v245
  v_accvgpr_write_b32 a4, v132
  v_accvgpr_write_b32 a5, v133
  v_mfma_f32_32x32x16_bf16 v[112:127], v[132:135], a[108:111], v[112:127]
  s_waitcnt lgkmcnt(7)
  ds_read_b64_tr_b16 a[92:93], v193 offset:63488
  ds_read_b64_tr_b16 a[94:95], v193 offset:64000
  v_accvgpr_write_b32 a6, v134
  v_accvgpr_write_b32 a7, v135
  v_lshlrev_b32 v246, 16, v140
  v_and_b32 v247, s74, v140
  v_lshlrev_b32 v248, 16, v141
  v_and_b32 v249, s74, v141
  v_mfma_f32_32x32x16_bf16 v[64:79], v[136:139], a[64:67], v[64:79]
  s_waitcnt vmcnt(23)
  s_barrier
  s_add_u32 m0, s65, 16384
  ds_read_b64_tr_b16 a[96:97], v196 offset:0
  ds_read_b64_tr_b16 a[98:99], v196 offset:512
  buffer_load_dwordx4 v203, s[28:31], s84 offen lds
  v_lshlrev_b32 v250, 16, v142
  v_and_b32 v251, s74, v142
  v_lshlrev_b32 v252, 16, v143
  v_and_b32 v253, s74, v143
  v_fma_f32 v246, v246, v208, v207
  v_fma_f32 v247, v247, v208, v207
  v_mfma_f32_32x32x16_bf16 v[80:95], v[136:139], a[68:71], v[80:95]
  ds_read_b64_tr_b16 a[100:101], v197 offset:0
  ds_read_b64_tr_b16 a[102:103], v197 offset:512
  buffer_load_dwordx4 v204, s[28:31], s84 offen offset:1024 lds
  v_fma_f32 v248, v248, v208, v207
  v_fma_f32 v249, v249, v208, v207
  v_fma_f32 v250, v250, v208, v207
  v_fma_f32 v251, v251, v208, v207
  v_fma_f32 v252, v252, v208, v207
  v_fma_f32 v253, v253, v208, v207
  v_mfma_f32_32x32x16_bf16 v[96:111], v[136:139], a[72:75], v[96:111]
  ds_read_b64_tr_b16 a[104:105], v196 offset:2048
  ds_read_b64_tr_b16 a[106:107], v196 offset:2560
  buffer_load_dwordx4 v203, s[32:35], s84 offen offset:2048 lds
  v_cvt_pk_bf16_f32 v140, v246, v247
  v_cvt_pk_bf16_f32 v141, v248, v249
  v_cvt_pk_bf16_f32 v142, v250, v251
  v_cvt_pk_bf16_f32 v143, v252, v253
  v_accvgpr_write_b32 a8, v136
  v_accvgpr_write_b32 a9, v137
  v_mfma_f32_32x32x16_bf16 v[112:127], v[136:139], a[76:79], v[112:127]
  s_waitcnt lgkmcnt(6)
  ds_read_b64_tr_b16 a[108:109], v197 offset:2048
  ds_read_b64_tr_b16 a[110:111], v197 offset:2560
  v_accvgpr_write_b32 a10, v138
  v_accvgpr_write_b32 a11, v139
  v_lshlrev_b32 v238, 16, v144
  v_and_b32 v239, s74, v144
  v_lshlrev_b32 v240, 16, v145
  v_and_b32 v241, s74, v145
  v_mfma_f32_32x32x16_bf16 v[64:79], v[140:143], a[80:83], v[64:79]
  s_waitcnt vmcnt(22)
  ds_read_b64_tr_b16 a[64:65], v196 offset:4096
  ds_read_b64_tr_b16 a[66:67], v196 offset:4608
  ds_read_b64_tr_b16 a[144:145], v214 offset:16384
  buffer_load_dwordx4 v204, s[32:35], s84 offen offset:3072 lds
  v_lshlrev_b32 v242, 16, v146
  v_and_b32 v243, s74, v146
  v_lshlrev_b32 v244, 16, v147
  v_and_b32 v245, s74, v147
  v_fma_f32 v238, v238, v208, v207
  v_fma_f32 v239, v239, v208, v207
  v_mfma_f32_32x32x16_bf16 v[80:95], v[140:143], a[84:87], v[80:95]
  ds_read_b64_tr_b16 a[68:69], v197 offset:4096
  ds_read_b64_tr_b16 a[70:71], v197 offset:4608
  ds_read_b64_tr_b16 a[146:147], v214 offset:17408
  v_fma_f32 v240, v240, v208, v207
  v_fma_f32 v241, v241, v208, v207
  v_fma_f32 v242, v242, v208, v207
  v_fma_f32 v243, v243, v208, v207
  v_fma_f32 v244, v244, v208, v207
  v_fma_f32 v245, v245, v208, v207
  v_mfma_f32_32x32x16_bf16 v[96:111], v[140:143], a[88:91], v[96:111]
  s_add_u32 m0, s65, 65536
  s_add_u32 s0, s15, 131072
  s_and_b32 s0, s0, 524287
  s_add_u32 s0, s0, 524288
  ds_read_b64_tr_b16 a[72:73], v196 offset:6144
  ds_read_b64_tr_b16 a[74:75], v196 offset:6656
  ds_read_b64_tr_b16 a[148:149], v215 offset:16384
  buffer_load_dwordx4 v210, s[52:55], s0 offen lds
  v_cvt_pk_bf16_f32 v144, v238, v239
  v_cvt_pk_bf16_f32 v145, v240, v241
  v_cvt_pk_bf16_f32 v146, v242, v243
  v_cvt_pk_bf16_f32 v147, v244, v245
  v_accvgpr_write_b32 a12, v140
  v_accvgpr_write_b32 a13, v141
  v_mfma_f32_32x32x16_bf16 v[112:127], v[140:143], a[92:95], v[112:127]
  s_waitcnt lgkmcnt(9)
  ds_read_b64_tr_b16 a[76:77], v197 offset:6144
  ds_read_b64_tr_b16 a[78:79], v197 offset:6656
  ds_read_b64_tr_b16 a[150:151], v215 offset:17408
  buffer_load_dwordx4 v211, s[52:55], s0 offen offset:1024 lds
  v_accvgpr_write_b32 a14, v142
  v_accvgpr_write_b32 a15, v143
  v_lshlrev_b32 v246, 16, v148
  v_and_b32 v247, s74, v148
  v_lshlrev_b32 v248, 16, v149
  v_and_b32 v249, s74, v149
  v_mfma_f32_32x32x16_bf16 v[64:79], v[144:147], a[96:99], v[64:79]
  s_add_u32 s0, s0, 63488
  ds_read_b64_tr_b16 a[80:81], v196 offset:8192
  ds_read_b64_tr_b16 a[82:83], v196 offset:8704
  ds_read_b64_tr_b16 a[152:153], v214 offset:18432
  buffer_load_dwordx4 v210, s[52:55], s0 offen offset:2048 lds
  v_lshlrev_b32 v250, 16, v150
  v_and_b32 v251, s74, v150
  v_lshlrev_b32 v252, 16, v151
  v_and_b32 v253, s74, v151
  v_fma_f32 v246, v246, v208, v207
  v_fma_f32 v247, v247, v208, v207
  v_mfma_f32_32x32x16_bf16 v[80:95], v[144:147], a[100:103], v[80:95]
  ds_read_b64_tr_b16 a[84:85], v197 offset:8192
  ds_read_b64_tr_b16 a[86:87], v197 offset:8704
  ds_read_b64_tr_b16 a[154:155], v214 offset:19456
  v_fma_f32 v248, v248, v208, v207
  v_fma_f32 v249, v249, v208, v207
  v_fma_f32 v250, v250, v208, v207
  v_fma_f32 v251, v251, v208, v207
  v_fma_f32 v252, v252, v208, v207
  v_fma_f32 v253, v253, v208, v207
  v_mfma_f32_32x32x16_bf16 v[96:111], v[144:147], a[104:107], v[96:111]
  ds_read_b64_tr_b16 a[88:89], v196 offset:10240
  ds_read_b64_tr_b16 a[90:91], v196 offset:10752
  ds_read_b64_tr_b16 a[156:157], v215 offset:18432
  buffer_load_dwordx4 v211, s[52:55], s0 offen offset:3072 lds
  v_cvt_pk_bf16_f32 v148, v246, v247
  v_cvt_pk_bf16_f32 v149, v248, v249
  v_cvt_pk_bf16_f32 v150, v250, v251
  v_cvt_pk_bf16_f32 v151, v252, v253
  v_accvgpr_write_b32 a16, v144
  v_accvgpr_write_b32 a17, v145
  v_mfma_f32_32x32x16_bf16 v[112:127], v[144:147], a[108:111], v[112:127]
  s_waitcnt lgkmcnt(10)
  ds_read_b64_tr_b16 a[92:93], v197 offset:10240
  ds_read_b64_tr_b16 a[94:95], v197 offset:10752
  ds_read_b64_tr_b16 a[158:159], v215 offset:19456
  v_accvgpr_write_b32 a18, v146
  v_accvgpr_write_b32 a19, v147
  v_lshlrev_b32 v238, 16, v152
  v_and_b32 v239, s74, v152
  v_lshlrev_b32 v240, 16, v153
  v_and_b32 v241, s74, v153
  v_mfma_f32_32x32x16_bf16 v[64:79], v[148:151], a[64:67], v[64:79]
  ds_read_b64_tr_b16 a[96:97], v196 offset:12288
  ds_read_b64_tr_b16 a[98:99], v196 offset:12800
  v_lshlrev_b32 v242, 16, v154
  v_and_b32 v243, s74, v154
  v_lshlrev_b32 v244, 16, v155
  v_and_b32 v245, s74, v155
  v_fma_f32 v238, v238, v208, v207
  v_fma_f32 v239, v239, v208, v207
  v_mfma_f32_32x32x16_bf16 v[80:95], v[148:151], a[68:71], v[80:95]
  ds_read_b64_tr_b16 a[100:101], v197 offset:12288
  ds_read_b64_tr_b16 a[102:103], v197 offset:12800
  v_fma_f32 v240, v240, v208, v207
  v_fma_f32 v241, v241, v208, v207
  v_fma_f32 v242, v242, v208, v207
  v_fma_f32 v243, v243, v208, v207
  v_fma_f32 v244, v244, v208, v207
  v_fma_f32 v245, v245, v208, v207
  v_mfma_f32_32x32x16_bf16 v[96:111], v[148:151], a[72:75], v[96:111]
  ds_read_b64_tr_b16 a[104:105], v196 offset:14336
  ds_read_b64_tr_b16 a[106:107], v196 offset:14848
  v_cvt_pk_bf16_f32 v152, v238, v239
  v_cvt_pk_bf16_f32 v153, v240, v241
  v_cvt_pk_bf16_f32 v154, v242, v243
  v_cvt_pk_bf16_f32 v155, v244, v245
  v_accvgpr_write_b32 a20, v148
  v_accvgpr_write_b32 a21, v149
  v_mfma_f32_32x32x16_bf16 v[112:127], v[148:151], a[76:79], v[112:127]
  s_waitcnt lgkmcnt(7)
  ds_read_b64_tr_b16 a[108:109], v197 offset:14336
  ds_read_b64_tr_b16 a[110:111], v197 offset:14848
  v_accvgpr_write_b32 a22, v150
  v_accvgpr_write_b32 a23, v151
  v_lshlrev_b32 v246, 16, v156
  v_and_b32 v247, s74, v156
  v_lshlrev_b32 v248, 16, v157
  v_and_b32 v249, s74, v157
  v_mfma_f32_32x32x16_bf16 v[64:79], v[152:155], a[80:83], v[64:79]
  s_waitcnt vmcnt(26)
  v_readfirstlane_b32 s66, v221
  s_mul_i32 s67, s83, 1
  s_nop 0
  s_bfe_u32 s66, s66, 524288
  s_cmp_eq_u32 s66, s67
  s_cbranch_scc0 k_A_rdy_spin
k_A_rdy_ok:
  s_waitcnt vmcnt(22)
  s_barrier
  s_add_u32 m0, s65, 49152
  ds_read_b64_tr_b16 a[64:65], v196 offset:16384
  ds_read_b64_tr_b16 a[66:67], v196 offset:16896
  buffer_load_dwordx4 v203, s[28:31], s85 offen lds
  v_lshlrev_b32 v250, 16, v158
  v_and_b32 v251, s74, v158
  v_lshlrev_b32 v252, 16, v159
  v_and_b32 v253, s74, v159
  v_fma_f32 v246, v246, v208, v207
  v_fma_f32 v247, v247, v208, v207
  v_mfma_f32_32x32x16_bf16 v[80:95], v[152:155], a[84:87], v[80:95]
  ds_read_b64_tr_b16 a[68:69], v197 offset:16384
  ds_read_b64_tr_b16 a[70:71], v197 offset:16896
  buffer_load_dwordx4 v204, s[28:31], s85 offen offset:1024 lds
  v_fma_f32 v248, v248, v208, v207
  v_fma_f32 v249, v249, v208, v207
  v_fma_f32 v250, v250, v208, v207
  v_fma_f32 v251, v251, v208, v207
  v_fma_f32 v252, v252, v208, v207
  v_fma_f32 v253, v253, v208, v207
  v_mfma_f32_32x32x16_bf16 v[96:111], v[152:155], a[88:91], v[96:111]
  ds_read_b64_tr_b16 a[72:73], v196 offset:18432
  ds_read_b64_tr_b16 a[74:75], v196 offset:18944
  buffer_load_dwordx4 v203, s[32:35], s85 offen offset:2048 lds
  v_cvt_pk_bf16_f32 v156, v246, v247
  v_cvt_pk_bf16_f32 v157, v248, v249
  v_cvt_pk_bf16_f32 v158, v250, v251
  v_cvt_pk_bf16_f32 v159, v252, v253
  v_accvgpr_write_b32 a24, v152
  v_accvgpr_write_b32 a25, v153
  v_mfma_f32_32x32x16_bf16 v[112:127], v[152:155], a[92:95], v[112:127]
  s_waitcnt lgkmcnt(6)
  ds_read_b64_tr_b16 a[76:77], v197 offset:18432
  ds_read_b64_tr_b16 a[78:79], v197 offset:18944
  v_accvgpr_write_b32 a26, v154
  v_accvgpr_write_b32 a27, v155
  v_lshlrev_b32 v238, 16, v160
  v_and_b32 v239, s74, v160
  v_lshlrev_b32 v240, 16, v161
  v_and_b32 v241, s74, v161
  v_mfma_f32_32x32x16_bf16 v[64:79], v[156:159], a[96:99], v[64:79]
  s_waitcnt vmcnt(21)
  ds_read_b64_tr_b16 a[80:81], v196 offset:20480
  ds_read_b64_tr_b16 a[82:83], v196 offset:20992
  ds_read_b64_tr_b16 a[160:161], v214 offset:32768
  buffer_load_dwordx4 v204, s[32:35], s85 offen offset:3072 lds
  v_lshlrev_b32 v242, 16, v162
  v_and_b32 v243, s74, v162
  v_lshlrev_b32 v244, 16, v163
  v_and_b32 v245, s74, v163
  v_fma_f32 v238, v238, v208, v207
  v_fma_f32 v239, v239, v208, v207
  v_mfma_f32_32x32x16_bf16 v[80:95], v[156:159], a[100:103], v[80:95]
  ds_read_b64_tr_b16 a[84:85], v197 offset:20480
  ds_read_b64_tr_b16 a[86:87], v197 offset:20992
  ds_read_b64_tr_b16 a[162:163], v214 offset:33792
  v_fma_f32 v240, v240, v208, v207
  v_fma_f32 v241, v241, v208, v207
  v_fma_f32 v242, v242, v208, v207
  v_fma_f32 v243, v243, v208, v207
  v_fma_f32 v244, v244, v208, v207
  v_fma_f32 v245, v245, v208, v207
  v_mfma_f32_32x32x16_bf16 v[96:111], v[156:159], a[104:107], v[96:111]
  s_add_u32 m0, s65, 81920
  s_add_u32 s0, s15, 262144
  s_and_b32 s0, s0, 524287
  s_add_u32 s0, s0, 524288
  ds_read_b64_tr_b16 a[88:89], v196 offset:22528
  ds_read_b64_tr_b16 a[90:91], v196 offset:23040
  ds_read_b64_tr_b16 a[164:165], v215 offset:32768
  buffer_load_dwordx4 v210, s[52:55], s0 offen lds
  v_cvt_pk_bf16_f32 v160, v238, v239
  v_cvt_pk_bf16_f32 v161, v240, v241
  v_cvt_pk_bf16_f32 v162, v242, v243
  v_cvt_pk_bf16_f32 v163, v244, v245
  v_accvgpr_write_b32 a28, v156
  v_accvgpr_write_b32 a29, v157
  v_mfma_f32_32x32x16_bf16 v[112:127], v[156:159], a[108:111], v[112:127]
  s_waitcnt lgkmcnt(9)
  ds_read_b64_tr_b16 a[92:93], v197 offset:22528
  ds_read_b64_tr_b16 a[94:95], v197 offset:23040
  ds_read_b64_tr_b16 a[166:167], v215 offset:33792
  buffer_load_dwordx4 v211, s[52:55], s0 offen offset:1024 lds
  v_accvgpr_write_b32 a30, v158
  v_accvgpr_write_b32 a31, v159
  v_lshlrev_b32 v246, 16, v164
  v_and_b32 v247, s74, v164
  v_lshlrev_b32 v248, 16, v165
  v_and_b32 v249, s74, v165
  v_mfma_f32_32x32x16_bf16 v[64:79], v[160:163], a[64:67], v[64:79]
  s_add_u32 s0, s0, 63488
  ds_read_b64_tr_b16 a[96:97], v196 offset:24576
  ds_read_b64_tr_b16 a[98:99], v196 offset:25088
  ds_read_b64_tr_b16 a[168:169], v214 offset:34816
  buffer_load_dwordx4 v210, s[52:55], s0 offen offset:2048 lds
  v_lshlrev_b32 v250, 16, v166
  v_and_b32 v251, s74, v166
  v_lshlrev_b32 v252, 16, v167
  v_and_b32 v253, s74, v167
  v_fma_f32 v246, v246, v208, v207
  v_fma_f32 v247, v247, v208, v207
  v_mfma_f32_32x32x16_bf16 v[80:95], v[160:163], a[68:71], v[80:95]
  ds_read_b64_tr_b16 a[100:101], v197 offset:24576
  ds_read_b64_tr_b16 a[102:103], v197 offset:25088
  ds_read_b64_tr_b16 a[170:171], v214 offset:35840
  v_fma_f32 v248, v248, v208, v207
  v_fma_f32 v249, v249, v208, v207
  v_fma_f32 v250, v250, v208, v207
  v_fma_f32 v251, v251, v208, v207
  v_fma_f32 v252, v252, v208, v207
  v_fma_f32 v253, v253, v208, v207
  v_mfma_f32_32x32x16_bf16 v[96:111], v[160:163], a[72:75], v[96:111]
  ds_read_b64_tr_b16 a[104:105], v196 offset:26624
  ds_read_b64_tr_b16 a[106:107], v196 offset:27136
  ds_read_b64_tr_b16 a[172:173], v215 offset:34816
  buffer_load_dwordx4 v211, s[52:55], s0 offen offset:3072 lds
  v_cvt_pk_bf16_f32 v164, v246, v247
  v_cvt_pk_bf16_f32 v165, v248, v249
  v_cvt_pk_bf16_f32 v166, v250, v251
  v_cvt_pk_bf16_f32 v167, v252, v253
  v_accvgpr_write_b32 a32, v160
  v_accvgpr_write_b32 a33, v161
  v_mfma_f32_32x32x16_bf16 v[112:127], v[160:163], a[76:79], v[112:127]
  s_waitcnt lgkmcnt(10)
  ds_read_b64_tr_b16 a[108:109], v197 offset:26624
  ds_read_b64_tr_b16 a[110:111], v197 offset:27136
  ds_read_b64_tr_b16 a[174:175], v215 offset:35840
  v_accvgpr_write_b32 a34, v162
  v_accvgpr_write_b32 a35, v163
  v_lshlrev_b32 v238, 16, v168
  v_and_b32 v239, s74, v168
  v_lshlrev_b32 v240, 16, v169
  v_and_b32 v241, s74, v169
  v_mfma_f32_32x32x16_bf16 v[64:79], v[164:167], a[80:83], v[64:79]
  ds_read_b64_tr_b16 a[64:65], v196 offset:28672
  ds_read_b64_tr_b16 a[66:67], v196 offset:29184
  v_lshlrev_b32 v242, 16, v170
  v_and_b32 v243, s74, v170
  v_lshlrev_b32 v244, 16, v171
  v_and_b32 v245, s74, v171
  v_fma_f32 v238, v238, v208, v207
  v_fma_f32 v239, v239, v208, v207
  v_mfma_f32_32x32x16_bf16 v[80:95], v[164:167], a[84:87], v[80:95]
  ds_read_b64_tr_b16 a[68:69], v197 offset:28672
  ds_read_b64_tr_b16 a[70:71], v197 offset:29184
  v_fma_f32 v240, v240, v208, v207
  v_fma_f32 v241, v241, v208, v207
  v_fma_f32 v242, v242, v208, v207
  v_fma_f32 v243, v243, v208, v207
  v_fma_f32 v244, v244, v208, v207
  v_fma_f32 v245, v245, v208, v207
  v_mfma_f32_32x32x16_bf16 v[96:111], v[164:167], a[88:91], v[96:111]
  ds_read_b64_tr_b16 a[72:73], v196 offset:30720
  ds_read_b64_tr_b16 a[74:75], v196 offset:31232
  v_cvt_pk_bf16_f32 v168, v238, v239
  v_cvt_pk_bf16_f32 v169, v240, v241
  v_cvt_pk_bf16_f32 v170, v242, v243
  v_cvt_pk_bf16_f32 v171, v244, v245
  v_accvgpr_write_b32 a36, v164
  v_accvgpr_write_b32 a37, v165
  v_mfma_f32_32x32x16_bf16 v[112:127], v[164:167], a[92:95], v[112:127]
  s_waitcnt lgkmcnt(7)
  ds_read_b64_tr_b16 a[76:77], v197 offset:30720
  ds_read_b64_tr_b16 a[78:79], v197 offset:31232
  v_accvgpr_write_b32 a38, v166
  v_accvgpr_write_b32 a39, v167
  v_lshlrev_b32 v246, 16, v172
  v_and_b32 v247, s74, v172
  v_lshlrev_b32 v248, 16, v173
  v_and_b32 v249, s74, v173
  v_mfma_f32_32x32x16_bf16 v[64:79], v[168:171], a[96:99], v[64:79]
  s_waitcnt vmcnt(22)
  s_barrier
  s_lshr_b32 s12, s64, 1
  s_add_u32 s12, s12, s101
  s_add_u32 s13, s12, 0
  s_and_b32 s13, s13, 7
  s_mul_i32 s48, s13, 229376
  s_add_u32 s13, s12, 2
  s_and_b32 s13, s13, 7
  s_mul_i32 s49, s13, 229376
  s_add_u32 s13, s12, 4
  s_and_b32 s13, s13, 7
  s_mul_i32 s50, s13, 229376
  s_add_u32 s13, s12, 6
  s_and_b32 s13, s13, 7
  s_mul_i32 s51, s13, 229376
  s_add_u32 m0, s65, 131072
  ds_read_b64_tr_b16 a[80:81], v192 offset:0
  ds_read_b64_tr_b16 a[82:83], v192 offset:512
  buffer_load_dwordx4 v203, s[28:31], s86 offen lds
  v_lshlrev_b32 v250, 16, v174
  v_and_b32 v251, s74, v174
  v_lshlrev_b32 v252, 16, v175
  v_and_b32 v253, s74, v175
  v_fma_f32 v246, v246, v208, v207
  v_fma_f32 v247, v247, v208, v207
  v_mfma_f32_32x32x16_bf16 v[80:95], v[168:171], a[100:103], v[80:95]
  ds_read_b64_tr_b16 a[84:85], v193 offset:0
  ds_read_b64_tr_b16 a[86:87], v193 offset:512
  buffer_load_dwordx4 v204, s[28:31], s86 offen offset:1024 lds
  v_fma_f32 v248, v248, v208, v207
  v_fma_f32 v249, v249, v208, v207
  v_fma_f32 v250, v250, v208, v207
  v_fma_f32 v251, v251, v208, v207
  v_fma_f32 v252, v252, v208, v207
  v_fma_f32 v253, v253, v208, v207
  v_mfma_f32_32x32x16_bf16 v[96:111], v[168:171], a[104:107], v[96:111]
  ds_read_b64_tr_b16 a[88:89], v192 offset:2048
  ds_read_b64_tr_b16 a[90:91], v192 offset:2560
  buffer_load_dwordx4 v203, s[32:35], s86 offen offset:2048 lds
  v_cvt_pk_bf16_f32 v172, v246, v247
  v_cvt_pk_bf16_f32 v173, v248, v249
  v_cvt_pk_bf16_f32 v174, v250, v251
  v_cvt_pk_bf16_f32 v175, v252, v253
  v_accvgpr_write_b32 a40, v168
  v_accvgpr_write_b32 a41, v169
  v_mfma_f32_32x32x16_bf16 v[112:127], v[168:171], a[108:111], v[112:127]
  s_waitcnt lgkmcnt(6)
  ds_read_b64_tr_b16 a[92:93], v193 offset:2048
  ds_read_b64_tr_b16 a[94:95], v193 offset:2560
  buffer_load_dwordx4 v204, s[32:35], s86 offen offset:3072 lds
  v_accvgpr_write_b32 a42, v170
  v_accvgpr_write_b32 a43, v171
  v_lshlrev_b32 v238, 16, v176
  v_and_b32 v239, s74, v176
  v_lshlrev_b32 v240, 16, v177
  v_and_b32 v241, s74, v177
  v_mfma_f32_32x32x16_bf16 v[64:79], v[172:175], a[64:67], v[64:79]
  s_waitcnt vmcnt(22)
  ds_read_b64_tr_b16 a[96:97], v192 offset:4096
  ds_read_b64_tr_b16 a[98:99], v192 offset:4608
  ds_read_b64_tr_b16 a[176:177], v212 offset:32768
  v_lshlrev_b32 v242, 16, v178
  v_and_b32 v243, s74, v178
  v_lshlrev_b32 v244, 16, v179
  v_and_b32 v245, s74, v179
  v_fma_f32 v238, v238, v208, v207
  v_fma_f32 v239, v239, v208, v207
  v_mfma_f32_32x32x16_bf16 v[80:95], v[172:175], a[68:71], v[80:95]
  s_add_u32 m0, s65, 98304
  s_add_u32 s0, s15, 393216
  s_and_b32 s0, s0, 524287
  s_add_u32 s0, s0, 524288
  ds_read_b64_tr_b16 a[100:101], v193 offset:4096
  ds_read_b64_tr_b16 a[102:103], v193 offset:4608
  ds_read_b64_tr_b16 a[178:179], v212 offset:33792
  buffer_load_dwordx4 v210, s[52:55], s0 offen lds
  v_fma_f32 v240, v240, v208, v207
  v_fma_f32 v241, v241, v208, v207
  v_fma_f32 v242, v242, v208, v207
  v_fma_f32 v243, v243, v208, v207
  v_fma_f32 v244, v244, v208, v207
  v_fma_f32 v245, v245, v208, v207
  v_mfma_f32_32x32x16_bf16 v[96:111], v[172:175], a[72:75], v[96:111]
  ds_read_b64_tr_b16 a[104:105], v192 offset:6144
  ds_read_b64_tr_b16 a[106:107], v192 offset:6656
  ds_read_b64_tr_b16 a[180:181], v213 offset:32768
  v_cvt_pk_bf16_f32 v176, v238, v239
  v_cvt_pk_bf16_f32 v177, v240, v241
  v_cvt_pk_bf16_f32 v178, v242, v243
  v_cvt_pk_bf16_f32 v179, v244, v245
  v_accvgpr_write_b32 a44, v172
  v_accvgpr_write_b32 a45, v173
  v_mfma_f32_32x32x16_bf16 v[112:127], v[172:175], a[76:79], v[112:127]
  s_waitcnt lgkmcnt(9)
  ds_read_b64_tr_b16 a[108:109], v193 offset:6144
  ds_read_b64_tr_b16 a[110:111], v193 offset:6656
  ds_read_b64_tr_b16 a[182:183], v213 offset:33792
  buffer_load_dwordx4 v211, s[52:55], s0 offen offset:1024 lds
  v_accvgpr_write_b32 a46, v174
  v_accvgpr_write_b32 a47, v175
  v_lshlrev_b32 v246, 16, v180
  v_and_b32 v247, s74, v180
  v_lshlrev_b32 v248, 16, v181
  v_and_b32 v249, s74, v181
  v_mfma_f32_32x32x16_bf16 v[64:79], v[176:179], a[80:83], v[64:79]
  s_add_u32 s0, s0, 63488
  ds_read_b64_tr_b16 a[64:65], v192 offset:8192
  ds_read_b64_tr_b16 a[66:67], v192 offset:8704
  ds_read_b64_tr_b16 a[184:185], v212 offset:34816
  buffer_load_dwordx4 v210, s[52:55], s0 offen offset:2048 lds
  v_lshlrev_b32 v250, 16, v182
  v_and_b32 v251, s74, v182
  v_lshlrev_b32 v252, 16, v183
  v_and_b32 v253, s74, v183
  v_fma_f32 v246, v246, v208, v207
  v_fma_f32 v247, v247, v208, v207
  v_mfma_f32_32x32x16_bf16 v[80:95], v[176:179], a[84:87], v[80:95]
  ds_read_b64_tr_b16 a[68:69], v193 offset:8192
  ds_read_b64_tr_b16 a[70:71], v193 offset:8704
  ds_read_b64_tr_b16 a[186:187], v212 offset:35840
  v_fma_f32 v248, v248, v208, v207
  v_fma_f32 v249, v249, v208, v207
  v_fma_f32 v250, v250, v208, v207
  v_fma_f32 v251, v251, v208, v207
  v_fma_f32 v252, v252, v208, v207
  v_fma_f32 v253, v253, v208, v207
  v_mfma_f32_32x32x16_bf16 v[96:111], v[176:179], a[88:91], v[96:111]
  ds_read_b64_tr_b16 a[72:73], v192 offset:10240
  ds_read_b64_tr_b16 a[74:75], v192 offset:10752
  ds_read_b64_tr_b16 a[188:189], v213 offset:34816
  buffer_load_dwordx4 v211, s[52:55], s0 offen offset:3072 lds
  v_cvt_pk_bf16_f32 v180, v246, v247
  v_cvt_pk_bf16_f32 v181, v248, v249
  v_cvt_pk_bf16_f32 v182, v250, v251
  v_cvt_pk_bf16_f32 v183, v252, v253
  v_accvgpr_write_b32 a48, v176
  v_accvgpr_write_b32 a49, v177
  v_mfma_f32_32x32x16_bf16 v[112:127], v[176:179], a[92:95], v[112:127]
  s_waitcnt lgkmcnt(10)
  s_lshr_b32 s66, s20, 2
  s_lshl_b32 s66, s66, 1
  s_lshr_b32 s67, s64, 1
  s_add_u32 s66, s66, s67
  s_lshl_b32 s66, s66, 3
  s_and_b32 s67, s20, 1
  s_lshl_b32 s67, s67, 1
  s_add_u32 s66, s66, s67
  s_mul_i32 s66, s66, 28672
  ds_read_b64_tr_b16 a[76:77], v193 offset:10240
  ds_read_b64_tr_b16 a[78:79], v193 offset:10752
  ds_read_b64_tr_b16 a[190:191], v213 offset:35840
  buffer_load_dword a254, v205, s[28:31], s66 offen
  v_accvgpr_write_b32 a50, v178
  v_accvgpr_write_b32 a51, v179
  v_lshlrev_b32 v238, 16, v184
  v_and_b32 v239, s74, v184
  v_lshlrev_b32 v240, 16, v185
  v_and_b32 v241, s74, v185
  v_mfma_f32_32x32x16_bf16 v[64:79], v[180:183], a[96:99], v[64:79]
  ds_read_b64_tr_b16 a[80:81], v192 offset:12288
  ds_read_b64_tr_b16 a[82:83], v192 offset:12800
  buffer_load_dword a255, v205, s[32:35], s66 offen offset:2048
  v_lshlrev_b32 v242, 16, v186
  v_and_b32 v243, s74, v186
  v_lshlrev_b32 v244, 16, v187
  v_and_b32 v245, s74, v187
  v_fma_f32 v238, v238, v208, v207
  v_fma_f32 v239, v239, v208, v207
  v_mfma_f32_32x32x16_bf16 v[80:95], v[180:183], a[100:103], v[80:95]
  ds_read_b64_tr_b16 a[84:85], v193 offset:12288
  ds_read_b64_tr_b16 a[86:87], v193 offset:12800
  v_fma_f32 v240, v240, v208, v207
  v_fma_f32 v241, v241, v208, v207
  v_fma_f32 v242, v242, v208, v207
  v_fma_f32 v243, v243, v208, v207
  v_fma_f32 v244, v244, v208, v207
  v_fma_f32 v245, v245, v208, v207
  v_mfma_f32_32x32x16_bf16 v[96:111], v[180:183], a[104:107], v[96:111]
  ds_read_b64_tr_b16 a[88:89], v192 offset:14336
  ds_read_b64_tr_b16 a[90:91], v192 offset:14848
  v_cvt_pk_bf16_f32 v184, v238, v239
  v_cvt_pk_bf16_f32 v185, v240, v241
  v_cvt_pk_bf16_f32 v186, v242, v243
  v_cvt_pk_bf16_f32 v187, v244, v245
  v_accvgpr_write_b32 a52, v180
  v_accvgpr_write_b32 a53, v181
  v_mfma_f32_32x32x16_bf16 v[112:127], v[180:183], a[108:111], v[112:127]
  s_waitcnt lgkmcnt(7)
  ds_read_b64_tr_b16 a[92:93], v193 offset:14336
  ds_read_b64_tr_b16 a[94:95], v193 offset:14848
  v_accvgpr_write_b32 a54, v182
  v_accvgpr_write_b32 a55, v183
  v_lshlrev_b32 v246, 16, v188
  v_and_b32 v247, s74, v188
  v_lshlrev_b32 v248, 16, v189
  v_and_b32 v249, s74, v189
  v_mfma_f32_32x32x16_bf16 v[64:79], v[184:187], a[64:67], v[64:79]
  s_waitcnt vmcnt(22)
  s_barrier
  s_add_u32 m0, s65, 147456
  s_add_u32 s0, s15, 0
  s_and_b32 s0, s0, 262143
  s_add_u32 s0, s0, 1048576
  ds_read_b64_tr_b16 a[96:97], v192 offset:16384
  ds_read_b64_tr_b16 a[98:99], v192 offset:16896
  buffer_load_dwordx4 v210, s[52:55], s0 offen lds
  v_lshlrev_b32 v250, 16, v190
  v_and_b32 v251, s74, v190
  v_lshlrev_b32 v252, 16, v191
  v_and_b32 v253, s74, v191
  v_fma_f32 v246, v246, v208, v207
  v_mfma_f32_32x32x16_bf16 v[80:95], v[184:187], a[68:71], v[80:95]
  ds_read_b64_tr_b16 a[100:101], v193 offset:16384
  ds_read_b64_tr_b16 a[102:103], v193 offset:16896
  buffer_load_dwordx4 v211, s[52:55], s0 offen offset:1024 lds
  v_fma_f32 v247, v247, v208, v207
  v_fma_f32 v248, v248, v208, v207
  v_fma_f32 v249, v249, v208, v207
  v_fma_f32 v250, v250, v208, v207
  v_fma_f32 v251, v251, v208, v207
  v_mfma_f32_32x32x16_bf16 v[96:111], v[184:187], a[72:75], v[96:111]
  s_add_u32 s0, s0, 63488
  ds_read_b64_tr_b16 a[104:105], v192 offset:18432
  ds_read_b64_tr_b16 a[106:107], v192 offset:18944
  buffer_load_dwordx4 v210, s[52:55], s0 offen offset:2048 lds
  v_fma_f32 v252, v252, v208, v207
  v_fma_f32 v253, v253, v208, v207
  v_cvt_pk_bf16_f32 v188, v246, v247
  v_cvt_pk_bf16_f32 v189, v248, v249
  v_cvt_pk_bf16_f32 v190, v250, v251
  v_mfma_f32_32x32x16_bf16 v[112:127], v[184:187], a[76:79], v[112:127]
  s_waitcnt lgkmcnt(6)
  ds_read_b64_tr_b16 a[108:109], v193 offset:18432
  ds_read_b64_tr_b16 a[110:111], v193 offset:18944
  v_cvt_pk_bf16_f32 v191, v252, v253
  v_accvgpr_write_b32 a56, v184
  v_accvgpr_write_b32 a57, v185
  v_accvgpr_write_b32 a58, v186
  v_accvgpr_write_b32 a59, v187
  v_mfma_f32_32x32x16_bf16 v[64:79], v[188:191], a[80:83], v[64:79]
  s_waitcnt vmcnt(21)
  ds_read_b64_tr_b16 a[64:65], v192 offset:20480
  ds_read_b64_tr_b16 a[66:67], v192 offset:20992
  ds_read_b64_tr_b16 a[192:193], v214 offset:0
  buffer_load_dwordx4 v211, s[52:55], s0 offen offset:3072 lds
  v_accvgpr_write_b32 a60, v188
  v_mfma_f32_32x32x16_bf16 v[80:95], v[188:191], a[84:87], v[80:95]
  ds_read_b64_tr_b16 a[68:69], v193 offset:20480
  ds_read_b64_tr_b16 a[70:71], v193 offset:20992
  ds_read_b64_tr_b16 a[194:195], v214 offset:1024
  v_accvgpr_write_b32 a61, v189
  v_mfma_f32_32x32x16_bf16 v[96:111], v[188:191], a[88:91], v[96:111]
  ds_read_b64_tr_b16 a[72:73], v192 offset:22528
  ds_read_b64_tr_b16 a[74:75], v192 offset:23040
  ds_read_b64_tr_b16 a[196:197], v215 offset:0
  v_accvgpr_write_b32 a62, v190
  v_mfma_f32_32x32x16_bf16 v[112:127], v[188:191], a[92:95], v[112:127]
  s_waitcnt lgkmcnt(9)
  ds_read_b64_tr_b16 a[76:77], v193 offset:22528
  ds_read_b64_tr_b16 a[78:79], v193 offset:23040
  ds_read_b64_tr_b16 a[198:199], v215 offset:1024
  v_accvgpr_write_b32 a63, v191
  v_mfma_f32_32x32x16_bf16 v[128:143], a[96:99], v[0:3], 0
  ds_read_b64_tr_b16 a[80:81], v192 offset:24576
  ds_read_b64_tr_b16 a[82:83], v192 offset:25088
  ds_read_b64_tr_b16 a[200:201], v214 offset:2048
  v_mfma_f32_32x32x16_bf16 v[144:159], a[100:103], v[0:3], 0
  ds_read_b64_tr_b16 a[84:85], v193 offset:24576
  ds_read_b64_tr_b16 a[86:87], v193 offset:25088
  ds_read_b64_tr_b16 a[202:203], v214 offset:3072
  v_mfma_f32_32x32x16_bf16 v[160:175], a[104:107], v[0:3], 0
  ds_read_b64_tr_b16 a[88:89], v192 offset:26624
  ds_read_b64_tr_b16 a[90:91], v192 offset:27136
  ds_read_b64_tr_b16 a[204:205], v215 offset:2048
  v_mul_f32 v234, s73, v64
  v_mul_f32 v235, s73, v65
  v_mul_f32 v236, s73, v66
  v_mul_f32 v237, s73, v67
  v_max_f32 v64, s75, v64
  v_max_f32 v65, s75, v65
  v_max_f32 v66, s75, v66
  v_max_f32 v67, s75, v67
  v_mfma_f32_32x32x16_bf16 v[176:191], a[108:111], v[0:3], 0
  s_waitcnt lgkmcnt(10)
  ds_read_b64_tr_b16 a[92:93], v193 offset:26624
  ds_read_b64_tr_b16 a[94:95], v193 offset:27136
  ds_read_b64_tr_b16 a[206:207], v215 offset:3072
  v_exp_f32_e64 v234, v234 clamp
  v_exp_f32_e64 v235, v235 clamp
  v_exp_f32_e64 v236, v236 clamp
  v_exp_f32_e64 v237, v237 clamp
  v_add_f32 v64, v234, v64
  v_mfma_f32_32x32x16_bf16 v[128:143], a[64:67], v[4:7], v[128:143]
  ds_read_b64_tr_b16 a[96:97], v192 offset:28672
  ds_read_b64_tr_b16 a[98:99], v192 offset:29184
  v_add_f32 v65, v235, v65
  v_add_f32 v66, v236, v66
  v_add_f32 v67, v237, v67
  v_mul_f32 v234, s73, v68
  v_mul_f32 v235, s73, v69
  v_mul_f32 v236, s73, v70
  v_mul_f32 v237, s73, v71
  v_max_f32 v68, s75, v68
  v_max_f32 v69, s75, v69
  v_max_f32 v70, s75, v70
  v_mfma_f32_32x32x16_bf16 v[144:159], a[68:71], v[4:7], v[144:159]
  ds_read_b64_tr_b16 a[100:101], v193 offset:28672
  ds_read_b64_tr_b16 a[102:103], v193 offset:29184
  v_max_f32 v71, s75, v71
  v_exp_f32_e64 v234, v234 clamp
  v_exp_f32_e64 v235, v235 clamp
  v_exp_f32_e64 v236, v236 clamp
  v_exp_f32_e64 v237, v237 clamp
  v_add_f32 v68, v234, v68
  v_mfma_f32_32x32x16_bf16 v[160:175], a[72:75], v[4:7], v[160:175]
  ds_read_b64_tr_b16 a[104:105], v192 offset:30720
  ds_read_b64_tr_b16 a[106:107], v192 offset:31232
  v_add_f32 v69, v235, v69
  v_add_f32 v70, v236, v70
  v_add_f32 v71, v237, v71
  v_mul_f32 v234, s73, v72
  v_mul_f32 v235, s73, v73
  v_mul_f32 v236, s73, v74
  v_mul_f32 v237, s73, v75
  v_max_f32 v72, s75, v72
  v_max_f32 v73, s75, v73
  v_max_f32 v74, s75, v74
  v_mfma_f32_32x32x16_bf16 v[176:191], a[76:79], v[4:7], v[176:191]
  s_waitcnt lgkmcnt(7)
  ds_read_b64_tr_b16 a[108:109], v193 offset:30720
  ds_read_b64_tr_b16 a[110:111], v193 offset:31232
  v_max_f32 v75, s75, v75
  v_exp_f32_e64 v234, v234 clamp
  v_exp_f32_e64 v235, v235 clamp
  v_exp_f32_e64 v236, v236 clamp
  v_exp_f32_e64 v237, v237 clamp
  v_add_f32 v72, v234, v72
  v_mfma_f32_32x32x16_bf16 v[128:143], a[80:83], v[8:11], v[128:143]
  s_waitcnt vmcnt(18)
  s_barrier
  s_add_u32 m0, s65, 0
  ds_read_b64_tr_b16 a[64:65], v192 offset:49152
  ds_read_b64_tr_b16 a[66:67], v192 offset:49664
  buffer_load_dwordx4 v203, s[28:31], s87 offen lds
  v_add_f32 v73, v235, v73
  v_add_f32 v74, v236, v74
  v_add_f32 v75, v237, v75
  v_mul_f32 v234, s73, v76
  v_mul_f32 v235, s73, v77
  v_mul_f32 v236, s73, v78
  v_mfma_f32_32x32x16_bf16 v[144:159], a[84:87], v[8:11], v[144:159]
  ds_read_b64_tr_b16 a[68:69], v193 offset:49152
  ds_read_b64_tr_b16 a[70:71], v193 offset:49664
  buffer_load_dwordx4 v204, s[28:31], s87 offen offset:1024 lds
  v_mul_f32 v237, s73, v79
  v_max_f32 v76, s75, v76
  v_max_f32 v77, s75, v77
  v_max_f32 v78, s75, v78
  v_max_f32 v79, s75, v79
  v_exp_f32_e64 v234, v234 clamp
  v_mfma_f32_32x32x16_bf16 v[160:175], a[88:91], v[8:11], v[160:175]
  ds_read_b64_tr_b16 a[72:73], v192 offset:51200
  ds_read_b64_tr_b16 a[74:75], v192 offset:51712
  buffer_load_dwordx4 v203, s[32:35], s87 offen offset:2048 lds
  v_exp_f32_e64 v235, v235 clamp
  v_exp_f32_e64 v236, v236 clamp
  v_exp_f32_e64 v237, v237 clamp
  v_add_f32 v76, v234, v76
  v_add_f32 v77, v235, v77
  v_mfma_f32_32x32x16_bf16 v[176:191], a[92:95], v[8:11], v[176:191]
  s_waitcnt lgkmcnt(6)
  ds_read_b64_tr_b16 a[76:77], v193 offset:51200
  ds_read_b64_tr_b16 a[78:79], v193 offset:51712
  v_add_f32 v78, v236, v78
  v_add_f32 v79, v237, v79
  v_cvt_pk_bf16_f32 v218, v64, v65
  v_cvt_pk_bf16_f32 v219, v66, v67
  v_cvt_pk_bf16_f32 v220, v68, v69
  v_cvt_pk_bf16_f32 v221, v70, v71
  v_cvt_pk_bf16_f32 v222, v72, v73
  v_cvt_pk_bf16_f32 v223, v74, v75
  v_cvt_pk_bf16_f32 v224, v76, v77
  v_cvt_pk_bf16_f32 v225, v78, v79
  v_mfma_f32_32x32x16_bf16 v[128:143], a[96:99], v[12:15], v[128:143]
  s_waitcnt vmcnt(17)
  ds_read_b64_tr_b16 a[80:81], v192 offset:53248
  ds_read_b64_tr_b16 a[82:83], v192 offset:53760
  ds_read_b64_tr_b16 a[208:209], v214 offset:16384
  buffer_load_dwordx4 v204, s[32:35], s87 offen offset:3072 lds
  v_cvt_pk_bf16_f32 v96, v96, v97
  v_cvt_pk_bf16_f32 v97, v98, v99
  v_cvt_pk_bf16_f32 v98, v100, v101
  v_cvt_pk_bf16_f32 v99, v102, v103
  v_cvt_pk_bf16_f32 v100, v104, v105
  v_cvt_pk_bf16_f32 v101, v106, v107
  v_cvt_pk_bf16_f32 v102, v108, v109
  v_mfma_f32_32x32x16_bf16 v[144:159], a[100:103], v[12:15], v[144:159]
  ds_read_b64_tr_b16 a[84:85], v193 offset:53248
  ds_read_b64_tr_b16 a[86:87], v193 offset:53760
  ds_read_b64_tr_b16 a[210:211], v214 offset:17408
  v_cvt_pk_bf16_f32 v103, v110, v111
  v_add_f32 v64, v64, v72
  v_add_f32 v65, v65, v73
  v_add_f32 v66, v66, v74
  v_add_f32 v67, v67, v75
  v_add_f32 v68, v68, v76
  v_add_f32 v69, v69, v77
  v_add_f32 v70, v70, v78
  v_add_f32 v71, v71, v79
  v_mfma_f32_32x32x16_bf16 v[160:175], a[104:107], v[12:15], v[160:175]
  ds_read_b64_tr_b16 a[88:89], v192 offset:55296
  ds_read_b64_tr_b16 a[90:91], v192 offset:55808
  ds_read_b64_tr_b16 a[212:213], v215 offset:16384
  v_add_f32 v64, v64, v68
  v_add_f32 v65, v65, v69
  v_add_f32 v66, v66, v70
  v_add_f32 v67, v67, v71
  v_add_f32 v64, v64, v66
  v_add_f32 v65, v65, v67
  v_add_f32 v238, v64, v65
  v_mfma_f32_32x32x16_bf16 v[64:79], v[218:221], v[96:99], 0
  v_mfma_f32_32x32x16_bf16 v[64:79], v[222:225], v[100:103], v[64:79]
  v_add_u32 v240, s65, v200
  v_add_u32 v240, 32768, v240
  v_mul_f32 v234, s73, v80
  v_mul_f32 v235, s73, v81
  v_mul_f32 v236, s73, v82
  v_mfma_f32_32x32x16_bf16 v[176:191], a[108:111], v[12:15], v[176:191]
  s_waitcnt lgkmcnt(9)
  ds_read_b64_tr_b16 a[92:93], v193 offset:55296
  ds_read_b64_tr_b16 a[94:95], v193 offset:55808
  ds_read_b64_tr_b16 a[214:215], v215 offset:17408
  v_mul_f32 v237, s73, v83
  v_max_f32 v80, s75, v80
  v_max_f32 v81, s75, v81
  v_max_f32 v82, s75, v82
  v_max_f32 v83, s75, v83
  v_exp_f32_e64 v234, v234 clamp
  v_exp_f32_e64 v235, v235 clamp
  v_mfma_f32_32x32x16_bf16 v[128:143], a[64:67], v[16:19], v[128:143]
  ds_read_b64_tr_b16 a[96:97], v192 offset:57344
  ds_read_b64_tr_b16 a[98:99], v192 offset:57856
  ds_read_b64_tr_b16 a[216:217], v214 offset:18432
  v_exp_f32_e64 v236, v236 clamp
  v_exp_f32_e64 v237, v237 clamp
  v_add_f32 v80, v234, v80
  v_add_f32 v81, v235, v81
  v_add_f32 v82, v236, v82
  v_add_f32 v83, v237, v83
  v_mul_f32 v234, s73, v84
  v_mfma_f32_32x32x16_bf16 v[144:159], a[68:71], v[16:19], v[144:159]
  ds_read_b64_tr_b16 a[100:101], v193 offset:57344
  ds_read_b64_tr_b16 a[102:103], v193 offset:57856
  ds_read_b64_tr_b16 a[218:219], v214 offset:19456
  v_mul_f32 v235, s73, v85
  v_mul_f32 v236, s73, v86
  v_mul_f32 v237, s73, v87
  v_max_f32 v84, s75, v84
  v_max_f32 v85, s75, v85
  v_max_f32 v86, s75, v86
  v_max_f32 v87, s75, v87
  v_exp_f32_e64 v234, v234 clamp
  v_mfma_f32_32x32x16_bf16 v[160:175], a[72:75], v[16:19], v[160:175]
  ds_read_b64_tr_b16 a[104:105], v192 offset:59392
  ds_read_b64_tr_b16 a[106:107], v192 offset:59904
  ds_read_b64_tr_b16 a[220:221], v215 offset:18432
  v_exp_f32_e64 v235, v235 clamp
  v_exp_f32_e64 v236, v236 clamp
  v_exp_f32_e64 v237, v237 clamp
  v_add_f32 v84, v234, v84
  v_add_f32 v85, v235, v85
  v_add_f32 v86, v236, v86
  v_mfma_f32_32x32x16_bf16 v[176:191], a[76:79], v[16:19], v[176:191]
  s_waitcnt lgkmcnt(10)
  ds_read_b64_tr_b16 a[108:109], v193 offset:59392
  ds_read_b64_tr_b16 a[110:111], v193 offset:59904
  ds_read_b64_tr_b16 a[222:223], v215 offset:19456
  v_add_f32 v87, v237, v87
  v_mul_f32 v234, s73, v88
  v_mul_f32 v235, s73, v89
  v_mul_f32 v236, s73, v90
  v_mul_f32 v237, s73, v91
  v_max_f32 v88, s75, v88
  v_max_f32 v89, s75, v89
  v_max_f32 v90, s75, v90
  v_max_f32 v91, s75, v91
  v_mfma_f32_32x32x16_bf16 v[128:143], a[80:83], v[20:23], v[128:143]
  ds_read_b64_tr_b16 a[64:65], v192 offset:61440
  ds_read_b64_tr_b16 a[66:67], v192 offset:61952
  v_exp_f32_e64 v234, v234 clamp
  v_exp_f32_e64 v235, v235 clamp
  v_exp_f32_e64 v236, v236 clamp
  v_exp_f32_e64 v237, v237 clamp
  v_add_f32 v88, v234, v88
  v_add_f32 v89, v235, v89
  v_mfma_f32_32x32x16_bf16 v[144:159], a[84:87], v[20:23], v[144:159]
  ds_read_b64_tr_b16 a[68:69], v193 offset:61440
  ds_read_b64_tr_b16 a[70:71], v193 offset:61952
  v_add_f32 v90, v236, v90
  v_add_f32 v91, v237, v91
  v_mul_f32 v234, s73, v92
  v_mul_f32 v235, s73, v93
  v_mul_f32 v236, s73, v94
  v_mul_f32 v237, s73, v95
  v_max_f32 v92, s75, v92
  v_max_f32 v93, s75, v93
  v_max_f32 v94, s75, v94
  v_max_f32 v95, s75, v95
  v_mfma_f32_32x32x16_bf16 v[160:175], a[88:91], v[20:23], v[160:175]
  ds_read_b64_tr_b16 a[72:73], v192 offset:63488
  ds_read_b64_tr_b16 a[74:75], v192 offset:64000
  v_exp_f32_e64 v234, v234 clamp
  v_exp_f32_e64 v235, v235 clamp
  v_exp_f32_e64 v236, v236 clamp
  v_exp_f32_e64 v237, v237 clamp
  v_add_f32 v92, v234, v92
  v_add_f32 v93, v235, v93
  v_mfma_f32_32x32x16_bf16 v[176:191], a[92:95], v[20:23], v[176:191]
  s_waitcnt lgkmcnt(7)
  ds_read_b64_tr_b16 a[76:77], v193 offset:63488
  ds_read_b64_tr_b16 a[78:79], v193 offset:64000
  v_add_f32 v94, v236, v94
  v_add_f32 v95, v237, v95
  v_cvt_pk_bf16_f32 v226, v80, v81
  v_cvt_pk_bf16_f32 v227, v82, v83
  v_cvt_pk_bf16_f32 v228, v84, v85
  v_cvt_pk_bf16_f32 v229, v86, v87
  v_cvt_pk_bf16_f32 v230, v88, v89
  v_cvt_pk_bf16_f32 v231, v90, v91
  v_cvt_pk_bf16_f32 v232, v92, v93
  v_cvt_pk_bf16_f32 v233, v94, v95
  v_mfma_f32_32x32x16_bf16 v[128:143], a[96:99], v[24:27], v[128:143]
  s_waitcnt vmcnt(14)
  s_barrier
  s_add_u32 m0, s65, 16384
  ds_read_b64_tr_b16 a[80:81], v196 offset:0
  ds_read_b64_tr_b16 a[82:83], v196 offset:512
  buffer_load_dwordx4 v203, s[28:31], s88 offen lds
  v_cvt_pk_bf16_f32 v112, v112, v113
  v_cvt_pk_bf16_f32 v113, v114, v115
  v_cvt_pk_bf16_f32 v114, v116, v117
  v_cvt_pk_bf16_f32 v115, v118, v119
  v_cvt_pk_bf16_f32 v116, v120, v121
  v_cvt_pk_bf16_f32 v117, v122, v123
  v_mfma_f32_32x32x16_bf16 v[144:159], a[100:103], v[24:27], v[144:159]
  ds_read_b64_tr_b16 a[84:85], v197 offset:0
  ds_read_b64_tr_b16 a[86:87], v197 offset:512
  buffer_load_dwordx4 v204, s[28:31], s88 offen offset:1024 lds
  v_cvt_pk_bf16_f32 v118, v124, v125
  v_cvt_pk_bf16_f32 v119, v126, v127
  v_add_f32 v80, v80, v88
  v_add_f32 v81, v81, v89
  v_add_f32 v82, v82, v90
  v_add_f32 v83, v83, v91
  v_add_f32 v84, v84, v92
  v_add_f32 v85, v85, v93
  v_mfma_f32_32x32x16_bf16 v[160:175], a[104:107], v[24:27], v[160:175]
  ds_read_b64_tr_b16 a[88:89], v196 offset:2048
  ds_read_b64_tr_b16 a[90:91], v196 offset:2560
  buffer_load_dwordx4 v203, s[32:35], s88 offen offset:2048 lds
  v_add_f32 v86, v86, v94
  v_add_f32 v87, v87, v95
  v_add_f32 v80, v80, v84
  v_add_f32 v81, v81, v85
  v_add_f32 v82, v82, v86
  v_add_f32 v83, v83, v87
  v_add_f32 v80, v80, v82
  v_add_f32 v81, v81, v83
  v_mfma_f32_32x32x16_bf16 v[176:191], a[108:111], v[24:27], v[176:191]
  s_waitcnt lgkmcnt(6)
  ds_read_b64_tr_b16 a[92:93], v197 offset:2048
  ds_read_b64_tr_b16 a[94:95], v197 offset:2560
  v_add_f32 v239, v80, v81
  v_mfma_f32_32x32x16_bf16 v[80:95], v[226:229], v[112:115], 0
  v_mfma_f32_32x32x16_bf16 v[80:95], v[230:233], v[116:119], v[80:95]
  v_cndmask_b32 v64, v64, v72, s[78:79]
  v_cndmask_b32 v65, v65, v73, s[78:79]
  v_cndmask_b32 v66, v66, v74, s[78:79]
  v_cndmask_b32 v67, v67, v75, s[78:79]
  v_cndmask_b32 v68, v68, v76, s[78:79]
  v_mfma_f32_32x32x16_bf16 v[128:143], a[64:67], v[28:31], v[128:143]
  s_waitcnt vmcnt(13)
  ds_read_b64_tr_b16 a[96:97], v196 offset:4096
  ds_read_b64_tr_b16 a[98:99], v196 offset:4608
  ds_read_b64_tr_b16 a[224:225], v214 offset:32768
  buffer_load_dwordx4 v204, s[32:35], s88 offen offset:3072 lds
  v_cndmask_b32 v69, v69, v77, s[78:79]
  v_cndmask_b32 v70, v70, v78, s[78:79]
  v_cndmask_b32 v71, v71, v79, s[78:79]
  v_mfma_f32_32x32x16_bf16 v[144:159], a[68:71], v[28:31], v[144:159]
  s_add_u32 m0, s65, 65536
  s_add_u32 s1, s15, 131072
  s_and_b32 s1, s1, 262143
  s_add_u32 s1, s1, 1048576
  ds_read_b64_tr_b16 a[100:101], v197 offset:4096
  ds_read_b64_tr_b16 a[102:103], v197 offset:4608
  ds_read_b64_tr_b16 a[226:227], v214 offset:33792
  ds_write_b128 v240, v[64:67] offset:0
  ds_write_b128 v240, v[68:71] offset:1024
  buffer_load_dwordx4 v210, s[52:55], s1 offen lds
  v_permlane32_swap_b32 v238, v239
  v_mfma_f32_32x32x16_bf16 v[160:175], a[72:75], v[28:31], v[160:175]
  ds_read_b64_tr_b16 a[104:105], v196 offset:6144
  ds_read_b64_tr_b16 a[106:107], v196 offset:6656
  ds_read_b64_tr_b16 a[228:229], v215 offset:32768
  buffer_load_dwordx4 v211, s[52:55], s1 offen offset:1024 lds
  v_and_b32 v234, 0xf0, v200
  v_lshrrev_b32 v234, 3, v234
  v_and_b32 v235, 0x300, v200
  v_lshl_add_u32 v234, v235, 4, v234
  v_add_f32 v238, v238, v239
  v_cvt_pk_bf16_f32 v238, v238, v238
  v_lshrrev_b32 v235, 1, v200
  v_mfma_f32_32x32x16_bf16 v[176:191], a[76:79], v[28:31], v[176:191]
  s_waitcnt lgkmcnt(11)
  ds_read_b64_tr_b16 a[108:109], v197 offset:6144
  ds_read_b64_tr_b16 a[110:111], v197 offset:6656
  ds_read_b64_tr_b16 a[230:231], v215 offset:33792
  buffer_store_short v238, v234, s[44:47], s77 offen sc1
  v_cndmask_b32 v80, v80, v88, s[78:79]
  v_cndmask_b32 v81, v81, v89, s[78:79]
  v_cndmask_b32 v82, v82, v90, s[78:79]
  v_cndmask_b32 v83, v83, v91, s[78:79]
  v_cndmask_b32 v84, v84, v92, s[78:79]
  v_cndmask_b32 v85, v85, v93, s[78:79]
  v_cndmask_b32 v86, v86, v94, s[78:79]
  v_mfma_f32_32x32x16_bf16 v[128:143], a[80:83], v[32:35], v[128:143]
  ds_read_b64_tr_b16 a[64:65], v196 offset:8192
  ds_read_b64_tr_b16 a[66:67], v196 offset:8704
  ds_read_b64_tr_b16 a[232:233], v214 offset:34816
  v_cndmask_b32 v87, v87, v95, s[78:79]
  v_mfma_f32_32x32x16_bf16 v[144:159], a[84:87], v[32:35], v[144:159]
  ds_read_b64_tr_b16 a[68:69], v197 offset:8192
  ds_read_b64_tr_b16 a[70:71], v197 offset:8704
  ds_read_b64_tr_b16 a[234:235], v214 offset:35840
  ds_write_b128 v240, v[80:83] offset:2048
  ds_write_b128 v240, v[84:87] offset:3072
  s_and_b32 s12, s64, 1
  s_lshl_b32 s12, s12, 8
  s_lshr_b32 s13, s64, 1
  s_lshl_b32 s13, s13, 11
  s_add_u32 s12, s12, s13
  s_add_u32 s12, s12, 32768
  v_and_b32 v241, 0x2f0, v200
  v_mfma_f32_32x32x16_bf16 v[160:175], a[88:91], v[32:35], v[160:175]
  s_add_u32 s1, s1, 63488
  ds_read_b64_tr_b16 a[72:73], v196 offset:10240
  ds_read_b64_tr_b16 a[74:75], v196 offset:10752
  ds_read_b64_tr_b16 a[236:237], v215 offset:34816
  buffer_load_dwordx4 v210, s[52:55], s1 offen offset:2048 lds
  v_and_b32 v242, 0x100, v200
  v_lshlrev_b32 v242, 2, v242
  v_add3_u32 v242, v242, v241, s12
  v_mfma_f32_32x32x16_bf16 v[176:191], a[92:95], v[32:35], v[176:191]
  s_waitcnt lgkmcnt(12)
  ds_read_b64_tr_b16 a[76:77], v197 offset:10240
  ds_read_b64_tr_b16 a[78:79], v197 offset:10752
  ds_read_b64_tr_b16 a[238:239], v215 offset:35840
  buffer_load_dwordx4 v211, s[52:55], s1 offen offset:3072 lds
  v_mfma_f32_32x32x16_bf16 v[128:143], a[96:99], v[36:39], v[128:143]
  s_waitcnt lgkmcnt(6)
  ds_read_b64_tr_b16 a[80:81], v196 offset:12288
  ds_read_b64_tr_b16 a[82:83], v196 offset:12800
  s_barrier
  ds_read_b128 v[96:99], v242 offset:0
  ds_read_b128 v[100:103], v242 offset:4096
  ds_read_b128 v[104:107], v242 offset:8192
  ds_read_b128 v[108:111], v242 offset:12288
  v_mfma_f32_32x32x16_bf16 v[144:159], a[100:103], v[36:39], v[144:159]
  s_add_u32 m0, s65, 81920
  s_add_u32 s1, s15, 0
  s_and_b32 s1, s1, 524287
  s_add_u32 s1, s1, 1310720
  ds_read_b64_tr_b16 a[84:85], v197 offset:12288
  ds_read_b64_tr_b16 a[86:87], v197 offset:12800
  buffer_load_dwordx4 v210, s[52:55], s1 offen lds
  v_mfma_f32_32x32x16_bf16 v[160:175], a[104:107], v[36:39], v[160:175]
  ds_read_b64_tr_b16 a[88:89], v196 offset:14336
  ds_read_b64_tr_b16 a[90:91], v196 offset:14848
  v_mfma_f32_32x32x16_bf16 v[176:191], a[108:111], v[36:39], v[176:191]
  s_waitcnt lgkmcnt(4)
  ds_read_b64_tr_b16 a[92:93], v197 offset:14336
  ds_read_b64_tr_b16 a[94:95], v197 offset:14848
  buffer_load_dwordx4 v211, s[52:55], s1 offen offset:1024 lds
  v_add_f32 v96, v96, v100
  v_add_f32 v97, v97, v101
  v_add_f32 v98, v98, v102
  v_add_f32 v99, v99, v103
  v_add_f32 v104, v104, v108
  v_add_f32 v105, v105, v109
  v_add_f32 v106, v106, v110
  v_add_f32 v107, v107, v111
  v_mfma_f32_32x32x16_bf16 v[128:143], a[64:67], v[40:43], v[128:143]
  s_waitcnt vmcnt(11)
  s_barrier
  ds_read_b64_tr_b16 a[96:97], v192 offset:0
  ds_read_b64_tr_b16 a[98:99], v192 offset:512
  v_add_f32 v96, v96, v104
  v_add_f32 v97, v97, v105
  v_add_f32 v98, v98, v106
  v_add_f32 v99, v99, v107
  v_cvt_pk_bf16_f32 v100, v96, v97
  v_cvt_pk_bf16_f32 v101, v98, v99
  v_mfma_f32_32x32x16_bf16 v[144:159], a[68:71], v[40:43], v[144:159]
  s_add_u32 m0, s65, 49152
  ds_read_b64_tr_b16 a[100:101], v193 offset:0
  ds_read_b64_tr_b16 a[102:103], v193 offset:512
  buffer_store_dwordx2 v[100:101], v235, s[44:47], s76 offen sc1
  buffer_load_dwordx4 v203, s[28:31], s89 offen lds
  v_mfma_f32_32x32x16_bf16 v[160:175], a[72:75], v[40:43], v[160:175]
  ds_read_b64_tr_b16 a[104:105], v192 offset:2048
  ds_read_b64_tr_b16 a[106:107], v192 offset:2560
  v_mfma_f32_32x32x16_bf16 v[176:191], a[76:79], v[40:43], v[176:191]
  s_waitcnt lgkmcnt(6)
  ds_read_b64_tr_b16 a[108:109], v193 offset:2048
  ds_read_b64_tr_b16 a[110:111], v193 offset:2560
  v_mfma_f32_32x32x16_bf16 v[128:143], a[80:83], v[44:47], v[128:143]
  ds_read_b64_tr_b16 a[64:65], v192 offset:4096
  ds_read_b64_tr_b16 a[66:67], v192 offset:4608
  ds_read_b64_tr_b16 a[240:241], v216 offset:16384
  v_mfma_f32_32x32x16_bf16 v[144:159], a[84:87], v[44:47], v[144:159]
  ds_read_b64_tr_b16 a[68:69], v193 offset:4096
  ds_read_b64_tr_b16 a[70:71], v193 offset:4608
  ds_read_b64_tr_b16 a[242:243], v216 offset:17408
  buffer_load_dwordx4 v204, s[28:31], s89 offen offset:1024 lds
  v_mfma_f32_32x32x16_bf16 v[160:175], a[88:91], v[44:47], v[160:175]
  ds_read_b64_tr_b16 a[72:73], v192 offset:6144
  ds_read_b64_tr_b16 a[74:75], v192 offset:6656
  ds_read_b64_tr_b16 a[244:245], v217 offset:16384
  v_mfma_f32_32x32x16_bf16 v[176:191], a[92:95], v[44:47], v[176:191]
  s_waitcnt lgkmcnt(9)
  ds_read_b64_tr_b16 a[76:77], v193 offset:6144
  ds_read_b64_tr_b16 a[78:79], v193 offset:6656
  ds_read_b64_tr_b16 a[246:247], v217 offset:17408
  v_mfma_f32_32x32x16_bf16 v[128:143], a[96:99], v[48:51], v[128:143]
  ds_read_b64_tr_b16 a[80:81], v192 offset:8192
  ds_read_b64_tr_b16 a[82:83], v192 offset:8704
  ds_read_b64_tr_b16 a[248:249], v216 offset:18432
  buffer_load_dwordx4 v203, s[32:35], s89 offen offset:2048 lds
  v_mfma_f32_32x32x16_bf16 v[144:159], a[100:103], v[48:51], v[144:159]
  ds_read_b64_tr_b16 a[84:85], v193 offset:8192
  ds_read_b64_tr_b16 a[86:87], v193 offset:8704
  ds_read_b64_tr_b16 a[250:251], v216 offset:19456
  v_mfma_f32_32x32x16_bf16 v[160:175], a[104:107], v[48:51], v[160:175]
  ds_read_b64_tr_b16 a[88:89], v192 offset:10240
  ds_read_b64_tr_b16 a[90:91], v192 offset:10752
  ds_read_b64_tr_b16 a[252:253], v217 offset:18432
  buffer_load_dwordx4 v204, s[32:35], s89 offen offset:3072 lds
  v_mfma_f32_32x32x16_bf16 v[176:191], a[108:111], v[48:51], v[176:191]
  s_waitcnt lgkmcnt(10)
  ds_read_b64_tr_b16 a[92:93], v193 offset:10240
  ds_read_b64_tr_b16 a[94:95], v193 offset:10752
  ds_read_b64_tr_b16 a[254:255], v217 offset:19456
  v_mfma_f32_32x32x16_bf16 v[128:143], a[64:67], v[52:55], v[128:143]
  ds_read_b64_tr_b16 a[96:97], v192 offset:12288
  ds_read_b64_tr_b16 a[98:99], v192 offset:12800
  v_mfma_f32_32x32x16_bf16 v[144:159], a[68:71], v[52:55], v[144:159]
  s_add_u32 m0, s65, 81920
  s_add_u32 s1, s1, 63488
  ds_read_b64_tr_b16 a[100:101], v193 offset:12288
  ds_read_b64_tr_b16 a[102:103], v193 offset:12800
  buffer_load_dwordx4 v210, s[52:55], s1 offen offset:2048 lds
  v_mfma_f32_32x32x16_bf16 v[160:175], a[72:75], v[52:55], v[160:175]
  ds_read_b64_tr_b16 a[104:105], v192 offset:14336
  ds_read_b64_tr_b16 a[106:107], v192 offset:14848
  v_mfma_f32_32x32x16_bf16 v[176:191], a[76:79], v[52:55], v[176:191]
  s_waitcnt lgkmcnt(7)
  ds_read_b64_tr_b16 a[108:109], v193 offset:14336
  ds_read_b64_tr_b16 a[110:111], v193 offset:14848
  buffer_load_dwordx4 v211, s[52:55], s1 offen offset:3072 lds
  v_mfma_f32_32x32x16_bf16 v[128:143], a[80:83], v[56:59], v[128:143]
  s_waitcnt vmcnt(14)
  s_barrier
  ds_read_b64_tr_b16 a[64:65], v192 offset:16384
  ds_read_b64_tr_b16 a[66:67], v192 offset:16896
  s_waitcnt vmcnt(6)
  s_barrier
  s_add_u32 s14, s80, 0
  v_mov_b32 v218, 1
  v_mfma_f32_32x32x16_bf16 v[144:159], a[84:87], v[56:59], v[144:159]
  ds_read_b64_tr_b16 a[68:69], v193 offset:16384
  ds_read_b64_tr_b16 a[70:71], v193 offset:16896
  buffer_atomic_add v218, v209, s[44:47], s14 offen sc1
  v_mfma_f32_32x32x16_bf16 v[160:175], a[88:91], v[56:59], v[160:175]
  ds_read_b64_tr_b16 a[72:73], v192 offset:18432
  ds_read_b64_tr_b16 a[74:75], v192 offset:18944
  v_mfma_f32_32x32x16_bf16 v[176:191], a[92:95], v[56:59], v[176:191]
  s_waitcnt lgkmcnt(6)
  ds_read_b64_tr_b16 a[76:77], v193 offset:18432
  ds_read_b64_tr_b16 a[78:79], v193 offset:18944
  v_mfma_f32_32x32x16_bf16 v[128:143], a[96:99], v[60:63], v[128:143]
  s_add_u32 m0, s65, 131072
  ds_read_b64_tr_b16 a[80:81], v192 offset:20480
  ds_read_b64_tr_b16 a[82:83], v192 offset:20992
  buffer_load_dwordx4 v203, s[28:31], s90 offen lds
  v_mfma_f32_32x32x16_bf16 v[144:159], a[100:103], v[60:63], v[144:159]
  ds_read_b64_tr_b16 a[84:85], v193 offset:20480
  ds_read_b64_tr_b16 a[86:87], v193 offset:20992
  v_mfma_f32_32x32x16_bf16 v[160:175], a[104:107], v[60:63], v[160:175]
  ds_read_b64_tr_b16 a[88:89], v192 offset:22528
  ds_read_b64_tr_b16 a[90:91], v192 offset:23040
  buffer_load_dwordx4 v204, s[28:31], s90 offen offset:1024 lds
  v_mfma_f32_32x32x16_bf16 v[176:191], a[108:111], v[60:63], v[176:191]
  s_waitcnt lgkmcnt(6)
  ds_read_b64_tr_b16 a[92:93], v193 offset:22528
  ds_read_b64_tr_b16 a[94:95], v193 offset:23040
  v_mfma_f32_32x32x16_bf16 v[128:143], a[64:67], a[0:3], v[128:143]
  ds_read_b64_tr_b16 a[96:97], v192 offset:24576
  ds_read_b64_tr_b16 a[98:99], v192 offset:25088
  v_mfma_f32_32x32x16_bf16 v[144:159], a[68:71], a[0:3], v[144:159]
  ds_read_b64_tr_b16 a[100:101], v193 offset:24576
  ds_read_b64_tr_b16 a[102:103], v193 offset:25088
  buffer_load_dwordx4 v203, s[32:35], s90 offen offset:2048 lds
  v_mfma_f32_32x32x16_bf16 v[160:175], a[72:75], a[0:3], v[160:175]
  ds_read_b64_tr_b16 a[104:105], v192 offset:26624
  ds_read_b64_tr_b16 a[106:107], v192 offset:27136
  v_mfma_f32_32x32x16_bf16 v[176:191], a[76:79], a[0:3], v[176:191]
  s_waitcnt lgkmcnt(6)
  ds_read_b64_tr_b16 a[108:109], v193 offset:26624
  ds_read_b64_tr_b16 a[110:111], v193 offset:27136
  buffer_load_dwordx4 v204, s[32:35], s90 offen offset:3072 lds
  v_mfma_f32_32x32x16_bf16 v[128:143], a[80:83], a[4:7], v[128:143]
  ds_read_b64_tr_b16 a[64:65], v192 offset:28672
  ds_read_b64_tr_b16 a[66:67], v192 offset:29184
  v_mfma_f32_32x32x16_bf16 v[144:159], a[84:87], a[4:7], v[144:159]
  ds_read_b64_tr_b16 a[68:69], v193 offset:28672
  ds_read_b64_tr_b16 a[70:71], v193 offset:29184
  v_mfma_f32_32x32x16_bf16 v[160:175], a[88:91], a[4:7], v[160:175]
  s_add_u32 m0, s65, 98304
  s_add_u32 s1, s15, 131072
  s_and_b32 s1, s1, 524287
  s_add_u32 s1, s1, 1310720
  ds_read_b64_tr_b16 a[72:73], v192 offset:30720
  ds_read_b64_tr_b16 a[74:75], v192 offset:31232
  buffer_load_dwordx4 v210, s[52:55], s1 offen lds
  v_mfma_f32_32x32x16_bf16 v[176:191], a[92:95], a[4:7], v[176:191]
  s_waitcnt lgkmcnt(6)
  ds_read_b64_tr_b16 a[76:77], v193 offset:30720
  ds_read_b64_tr_b16 a[78:79], v193 offset:31232
  v_mfma_f32_32x32x16_bf16 v[128:143], a[96:99], a[8:11], v[128:143]
  s_waitcnt vmcnt(8)
  s_barrier
  s_getpc_b64 s[12:13]
k_A_pc2:
  s_and_b32 s66, s20, 7
  s_lshl_b32 s66, s66, 2
  s_add_u32 s66, s66, s64
  s_lshl_b32 s66, s66, 9
  s_add_u32 s66, s66, 2048
  v_lshrrev_b32 v208, 1, v200
  v_add_u32 v208, s66, v208
  v_min_u32 v208, k_end-k_A_pc2-8, v208
  global_load_dword v208, v208, s[12:13]
  s_add_u32 m0, s65, 0
  ds_read_b64_tr_b16 a[80:81], v192 offset:49152
  ds_read_b64_tr_b16 a[82:83], v192 offset:49664
  buffer_load_dwordx4 v203, s[28:31], s91 offen lds
  v_mfma_f32_32x32x16_bf16 v[144:159], a[100:103], a[8:11], v[144:159]
  ds_read_b64_tr_b16 a[84:85], v193 offset:49152
  ds_read_b64_tr_b16 a[86:87], v193 offset:49664
  v_mfma_f32_32x32x16_bf16 v[160:175], a[104:107], a[8:11], v[160:175]
  ds_read_b64_tr_b16 a[88:89], v192 offset:51200
  ds_read_b64_tr_b16 a[90:91], v192 offset:51712
  buffer_load_dwordx4 v204, s[28:31], s91 offen offset:1024 lds
  v_mfma_f32_32x32x16_bf16 v[176:191], a[108:111], a[8:11], v[176:191]
  s_waitcnt lgkmcnt(6)
  ds_read_b64_tr_b16 a[92:93], v193 offset:51200
  ds_read_b64_tr_b16 a[94:95], v193 offset:51712
  v_mfma_f32_32x32x16_bf16 v[128:143], a[64:67], a[12:15], v[128:143]
  ds_read_b64_tr_b16 a[96:97], v192 offset:53248
  ds_read_b64_tr_b16 a[98:99], v192 offset:53760
  v_mfma_f32_32x32x16_bf16 v[144:159], a[68:71], a[12:15], v[144:159]
  ds_read_b64_tr_b16 a[100:101], v193 offset:53248
  ds_read_b64_tr_b16 a[102:103], v193 offset:53760
  buffer_load_dwordx4 v203, s[32:35], s91 offen offset:2048 lds
  v_mfma_f32_32x32x16_bf16 v[160:175], a[72:75], a[12:15], v[160:175]
  ds_read_b64_tr_b16 a[104:105], v192 offset:55296
  ds_read_b64_tr_b16 a[106:107], v192 offset:55808
  v_mfma_f32_32x32x16_bf16 v[176:191], a[76:79], a[12:15], v[176:191]
  s_waitcnt lgkmcnt(6)
  ds_read_b64_tr_b16 a[108:109], v193 offset:55296
  ds_read_b64_tr_b16 a[110:111], v193 offset:55808
  buffer_load_dwordx4 v204, s[32:35], s91 offen offset:3072 lds
  v_mfma_f32_32x32x16_bf16 v[128:143], a[80:83], a[16:19], v[128:143]
  ds_read_b64_tr_b16 a[64:65], v192 offset:57344
  ds_read_b64_tr_b16 a[66:67], v192 offset:57856
  v_mfma_f32_32x32x16_bf16 v[144:159], a[84:87], a[16:19], v[144:159]
  ds_read_b64_tr_b16 a[68:69], v193 offset:57344
  ds_read_b64_tr_b16 a[70:71], v193 offset:57856
  v_mfma_f32_32x32x16_bf16 v[160:175], a[88:91], a[16:19], v[160:175]
  s_add_u32 m0, s65, 98304
  ds_read_b64_tr_b16 a[72:73], v192 offset:59392
  ds_read_b64_tr_b16 a[74:75], v192 offset:59904
  buffer_load_dwordx4 v211, s[52:55], s1 offen offset:1024 lds
  v_mfma_f32_32x32x16_bf16 v[176:191], a[92:95], a[16:19], v[176:191]
  s_waitcnt lgkmcnt(6)
  ds_read_b64_tr_b16 a[76:77], v193 offset:59392
  ds_read_b64_tr_b16 a[78:79], v193 offset:59904
  v_mfma_f32_32x32x16_bf16 v[128:143], a[96:99], a[20:23], v[128:143]
  s_add_u32 s1, s1, 63488
  ds_read_b64_tr_b16 a[80:81], v192 offset:61440
  ds_read_b64_tr_b16 a[82:83], v192 offset:61952
  buffer_load_dwordx4 v210, s[52:55], s1 offen offset:2048 lds
  v_mfma_f32_32x32x16_bf16 v[144:159], a[100:103], a[20:23], v[144:159]
  ds_read_b64_tr_b16 a[84:85], v193 offset:61440
  ds_read_b64_tr_b16 a[86:87], v193 offset:61952
  v_mfma_f32_32x32x16_bf16 v[160:175], a[104:107], a[20:23], v[160:175]
  ds_read_b64_tr_b16 a[88:89], v192 offset:63488
  ds_read_b64_tr_b16 a[90:91], v192 offset:64000
  buffer_load_dwordx4 v211, s[52:55], s1 offen offset:3072 lds
  v_mfma_f32_32x32x16_bf16 v[176:191], a[108:111], a[20:23], v[176:191]
  s_waitcnt lgkmcnt(6)
  ds_read_b64_tr_b16 a[92:93], v193 offset:63488
  ds_read_b64_tr_b16 a[94:95], v193 offset:64000
  v_mfma_f32_32x32x16_bf16 v[128:143], a[64:67], a[24:27], v[128:143]
  s_waitcnt vmcnt(9)
  s_barrier
  s_mul_i32 s12, s23, 147456
  ds_read_b64_tr_b16 a[96:97], v196 offset:0
  ds_read_b64_tr_b16 a[98:99], v196 offset:512
  v_mfma_f32_32x32x16_bf16 v[144:159], a[68:71], a[24:27], v[144:159]
  s_add_u32 m0, s65, 16384
  s_lshl_b32 s13, s64, 10
  ds_read_b64_tr_b16 a[100:101], v197 offset:0
  ds_read_b64_tr_b16 a[102:103], v197 offset:512
  buffer_load_dwordx4 v205, s[28:31], s48 offen lds
  v_mfma_f32_32x32x16_bf16 v[160:175], a[72:75], a[24:27], v[160:175]
  s_add_u32 s12, s12, s13
  ds_read_b64_tr_b16 a[104:105], v196 offset:2048
  ds_read_b64_tr_b16 a[106:107], v196 offset:2560
  v_mfma_f32_32x32x16_bf16 v[176:191], a[76:79], a[24:27], v[176:191]
  s_waitcnt lgkmcnt(6)
  ds_read_b64_tr_b16 a[108:109], v197 offset:2048
  ds_read_b64_tr_b16 a[110:111], v197 offset:2560
  v_add_u32 v201, s12, v200
  v_mfma_f32_32x32x16_bf16 v[128:143], a[80:83], a[28:31], v[128:143]
  s_xor_b32 s12, s23, 1
  ds_read_b64_tr_b16 a[64:65], v196 offset:4096
  ds_read_b64_tr_b16 a[66:67], v196 offset:4608
  v_mfma_f32_32x32x16_bf16 v[144:159], a[84:87], a[28:31], v[144:159]
  s_mul_i32 s12, s12, 147456
  ds_read_b64_tr_b16 a[68:69], v197 offset:4096
  ds_read_b64_tr_b16 a[70:71], v197 offset:4608
  buffer_load_dwordx4 v206, s[28:31], s48 offen offset:1024 lds
  v_mfma_f32_32x32x16_bf16 v[160:175], a[88:91], a[28:31], v[160:175]
  s_add_u32 s12, s12, s13
  ds_read_b64_tr_b16 a[72:73], v196 offset:6144
  ds_read_b64_tr_b16 a[74:75], v196 offset:6656
  v_mfma_f32_32x32x16_bf16 v[176:191], a[92:95], a[28:31], v[176:191]
  s_waitcnt lgkmcnt(6)
  ds_read_b64_tr_b16 a[76:77], v197 offset:6144
  ds_read_b64_tr_b16 a[78:79], v197 offset:6656
  v_add_u32 v202, s12, v200
  v_mfma_f32_32x32x16_bf16 v[128:143], a[96:99], a[32:35], v[128:143]
  s_lshr_b32 s12, s19, 2
  ds_read_b64_tr_b16 a[80:81], v196 offset:8192
  ds_read_b64_tr_b16 a[82:83], v196 offset:8704
  v_mfma_f32_32x32x16_bf16 v[144:159], a[100:103], a[32:35], v[144:159]
  s_and_b32 s13, s23, -2
  ds_read_b64_tr_b16 a[84:85], v197 offset:8192
  ds_read_b64_tr_b16 a[86:87], v197 offset:8704
  buffer_load_dwordx4 v205, s[32:35], s48 offen offset:2048 lds
  v_mfma_f32_32x32x16_bf16 v[160:175], a[104:107], a[32:35], v[160:175]
  s_add_u32 s12, s12, s13
  ds_read_b64_tr_b16 a[88:89], v196 offset:10240
  ds_read_b64_tr_b16 a[90:91], v196 offset:10752
  v_mfma_f32_32x32x16_bf16 v[176:191], a[108:111], a[32:35], v[176:191]
  s_waitcnt lgkmcnt(6)
  s_mul_i32 s2, s12, 147456
  ds_read_b64_tr_b16 a[92:93], v197 offset:10240
  ds_read_b64_tr_b16 a[94:95], v197 offset:10752
  v_mfma_f32_32x32x16_bf16 v[128:143], a[64:67], a[36:39], v[128:143]
  s_and_b32 s12, s19, 3
  ds_read_b64_tr_b16 a[96:97], v196 offset:12288
  ds_read_b64_tr_b16 a[98:99], v196 offset:12800
  v_mfma_f32_32x32x16_bf16 v[144:159], a[68:71], a[36:39], v[144:159]
  s_lshl_b32 s12, s12, 2
  ds_read_b64_tr_b16 a[100:101], v197 offset:12288
  ds_read_b64_tr_b16 a[102:103], v197 offset:12800
  buffer_load_dwordx4 v206, s[32:35], s48 offen offset:3072 lds
  v_mfma_f32_32x32x16_bf16 v[160:175], a[72:75], a[36:39], v[160:175]
  s_add_u32 s18, s12, s64
  ds_read_b64_tr_b16 a[104:105], v196 offset:14336
  ds_read_b64_tr_b16 a[106:107], v196 offset:14848
  v_mfma_f32_32x32x16_bf16 v[176:191], a[76:79], a[36:39], v[176:191]
  s_waitcnt lgkmcnt(6)
  ds_read_b64_tr_b16 a[108:109], v197 offset:14336
  ds_read_b64_tr_b16 a[110:111], v197 offset:14848
  v_and_b32 v203, 0xf0, v200
  v_mfma_f32_32x32x16_bf16 v[128:143], a[80:83], a[40:43], v[128:143]
  s_waitcnt vmcnt(7)
  v_lshlrev_b32 v203, 3, v203
  v_and_b32 v204, 0x380, v203
  s_barrier
  ds_read_b64_tr_b16 a[64:65], v192 offset:0
  ds_read_b64_tr_b16 a[66:67], v192 offset:512
  v_mfma_f32_32x32x16_bf16 v[144:159], a[84:87], a[40:43], v[144:159]
  s_add_u32 m0, s65, 49152
  ds_read_b64_tr_b16 a[68:69], v193 offset:0
  ds_read_b64_tr_b16 a[70:71], v193 offset:512
  buffer_load_dwordx4 v205, s[28:31], s49 offen lds
  v_mfma_f32_32x32x16_bf16 v[160:175], a[88:91], a[40:43], v[160:175]
  ds_read_b64_tr_b16 a[72:73], v192 offset:2048
  ds_read_b64_tr_b16 a[74:75], v192 offset:2560
  v_mfma_f32_32x32x16_bf16 v[176:191], a[92:95], a[40:43], v[176:191]
  s_waitcnt lgkmcnt(6)
  ds_read_b64_tr_b16 a[76:77], v193 offset:2048
  ds_read_b64_tr_b16 a[78:79], v193 offset:2560
  v_mfma_f32_32x32x16_bf16 v[128:143], a[96:99], a[44:47], v[128:143]
  ds_read_b64_tr_b16 a[80:81], v192 offset:4096
  ds_read_b64_tr_b16 a[82:83], v192 offset:4608
  v_mfma_f32_32x32x16_bf16 v[144:159], a[100:103], a[44:47], v[144:159]
  ds_read_b64_tr_b16 a[84:85], v193 offset:4096
  ds_read_b64_tr_b16 a[86:87], v193 offset:4608
  buffer_load_dwordx4 v206, s[28:31], s49 offen offset:1024 lds
  v_mfma_f32_32x32x16_bf16 v[160:175], a[104:107], a[44:47], v[160:175]
  ds_read_b64_tr_b16 a[88:89], v192 offset:6144
  ds_read_b64_tr_b16 a[90:91], v192 offset:6656
  v_mfma_f32_32x32x16_bf16 v[176:191], a[108:111], a[44:47], v[176:191]
  s_waitcnt lgkmcnt(6)
  ds_read_b64_tr_b16 a[92:93], v193 offset:6144
  ds_read_b64_tr_b16 a[94:95], v193 offset:6656
  v_mfma_f32_32x32x16_bf16 v[128:143], a[64:67], a[48:51], v[128:143]
  ds_read_b64_tr_b16 a[96:97], v192 offset:8192
  ds_read_b64_tr_b16 a[98:99], v192 offset:8704
  v_mfma_f32_32x32x16_bf16 v[144:159], a[68:71], a[48:51], v[144:159]
  ds_read_b64_tr_b16 a[100:101], v193 offset:8192
  ds_read_b64_tr_b16 a[102:103], v193 offset:8704
  buffer_load_dwordx4 v205, s[32:35], s49 offen offset:2048 lds
  v_mfma_f32_32x32x16_bf16 v[160:175], a[72:75], a[48:51], v[160:175]
  ds_read_b64_tr_b16 a[104:105], v192 offset:10240
  ds_read_b64_tr_b16 a[106:107], v192 offset:10752
  v_mfma_f32_32x32x16_bf16 v[176:191], a[76:79], a[48:51], v[176:191]
  s_waitcnt lgkmcnt(6)
  ds_read_b64_tr_b16 a[108:109], v193 offset:10240
  ds_read_b64_tr_b16 a[110:111], v193 offset:10752
  v_mfma_f32_32x32x16_bf16 v[128:143], a[80:83], a[52:55], v[128:143]
  ds_read_b64_tr_b16 a[64:65], v192 offset:12288
  ds_read_b64_tr_b16 a[66:67], v192 offset:12800
  v_mfma_f32_32x32x16_bf16 v[144:159], a[84:87], a[52:55], v[144:159]
  ds_read_b64_tr_b16 a[68:69], v193 offset:12288
  ds_read_b64_tr_b16 a[70:71], v193 offset:12800
  buffer_load_dwordx4 v206, s[32:35], s49 offen offset:3072 lds
  v_mfma_f32_32x32x16_bf16 v[160:175], a[88:91], a[52:55], v[160:175]
  ds_read_b64_tr_b16 a[72:73], v192 offset:14336
  ds_read_b64_tr_b16 a[74:75], v192 offset:14848
  v_mfma_f32_32x32x16_bf16 v[176:191], a[92:95], a[52:55], v[176:191]
  s_waitcnt lgkmcnt(6)
  ds_read_b64_tr_b16 a[76:77], v193 offset:14336
  ds_read_b64_tr_b16 a[78:79], v193 offset:14848
  v_mfma_f32_32x32x16_bf16 v[128:143], a[96:99], a[56:59], v[128:143]
  s_waitcnt vmcnt(4)
  s_barrier
  ds_read_b64_tr_b16 a[80:81], v198 offset:16384
  ds_read_b64_tr_b16 a[82:83], v198 offset:16640
  v_mfma_f32_32x32x16_bf16 v[144:159], a[100:103], a[56:59], v[144:159]
  s_add_u32 m0, s65, 131072
  ds_read_b64_tr_b16 a[84:85], v198 offset:18432
  ds_read_b64_tr_b16 a[86:87], v198 offset:18688
  buffer_load_dwordx4 v205, s[28:31], s50 offen lds
  v_mfma_f32_32x32x16_bf16 v[160:175], a[104:107], a[56:59], v[160:175]
  s_add_u32 s68, s82, 65536
  buffer_load_dword v207, v209, s[44:47], s68 offen sc1
  ds_read_b64_tr_b16 a[88:89], v198 offset:17408
  ds_read_b64_tr_b16 a[90:91], v198 offset:17664
  v_mfma_f32_32x32x16_bf16 v[176:191], a[108:111], a[56:59], v[176:191]
  s_waitcnt lgkmcnt(6)
  ds_read_b64_tr_b16 a[92:93], v198 offset:19456
  ds_read_b64_tr_b16 a[94:95], v198 offset:19712
  v_mfma_f32_32x32x16_bf16 v[128:143], a[64:67], a[60:63], v[128:143]
  ds_read_b64_tr_b16 a[96:97], v198 offset:20480
  ds_read_b64_tr_b16 a[98:99], v198 offset:20736
  v_mfma_f32_32x32x16_bf16 v[144:159], a[68:71], a[60:63], v[144:159]
  ds_read_b64_tr_b16 a[100:101], v198 offset:22528
  ds_read_b64_tr_b16 a[102:103], v198 offset:22784
  buffer_load_dwordx4 v206, s[28:31], s50 offen offset:1024 lds
  v_mfma_f32_32x32x16_bf16 v[160:175], a[72:75], a[60:63], v[160:175]
  ds_read_b64_tr_b16 a[104:105], v198 offset:21504
  ds_read_b64_tr_b16 a[106:107], v198 offset:21760
  v_mfma_f32_32x32x16_bf16 v[176:191], a[76:79], a[60:63], v[176:191]
  s_waitcnt lgkmcnt(6)
  ds_read_b64_tr_b16 a[108:109], v198 offset:23552
  ds_read_b64_tr_b16 a[110:111], v198 offset:23808
  v_mfma_f32_32x32x16_bf16 v[64:79], a[80:83], v[0:3], 0
  ds_read_b64_tr_b16 a[64:65], v198 offset:24576
  ds_read_b64_tr_b16 a[66:67], v198 offset:24832
  v_mfma_f32_32x32x16_bf16 v[80:95], a[84:87], v[0:3], 0
  ds_read_b64_tr_b16 a[68:69], v198 offset:26624
  ds_read_b64_tr_b16 a[70:71], v198 offset:26880
  buffer_load_dwordx4 v205, s[32:35], s50 offen offset:2048 lds
  v_mfma_f32_32x32x16_bf16 v[64:79], a[88:91], v[4:7], v[64:79]
  ds_read_b64_tr_b16 a[72:73], v198 offset:25600
  ds_read_b64_tr_b16 a[74:75], v198 offset:25856
  v_mul_f32 v128, s72, v128
  v_mul_f32 v129, s72, v129
  v_mul_f32 v130, s72, v130
  v_mul_f32 v131, s72, v131
  v_mfma_f32_32x32x16_bf16 v[80:95], a[92:95], v[4:7], v[80:95]
  s_waitcnt lgkmcnt(6)
  ds_read_b64_tr_b16 a[76:77], v198 offset:27648
  ds_read_b64_tr_b16 a[78:79], v198 offset:27904
  v_exp_f32 v128, v128
  v_exp_f32 v129, v129
  v_mfma_f32_32x32x16_bf16 v[64:79], a[96:99], v[8:11], v[64:79]
  ds_read_b64_tr_b16 a[80:81], v198 offset:28672
  ds_read_b64_tr_b16 a[82:83], v198 offset:28928
  v_exp_f32 v130, v130
  v_exp_f32 v131, v131
  v_add_f32 v128, 1.0, v128
  v_mfma_f32_32x32x16_bf16 v[80:95], a[100:103], v[8:11], v[80:95]
  ds_read_b64_tr_b16 a[84:85], v198 offset:30720
  ds_read_b64_tr_b16 a[86:87], v198 offset:30976
  buffer_load_dwordx4 v206, s[32:35], s50 offen offset:3072 lds
  v_add_f32 v129, 1.0, v129
  v_add_f32 v130, 1.0, v130
  v_add_f32 v131, 1.0, v131
  v_mfma_f32_32x32x16_bf16 v[64:79], a[104:107], v[12:15], v[64:79]
  ds_read_b64_tr_b16 a[88:89], v198 offset:29696
  ds_read_b64_tr_b16 a[90:91], v198 offset:29952
  v_rcp_f32 v128, v128
  v_rcp_f32 v129, v129
  v_mfma_f32_32x32x16_bf16 v[80:95], a[108:111], v[12:15], v[80:95]
  s_waitcnt lgkmcnt(6)
  ds_read_b64_tr_b16 a[92:93], v198 offset:31744
  ds_read_b64_tr_b16 a[94:95], v198 offset:32000
  v_rcp_f32 v130, v130
  v_rcp_f32 v131, v131
  v_mul_f32 v160, v128, v160
  v_mfma_f32_32x32x16_bf16 v[64:79], a[64:67], v[16:19], v[64:79]
  s_waitcnt vmcnt(5)
  s_barrier
  ds_read_b64_tr_b16 a[96:97], v198 offset:49152
  ds_read_b64_tr_b16 a[98:99], v198 offset:49408
  v_mul_f32 v161, v129, v161
  v_mul_f32 v162, v130, v162
  v_mul_f32 v163, v131, v163
  v_cvt_pk_bf16_f32 v240, v160, v161
  v_mfma_f32_32x32x16_bf16 v[80:95], a[68:71], v[16:19], v[80:95]
  s_add_u32 m0, s65, 0
  ds_read_b64_tr_b16 a[100:101], v198 offset:51200
  ds_read_b64_tr_b16 a[102:103], v198 offset:51456
  buffer_load_dwordx4 v205, s[28:31], s51 offen lds
  v_cvt_pk_bf16_f32 v241, v162, v163
  v_mul_f32 v132, s72, v132
  v_mul_f32 v133, s72, v133
  v_mul_f32 v134, s72, v134
  v_mfma_f32_32x32x16_bf16 v[64:79], a[72:75], v[20:23], v[64:79]
  ds_read_b64_tr_b16 a[104:105], v198 offset:50176
  ds_read_b64_tr_b16 a[106:107], v198 offset:50432
  v_mul_f32 v135, s72, v135
  v_exp_f32 v132, v132
  v_exp_f32 v133, v133
  v_mfma_f32_32x32x16_bf16 v[80:95], a[76:79], v[20:23], v[80:95]
  s_waitcnt lgkmcnt(6)
  ds_read_b64_tr_b16 a[108:109], v198 offset:52224
  ds_read_b64_tr_b16 a[110:111], v198 offset:52480
  v_exp_f32 v134, v134
  v_exp_f32 v135, v135
  v_add_f32 v132, 1.0, v132
  v_mfma_f32_32x32x16_bf16 v[64:79], a[80:83], v[24:27], v[64:79]
  ds_read_b64_tr_b16 a[64:65], v198 offset:53248
  ds_read_b64_tr_b16 a[66:67], v198 offset:53504
  buffer_load_dwordx4 v206, s[28:31], s51 offen offset:1024 lds
  v_add_f32 v133, 1.0, v133
  v_add_f32 v134, 1.0, v134
  v_add_f32 v135, 1.0, v135
  v_mfma_f32_32x32x16_bf16 v[80:95], a[84:87], v[24:27], v[80:95]
  ds_read_b64_tr_b16 a[68:69], v198 offset:55296
  ds_read_b64_tr_b16 a[70:71], v198 offset:55552
  v_rcp_f32 v132, v132
  v_rcp_f32 v133, v133
  v_mfma_f32_32x32x16_bf16 v[64:79], a[88:91], v[28:31], v[64:79]
  ds_read_b64_tr_b16 a[72:73], v198 offset:54272
  ds_read_b64_tr_b16 a[74:75], v198 offset:54528
  v_rcp_f32 v134, v134
  v_rcp_f32 v135, v135
  v_mul_f32 v164, v132, v164
  v_mfma_f32_32x32x16_bf16 v[80:95], a[92:95], v[28:31], v[80:95]
  s_waitcnt lgkmcnt(6)
  ds_read_b64_tr_b16 a[76:77], v198 offset:56320
  ds_read_b64_tr_b16 a[78:79], v198 offset:56576
  v_mul_f32 v165, v133, v165
  v_mul_f32 v166, v134, v166
  v_mul_f32 v167, v135, v167
  v_cvt_pk_bf16_f32 v242, v164, v165
  v_cvt_pk_bf16_f32 v243, v166, v167
  v_mfma_f32_32x32x16_bf16 v[64:79], a[96:99], v[32:35], v[64:79]
  ds_read_b64_tr_b16 a[80:81], v198 offset:57344
  ds_read_b64_tr_b16 a[82:83], v198 offset:57600
  buffer_store_dwordx4 v[240:243], v200, s[44:47], s70 offen offset:0 sc1
  buffer_load_dwordx4 v205, s[32:35], s51 offen offset:2048 lds
  v_mul_f32 v136, s72, v136
  v_mul_f32 v137, s72, v137
  v_mfma_f32_32x32x16_bf16 v[80:95], a[100:103], v[32:35], v[80:95]
  ds_read_b64_tr_b16 a[84:85], v198 offset:59392
  ds_read_b64_tr_b16 a[86:87], v198 offset:59648
  v_mul_f32 v138, s72, v138
  v_mul_f32 v139, s72, v139
  v_exp_f32 v136, v136
  v_mfma_f32_32x32x16_bf16 v[64:79], a[104:107], v[36:39], v[64:79]
  ds_read_b64_tr_b16 a[88:89], v198 offset:58368
  ds_read_b64_tr_b16 a[90:91], v198 offset:58624
  v_exp_f32 v137, v137
  v_exp_f32 v138, v138
  v_mfma_f32_32x32x16_bf16 v[80:95], a[108:111], v[36:39], v[80:95]
  s_waitcnt lgkmcnt(6)
  ds_read_b64_tr_b16 a[92:93], v198 offset:60416
  ds_read_b64_tr_b16 a[94:95], v198 offset:60672
  v_exp_f32 v139, v139
  v_add_f32 v136, 1.0, v136
  v_add_f32 v137, 1.0, v137
  v_add_f32 v138, 1.0, v138
  v_mfma_f32_32x32x16_bf16 v[64:79], a[64:67], v[40:43], v[64:79]
  ds_read_b64_tr_b16 a[96:97], v198 offset:61440
  ds_read_b64_tr_b16 a[98:99], v198 offset:61696
  v_add_f32 v139, 1.0, v139
  v_rcp_f32 v136, v136
  v_rcp_f32 v137, v137
  v_mfma_f32_32x32x16_bf16 v[80:95], a[68:71], v[40:43], v[80:95]
  ds_read_b64_tr_b16 a[100:101], v198 offset:63488
  ds_read_b64_tr_b16 a[102:103], v198 offset:63744
  v_rcp_f32 v138, v138
  v_rcp_f32 v139, v139
  v_mul_f32 v168, v136, v168
  v_mfma_f32_32x32x16_bf16 v[64:79], a[72:75], v[44:47], v[64:79]
  ds_read_b64_tr_b16 a[104:105], v198 offset:62464
  ds_read_b64_tr_b16 a[106:107], v198 offset:62720
  buffer_load_dwordx4 v206, s[32:35], s51 offen offset:3072 lds
  v_mul_f32 v169, v137, v169
  v_mul_f32 v170, v138, v170
  v_mul_f32 v171, v139, v171
  v_cvt_pk_bf16_f32 v244, v168, v169
  v_mfma_f32_32x32x16_bf16 v[80:95], a[76:79], v[44:47], v[80:95]
  s_waitcnt lgkmcnt(6)
  ds_read_b64_tr_b16 a[108:109], v198 offset:64512
  ds_read_b64_tr_b16 a[110:111], v198 offset:64768
  v_cvt_pk_bf16_f32 v245, v170, v171
  v_mul_f32 v140, s72, v140
  v_mul_f32 v141, s72, v141
  v_mul_f32 v142, s72, v142
  v_mul_f32 v143, s72, v143
  v_mfma_f32_32x32x16_bf16 v[64:79], a[80:83], v[48:51], v[64:79]
  s_waitcnt vmcnt(8)
  v_readfirstlane_b32 s66, v207
  s_mul_i32 s67, s83, 8
  s_nop 0
  s_bfe_u32 s66, s66, 524288
  s_cmp_eq_u32 s66, s67
  s_cbranch_scc0 k_A_c0_spin
k_A_c0_ok:
  s_waitcnt vmcnt(5)
  s_barrier
  ds_read_b64_tr_b16 a[64:65], v199 offset:0
  ds_read_b64_tr_b16 a[66:67], v199 offset:256
  v_exp_f32 v140, v140
  v_exp_f32 v141, v141
  v_mfma_f32_32x32x16_bf16 v[80:95], a[84:87], v[48:51], v[80:95]
  ds_read_b64_tr_b16 a[68:69], v199 offset:2048
  ds_read_b64_tr_b16 a[70:71], v199 offset:2304
  v_exp_f32 v142, v142
  v_exp_f32 v143, v143
  v_add_f32 v140, 1.0, v140
  v_mfma_f32_32x32x16_bf16 v[64:79], a[88:91], v[52:55], v[64:79]
  s_add_u32 m0, s65, 114688
  s_add_u32 s1, s15, 262144
  s_and_b32 s1, s1, 524287
  s_add_u32 s1, s1, 1310720
  ds_read_b64_tr_b16 a[72:73], v199 offset:1024
  ds_read_b64_tr_b16 a[74:75], v199 offset:1280
  buffer_load_dwordx4 v210, s[52:55], s1 offen lds
  v_add_f32 v141, 1.0, v141
  v_add_f32 v142, 1.0, v142
  v_add_f32 v143, 1.0, v143
  v_mfma_f32_32x32x16_bf16 v[80:95], a[92:95], v[52:55], v[80:95]
  s_waitcnt lgkmcnt(6)
  ds_read_b64_tr_b16 a[76:77], v199 offset:3072
  ds_read_b64_tr_b16 a[78:79], v199 offset:3328
  buffer_load_dwordx4 v211, s[52:55], s1 offen offset:1024 lds
  v_rcp_f32 v140, v140
  v_rcp_f32 v141, v141
  v_mfma_f32_32x32x16_bf16 v[64:79], a[96:99], v[56:59], v[64:79]
  ds_read_b64_tr_b16 a[80:81], v199 offset:4096
  ds_read_b64_tr_b16 a[82:83], v199 offset:4352
  v_rcp_f32 v142, v142
  v_rcp_f32 v143, v143
  v_mul_f32 v172, v140, v172
  v_mfma_f32_32x32x16_bf16 v[80:95], a[100:103], v[56:59], v[80:95]
  s_add_u32 s1, s1, 63488
  ds_read_b64_tr_b16 a[84:85], v199 offset:6144
  ds_read_b64_tr_b16 a[86:87], v199 offset:6400
  buffer_load_dwordx4 v210, s[52:55], s1 offen offset:2048 lds
  v_mul_f32 v173, v141, v173
  v_mul_f32 v174, v142, v174
  v_mul_f32 v175, v143, v175
  v_cvt_pk_bf16_f32 v246, v172, v173
  v_mfma_f32_32x32x16_bf16 v[64:79], a[104:107], v[60:63], v[64:79]
  ds_read_b64_tr_b16 a[88:89], v199 offset:5120
  ds_read_b64_tr_b16 a[90:91], v199 offset:5376
  v_cvt_pk_bf16_f32 v247, v174, v175
  v_mfma_f32_32x32x16_bf16 v[80:95], a[108:111], v[60:63], v[80:95]
  s_waitcnt lgkmcnt(6)
  ds_read_b64_tr_b16 a[92:93], v199 offset:7168
  ds_read_b64_tr_b16 a[94:95], v199 offset:7424
  buffer_store_dwordx4 v[244:247], v200, s[44:47], s70 offen offset:1024 sc1
  buffer_load_dwordx4 v211, s[52:55], s1 offen offset:3072 lds
  v_mul_f32 v144, s72, v144
  v_mul_f32 v145, s72, v145
  v_mfma_f32_32x32x16_bf16 v[64:79], a[64:67], a[0:3], v[64:79]
  ds_read_b64_tr_b16 a[96:97], v199 offset:8192
  ds_read_b64_tr_b16 a[98:99], v199 offset:8448
  v_mul_f32 v146, s72, v146
  v_mul_f32 v147, s72, v147
  v_exp_f32 v144, v144
  v_mfma_f32_32x32x16_bf16 v[80:95], a[68:71], a[0:3], v[80:95]
  ds_read_b64_tr_b16 a[100:101], v199 offset:10240
  ds_read_b64_tr_b16 a[102:103], v199 offset:10496
  v_exp_f32 v145, v145
  v_exp_f32 v146, v146
  v_mfma_f32_32x32x16_bf16 v[64:79], a[72:75], a[4:7], v[64:79]
  ds_read_b64_tr_b16 a[104:105], v199 offset:9216
  ds_read_b64_tr_b16 a[106:107], v199 offset:9472
  v_exp_f32 v147, v147
  v_add_f32 v144, 1.0, v144
  v_add_f32 v145, 1.0, v145
  v_add_f32 v146, 1.0, v146
  v_mfma_f32_32x32x16_bf16 v[80:95], a[76:79], a[4:7], v[80:95]
  s_waitcnt lgkmcnt(6)
  ds_read_b64_tr_b16 a[108:109], v199 offset:11264
  ds_read_b64_tr_b16 a[110:111], v199 offset:11520
  v_add_f32 v147, 1.0, v147
  v_rcp_f32 v144, v144
  v_rcp_f32 v145, v145
  v_mfma_f32_32x32x16_bf16 v[64:79], a[80:83], a[8:11], v[64:79]
  s_lshr_b32 s3, s15, 4
  s_and_b32 s3, s3, 32767
  ds_read_b64_tr_b16 a[64:65], v199 offset:12288
  ds_read_b64_tr_b16 a[66:67], v199 offset:12544
  buffer_load_dwordx4 v[0:3], v201, s[44:47], s3 offen sc1
  v_rcp_f32 v146, v146
  v_rcp_f32 v147, v147
  v_mfma_f32_32x32x16_bf16 v[80:95], a[84:87], a[8:11], v[80:95]
  ds_read_b64_tr_b16 a[68:69], v199 offset:14336
  ds_read_b64_tr_b16 a[70:71], v199 offset:14592
  buffer_load_dwordx4 v[4:7], v202, s[44:47], s3 offen sc1
  v_mul_f32 v176, v144, v176
  v_mul_f32 v177, v145, v177
  v_mul_f32 v178, v146, v178
  v_mul_f32 v179, v147, v179
  v_mfma_f32_32x32x16_bf16 v[64:79], a[88:91], a[12:15], v[64:79]
  ds_read_b64_tr_b16 a[72:73], v199 offset:13312
  ds_read_b64_tr_b16 a[74:75], v199 offset:13568
  v_cvt_pk_bf16_f32 v248, v176, v177
  v_cvt_pk_bf16_f32 v249, v178, v179
  v_mul_f32 v148, s72, v148
  v_mul_f32 v149, s72, v149
  v_mul_f32 v150, s72, v150
  v_mfma_f32_32x32x16_bf16 v[80:95], a[92:95], a[12:15], v[80:95]
  s_waitcnt lgkmcnt(6)
  s_add_u32 s3, s3, 4096
  s_and_b32 s3, s3, 32767
  ds_read_b64_tr_b16 a[76:77], v199 offset:15360
  ds_read_b64_tr_b16 a[78:79], v199 offset:15616
  buffer_load_dwordx4 v[8:11], v201, s[44:47], s3 offen sc1
  v_mul_f32 v151, s72, v151
  v_exp_f32 v148, v148
  v_mfma_f32_32x32x16_bf16 v[64:79], a[96:99], a[16:19], v[64:79]
  s_waitcnt vmcnt(8)
  s_barrier
  ds_read_b64_tr_b16 a[80:81], v198 offset:0
  ds_read_b64_tr_b16 a[82:83], v198 offset:256
  v_exp_f32 v149, v149
  v_exp_f32 v150, v150
  v_mfma_f32_32x32x16_bf16 v[80:95], a[100:103], a[16:19], v[80:95]
  ds_read_b64_tr_b16 a[84:85], v198 offset:2048
  ds_read_b64_tr_b16 a[86:87], v198 offset:2304
  buffer_load_dwordx4 v[12:15], v202, s[44:47], s3 offen sc1
  v_exp_f32 v151, v151
  v_add_f32 v148, 1.0, v148
  v_add_f32 v149, 1.0, v149
  v_mfma_f32_32x32x16_bf16 v[64:79], a[104:107], a[20:23], v[64:79]
  ds_read_b64_tr_b16 a[88:89], v198 offset:1024
  ds_read_b64_tr_b16 a[90:91], v198 offset:1280
  v_add_f32 v150, 1.0, v150
  v_add_f32 v151, 1.0, v151
  v_rcp_f32 v148, v148
  v_mfma_f32_32x32x16_bf16 v[80:95], a[108:111], a[20:23], v[80:95]
  s_waitcnt lgkmcnt(6)
  ds_read_b64_tr_b16 a[92:93], v198 offset:3072
  ds_read_b64_tr_b16 a[94:95], v198 offset:3328
  v_rcp_f32 v149, v149
  v_rcp_f32 v150, v150
  v_mfma_f32_32x32x16_bf16 v[64:79], a[64:67], a[24:27], v[64:79]
  s_add_u32 s3, s3, 4096
  s_and_b32 s3, s3, 32767
  ds_read_b64_tr_b16 a[96:97], v198 offset:4096
  ds_read_b64_tr_b16 a[98:99], v198 offset:4352
  buffer_load_dwordx4 v[16:19], v201, s[44:47], s3 offen sc1
  v_rcp_f32 v151, v151
  v_mul_f32 v180, v148, v180
  v_mul_f32 v181, v149, v181
  v_mfma_f32_32x32x16_bf16 v[80:95], a[68:71], a[24:27], v[80:95]
  ds_read_b64_tr_b16 a[100:101], v198 offset:6144
  ds_read_b64_tr_b16 a[102:103], v198 offset:6400
  buffer_load_dwordx4 v[20:23], v202, s[44:47], s3 offen sc1
  v_mul_f32 v182, v150, v182
  v_mul_f32 v183, v151, v183
  v_cvt_pk_bf16_f32 v250, v180, v181
  v_cvt_pk_bf16_f32 v251, v182, v183
  v_mfma_f32_32x32x16_bf16 v[64:79], a[72:75], a[28:31], v[64:79]
  ds_read_b64_tr_b16 a[104:105], v198 offset:5120
  ds_read_b64_tr_b16 a[106:107], v198 offset:5376
  buffer_store_dwordx4 v[248:251], v200, s[44:47], s70 offen offset:2048 sc1
  v_mul_f32 v152, s72, v152
  v_mul_f32 v153, s72, v153
  v_mul_f32 v154, s72, v154
  v_mfma_f32_32x32x16_bf16 v[80:95], a[76:79], a[28:31], v[80:95]
  s_waitcnt lgkmcnt(6)
  ds_read_b64_tr_b16 a[108:109], v198 offset:7168
  ds_read_b64_tr_b16 a[110:111], v198 offset:7424
  v_mul_f32 v155, s72, v155
  v_exp_f32 v152, v152
  v_exp_f32 v153, v153
  v_mfma_f32_32x32x16_bf16 v[64:79], a[80:83], a[32:35], v[64:79]
  ds_read_b64_tr_b16 a[64:65], v198 offset:8192
  ds_read_b64_tr_b16 a[66:67], v198 offset:8448
  v_exp_f32 v154, v154
  v_exp_f32 v155, v155
  v_add_f32 v152, 1.0, v152
  v_mfma_f32_32x32x16_bf16 v[80:95], a[84:87], a[32:35], v[80:95]
  s_add_u32 s3, s3, 4096
  s_and_b32 s3, s3, 32767
  ds_read_b64_tr_b16 a[68:69], v198 offset:10240
  ds_read_b64_tr_b16 a[70:71], v198 offset:10496
  buffer_load_dwordx4 v[24:27], v201, s[44:47], s3 offen sc1
  v_add_f32 v153, 1.0, v153
  v_add_f32 v154, 1.0, v154
  v_add_f32 v155, 1.0, v155
  v_mfma_f32_32x32x16_bf16 v[64:79], a[88:91], a[36:39], v[64:79]
  ds_read_b64_tr_b16 a[72:73], v198 offset:9216
  ds_read_b64_tr_b16 a[74:75], v198 offset:9472
  v_rcp_f32 v152, v152
  v_rcp_f32 v153, v153
  v_mfma_f32_32x32x16_bf16 v[80:95], a[92:95], a[36:39], v[80:95]
  s_waitcnt lgkmcnt(6)
  ds_read_b64_tr_b16 a[76:77], v198 offset:11264
  ds_read_b64_tr_b16 a[78:79], v198 offset:11520
  buffer_load_dwordx4 v[28:31], v202, s[44:47], s3 offen sc1
  v_rcp_f32 v154, v154
  v_rcp_f32 v155, v155
  v_mfma_f32_32x32x16_bf16 v[64:79], a[96:99], a[40:43], v[64:79]
  ds_read_b64_tr_b16 a[80:81], v198 offset:12288
  ds_read_b64_tr_b16 a[82:83], v198 offset:12544
  v_mul_f32 v184, v152, v184
  v_mul_f32 v185, v153, v185
  v_mul_f32 v186, v154, v186
  v_mul_f32 v187, v155, v187
  v_cvt_pk_bf16_f32 v240, v184, v185
  v_mfma_f32_32x32x16_bf16 v[80:95], a[100:103], a[40:43], v[80:95]
  s_add_u32 s3, s3, 4096
  s_and_b32 s3, s3, 32767
  ds_read_b64_tr_b16 a[84:85], v198 offset:14336
  ds_read_b64_tr_b16 a[86:87], v198 offset:14592
  buffer_load_dwordx4 v[32:35], v201, s[44:47], s3 offen sc1
  v_cvt_pk_bf16_f32 v241, v186, v187
  v_mul_f32 v156, s72, v156
  v_mul_f32 v157, s72, v157
  v_mfma_f32_32x32x16_bf16 v[64:79], a[104:107], a[44:47], v[64:79]
  ds_read_b64_tr_b16 a[88:89], v198 offset:13312
  ds_read_b64_tr_b16 a[90:91], v198 offset:13568
  v_mul_f32 v158, s72, v158
  v_mul_f32 v159, s72, v159
  v_exp_f32 v156, v156
  v_mfma_f32_32x32x16_bf16 v[80:95], a[108:111], a[44:47], v[80:95]
  s_waitcnt lgkmcnt(6)
  ds_read_b64_tr_b16 a[92:93], v198 offset:15360
  ds_read_b64_tr_b16 a[94:95], v198 offset:15616
  buffer_load_dwordx4 v[36:39], v202, s[44:47], s3 offen sc1
  v_exp_f32 v157, v157
  v_mfma_f32_32x32x16_bf16 v[64:79], a[64:67], a[48:51], v[64:79]
  v_exp_f32 v158, v158
  v_exp_f32 v159, v159
  v_add_f32 v156, 1.0, v156
  v_mfma_f32_32x32x16_bf16 v[80:95], a[68:71], a[48:51], v[80:95]
  v_add_f32 v157, 1.0, v157
  v_add_f32 v158, 1.0, v158
  v_add_f32 v159, 1.0, v159
  v_rcp_f32 v156, v156
  v_mfma_f32_32x32x16_bf16 v[64:79], a[72:75], a[52:55], v[64:79]
  s_add_u32 s3, s3, 4096
  s_and_b32 s3, s3, 32767
  buffer_load_dwordx4 v[40:43], v201, s[44:47], s3 offen sc1
  v_rcp_f32 v157, v157
  v_mfma_f32_32x32x16_bf16 v[80:95], a[76:79], a[52:55], v[80:95]
  s_waitcnt lgkmcnt(0)
  v_rcp_f32 v158, v158
  v_rcp_f32 v159, v159
  v_mul_f32 v188, v156, v188
  v_mfma_f32_32x32x16_bf16 v[64:79], a[80:83], a[56:59], v[64:79]
  buffer_load_dwordx4 v[44:47], v202, s[44:47], s3 offen sc1
  v_mul_f32 v189, v157, v189
  v_mul_f32 v190, v158, v190
  v_mul_f32 v191, v159, v191
  v_mfma_f32_32x32x16_bf16 v[80:95], a[84:87], a[56:59], v[80:95]
  v_cvt_pk_bf16_f32 v242, v188, v189
  v_cvt_pk_bf16_f32 v243, v190, v191
  v_mfma_f32_32x32x16_bf16 v[64:79], a[88:91], a[60:63], v[64:79]
  buffer_store_dwordx4 v[240:243], v200, s[44:47], s70 offen offset:3072 sc1
  v_mfma_f32_32x32x16_bf16 v[80:95], a[92:95], a[60:63], v[80:95]
  s_nop 9
  v_pk_mul_f32 v[64:65], v[64:65], s[72:73] op_sel_hi:[1,0]
  v_pk_mul_f32 v[66:67], v[66:67], s[72:73] op_sel_hi:[1,0]
  v_exp_f32 v64, v64
  v_exp_f32 v65, v65
  v_exp_f32 v66, v66
  v_exp_f32 v67, v67
  v_pk_add_f32 v[64:65], v[64:65], 1.0 op_sel_hi:[1,0]
  v_pk_add_f32 v[66:67], v[66:67], 1.0 op_sel_hi:[1,0]
  v_rcp_f32 v64, v64
  v_rcp_f32 v65, v65
  v_rcp_f32 v66, v66
  v_rcp_f32 v67, v67
  s_add_u32 s3, s3, 4096
  s_and_b32 s3, s3, 32767
  buffer_load_dwordx4 v[48:51], v201, s[44:47], s3 offen sc1
  v_pk_mul_f32 v[80:81], v[64:65], v[80:81]
  v_pk_mul_f32 v[82:83], v[66:67], v[82:83]
  v_cvt_pk_bf16_f32 v240, v80, v81
  v_cvt_pk_bf16_f32 v241, v82, v83
  v_pk_mul_f32 v[68:69], v[68:69], s[72:73] op_sel_hi:[1,0]
  v_pk_mul_f32 v[70:71], v[70:71], s[72:73] op_sel_hi:[1,0]
  v_exp_f32 v68, v68
  v_exp_f32 v69, v69
  v_exp_f32 v70, v70
  v_exp_f32 v71, v71
  v_pk_add_f32 v[68:69], v[68:69], 1.0 op_sel_hi:[1,0]
  v_pk_add_f32 v[70:71], v[70:71], 1.0 op_sel_hi:[1,0]
  buffer_load_dwordx4 v[52:55], v202, s[44:47], s3 offen sc1
  v_rcp_f32 v68, v68
  v_rcp_f32 v69, v69
  v_rcp_f32 v70, v70
  v_rcp_f32 v71, v71
  v_pk_mul_f32 v[84:85], v[68:69], v[84:85]
  v_pk_mul_f32 v[86:87], v[70:71], v[86:87]
  v_cvt_pk_bf16_f32 v242, v84, v85
  v_cvt_pk_bf16_f32 v243, v86, v87
  buffer_store_dwordx4 v[240:243], v200, s[44:47], s71 offen offset:0 sc1
  v_pk_mul_f32 v[72:73], v[72:73], s[72:73] op_sel_hi:[1,0]
  v_pk_mul_f32 v[74:75], v[74:75], s[72:73] op_sel_hi:[1,0]
  v_exp_f32 v72, v72
  s_add_u32 s3, s3, 4096
  s_and_b32 s3, s3, 32767
  buffer_load_dwordx4 v[56:59], v201, s[44:47], s3 offen sc1
  v_exp_f32 v73, v73
  v_exp_f32 v74, v74
  v_exp_f32 v75, v75
  v_pk_add_f32 v[72:73], v[72:73], 1.0 op_sel_hi:[1,0]
  v_pk_add_f32 v[74:75], v[74:75], 1.0 op_sel_hi:[1,0]
  v_rcp_f32 v72, v72
  v_rcp_f32 v73, v73
  v_rcp_f32 v74, v74
  v_rcp_f32 v75, v75
  v_pk_mul_f32 v[88:89], v[72:73], v[88:89]
  v_pk_mul_f32 v[90:91], v[74:75], v[90:91]
  v_cvt_pk_bf16_f32 v244, v88, v89
  buffer_load_dwordx4 v[60:63], v202, s[44:47], s3 offen sc1
  v_cvt_pk_bf16_f32 v245, v90, v91
  v_pk_mul_f32 v[76:77], v[76:77], s[72:73] op_sel_hi:[1,0]
  v_pk_mul_f32 v[78:79], v[78:79], s[72:73] op_sel_hi:[1,0]
  v_exp_f32 v76, v76
  v_exp_f32 v77, v77
  v_exp_f32 v78, v78
  v_exp_f32 v79, v79
  v_pk_add_f32 v[76:77], v[76:77], 1.0 op_sel_hi:[1,0]
  v_pk_add_f32 v[78:79], v[78:79], 1.0 op_sel_hi:[1,0]
  v_rcp_f32 v76, v76
  v_rcp_f32 v77, v77
  v_rcp_f32 v78, v78
  s_add_u32 m0, s65, 147456
  s_add_u32 s1, s15, 393216
  s_and_b32 s1, s1, 524287
  s_add_u32 s1, s1, 1310720
  buffer_load_dwordx4 v210, s[52:55], s1 offen lds
  v_rcp_f32 v79, v79
  v_pk_mul_f32 v[92:93], v[76:77], v[92:93]
  v_pk_mul_f32 v[94:95], v[78:79], v[94:95]
  v_cvt_pk_bf16_f32 v246, v92, v93
  v_cvt_pk_bf16_f32 v247, v94, v95
  buffer_store_dwordx4 v[244:247], v200, s[44:47], s71 offen offset:1024 sc1
  s_waitcnt vmcnt(7)
  s_barrier
  s_add_u32 s14, s81, 0
  v_mov_b32 v218, 1
  buffer_atomic_add v218, v209, s[44:47], s14 offen sc1
  v_mfma_f32_32x32x16_bf16 v[128:143], a[112:115], v[0:3], 0
  ds_read_b64_tr_b16 a[0:1], v214 offset:0
  ds_read_b64_tr_b16 a[2:3], v214 offset:1024
  ds_read_b64_tr_b16 a[4:5], v215 offset:0
  ds_read_b64_tr_b16 a[6:7], v215 offset:1024
  ds_read_b64_tr_b16 a[8:9], v214 offset:2048
  buffer_load_dwordx4 v211, s[52:55], s1 offen offset:1024 lds
  v_mfma_f32_32x32x16_bf16 v[144:159], a[112:115], v[4:7], 0
  s_add_u32 s1, s1, 63488
  ds_read_b64_tr_b16 a[10:11], v214 offset:3072
  ds_read_b64_tr_b16 a[12:13], v215 offset:2048
  ds_read_b64_tr_b16 a[14:15], v215 offset:3072
  ds_read_b64_tr_b16 a[16:17], v214 offset:16384
  buffer_load_dwordx4 v210, s[52:55], s1 offen offset:2048 lds
  v_mfma_f32_32x32x16_bf16 v[160:175], a[116:119], v[0:3], 0
  ds_read_b64_tr_b16 a[18:19], v214 offset:17408
  ds_read_b64_tr_b16 a[20:21], v215 offset:16384
  ds_read_b64_tr_b16 a[22:23], v215 offset:17408
  ds_read_b64_tr_b16 a[24:25], v214 offset:18432
  ds_read_b64_tr_b16 a[26:27], v214 offset:19456
  buffer_load_dwordx4 v211, s[52:55], s1 offen offset:3072 lds
  v_mfma_f32_32x32x16_bf16 v[176:191], a[116:119], v[4:7], 0
  s_add_u32 m0, s65, 32768
  s_add_u32 s1, s15, 0
  s_and_b32 s1, s1, 524287
  ds_read_b64_tr_b16 a[28:29], v215 offset:18432
  ds_read_b64_tr_b16 a[30:31], v215 offset:19456
  buffer_load_dwordx4 v210, s[56:59], s1 offen lds
  v_mfma_f32_32x32x16_bf16 v[128:143], a[120:123], v[8:11], v[128:143]
  ds_read_b64_tr_b16 a[32:33], v214 offset:32768
  ds_read_b64_tr_b16 a[34:35], v214 offset:33792
  ds_read_b64_tr_b16 a[36:37], v215 offset:32768
  ds_read_b64_tr_b16 a[38:39], v215 offset:33792
  ds_read_b64_tr_b16 a[40:41], v214 offset:34816
  buffer_load_dwordx4 v211, s[56:59], s1 offen offset:1024 lds
  v_mfma_f32_32x32x16_bf16 v[144:159], a[120:123], v[12:15], v[144:159]
  s_add_u32 s1, s1, 63488
  ds_read_b64_tr_b16 a[42:43], v214 offset:35840
  ds_read_b64_tr_b16 a[44:45], v215 offset:34816
  ds_read_b64_tr_b16 a[46:47], v215 offset:35840
  ds_read_b64_tr_b16 a[48:49], v214 offset:49152
  buffer_load_dwordx4 v210, s[56:59], s1 offen offset:2048 lds
  v_mfma_f32_32x32x16_bf16 v[160:175], a[124:127], v[8:11], v[160:175]
  ds_read_b64_tr_b16 a[50:51], v214 offset:50176
  ds_read_b64_tr_b16 a[52:53], v215 offset:49152
  ds_read_b64_tr_b16 a[54:55], v215 offset:50176
  ds_read_b64_tr_b16 a[56:57], v214 offset:51200
  ds_read_b64_tr_b16 a[58:59], v214 offset:52224
  buffer_load_dwordx4 v211, s[56:59], s1 offen offset:3072 lds
  v_mfma_f32_32x32x16_bf16 v[176:191], a[124:127], v[12:15], v[176:191]
  s_add_u32 m0, s65, 16384
  s_add_u32 s1, s15, 131072
  s_and_b32 s1, s1, 524287
  ds_read_b64_tr_b16 a[60:61], v215 offset:51200
  ds_read_b64_tr_b16 a[62:63], v215 offset:52224
  buffer_load_dwordx4 v210, s[56:59], s1 offen lds
  v_mfma_f32_32x32x16_bf16 v[128:143], a[128:131], v[16:19], v[128:143]
  buffer_load_dwordx4 v211, s[56:59], s1 offen offset:1024 lds
  v_subrev_u32 v218, s65, v212
  v_add_u32 v219, 65536, v218
  v_add_u32 v220, 131072, v218
  v_mfma_f32_32x32x16_bf16 v[144:159], a[128:131], v[20:23], v[144:159]
  s_add_u32 s1, s1, 63488
  s_and_b32 s12, s64, 1
  s_lshl_b32 s12, s12, 12
  buffer_load_dwordx4 v210, s[56:59], s1 offen offset:2048 lds
  v_add_u32 v221, s12, v200
  v_add_u32 v222, 65536, v221
  v_mfma_f32_32x32x16_bf16 v[160:175], a[132:135], v[16:19], v[160:175]
  buffer_load_dwordx4 v211, s[56:59], s1 offen offset:3072 lds
  v_add_u32 v223, 131072, v221
  v_mfma_f32_32x32x16_bf16 v[176:191], a[132:135], v[20:23], v[176:191]
  s_xor_b32 s12, s64, 1
  s_lshl_b32 s12, s12, 12
  s_add_u32 s12, s12, 32768
  v_add_u32 v224, s12, v200
  v_mfma_f32_32x32x16_bf16 v[128:143], a[136:139], v[24:27], v[128:143]
  s_add_u32 m0, s65, 49152
  s_add_u32 s1, s15, 262144
  s_and_b32 s1, s1, 524287
  s_add_u32 s12, s65, 32768
  buffer_load_dwordx4 v210, s[56:59], s1 offen lds
  v_add_u32 v227, s12, v200
  v_mfma_f32_32x32x16_bf16 v[144:159], a[136:139], v[28:31], v[144:159]
  s_xor_b32 s12, s64, 2
  s_lshl_b32 s12, s12, 12
  s_add_u32 s12, s12, 16384
  buffer_load_dwordx4 v211, s[56:59], s1 offen offset:1024 lds
  v_add_u32 v225, s12, v200
  v_mfma_f32_32x32x16_bf16 v[160:175], a[140:143], v[24:27], v[160:175]
  s_add_u32 s1, s1, 63488
  s_add_u32 s12, s65, 16384
  buffer_load_dwordx4 v210, s[56:59], s1 offen offset:2048 lds
  v_add_u32 v228, s12, v200
  v_mfma_f32_32x32x16_bf16 v[176:191], a[140:143], v[28:31], v[176:191]
  s_waitcnt vmcnt(15)
  s_barrier
  s_add_u32 s68, s81, 0
  v_mov_b32 v233, 256
  buffer_atomic_add v233, v209, s[44:47], s68 offen sc1
  buffer_load_dwordx4 v211, s[56:59], s1 offen offset:3072 lds
  v_mfma_f32_32x32x16_bf16 v[128:143], a[144:147], v[32:35], v[128:143]
  s_add_u32 m0, s65, 131072
  s_add_u32 s1, s15, 393216
  s_and_b32 s1, s1, 524287
  s_xor_b32 s12, s64, 3
  s_lshl_b32 s12, s12, 12
  buffer_load_dwordx4 v210, s[56:59], s1 offen lds
  v_mfma_f32_32x32x16_bf16 v[144:159], a[144:147], v[36:39], v[144:159]
  s_add_u32 s12, s12, 49152
  buffer_load_dwordx4 v211, s[56:59], s1 offen offset:1024 lds
  v_add_u32 v226, s12, v200
  v_mfma_f32_32x32x16_bf16 v[160:175], a[148:151], v[32:35], v[160:175]
  s_add_u32 s1, s1, 63488
  s_add_u32 s12, s65, 49152
  buffer_load_dwordx4 v210, s[56:59], s1 offen offset:2048 lds
  v_add_u32 v229, s12, v200
  v_mfma_f32_32x32x16_bf16 v[176:191], a[148:151], v[36:39], v[176:191]
  s_add_u32 s68, s82, 0
  buffer_load_dword v207, v209, s[44:47], s68 offen sc1
  s_lshl_b32 s12, s23, 15
  s_lshl_b32 s13, s19, 7
  s_add_u32 s12, s12, s13
  s_lshr_b32 s13, s64, 1
  v_mfma_f32_32x32x16_bf16 v[128:143], a[152:155], v[40:43], v[128:143]
  s_lshl_b32 s14, s13, 6
  s_add_u32 s12, s12, s14
  buffer_load_dwordx4 v211, s[56:59], s1 offen offset:3072 lds
  v_and_b32 v231, 0xf0, v200
  v_lshlrev_b32 v231, 6, v231
  v_lshrrev_b32 v232, 4, v200
  v_mfma_f32_32x32x16_bf16 v[144:159], a[152:155], v[44:47], v[144:159]
  v_and_b32 v232, 48, v232
  v_add3_u32 v231, v231, v232, s12
  v_add_u32 v232, 16384, v231
  v_mfma_f32_32x32x16_bf16 v[160:175], a[156:159], v[40:43], v[160:175]
  s_mul_i32 s100, s23, 147456
  s_lshl_b32 s13, s13, 12
  s_add_u32 s100, s100, s13
  s_add_u32 s100, s100, 114688
  buffer_load_dwordx4 v[112:115], v231, s[24:27], 0 offen
  buffer_load_dwordx4 v[116:119], v232, s[24:27], 0 offen
  v_mfma_f32_32x32x16_bf16 v[176:191], a[156:159], v[44:47], v[176:191]
  v_mfma_f32_32x32x16_bf16 v[128:143], a[160:163], v[48:51], v[128:143]
  v_mfma_f32_32x32x16_bf16 v[144:159], a[160:163], v[52:55], v[144:159]
  v_mfma_f32_32x32x16_bf16 v[160:175], a[164:167], v[48:51], v[160:175]
  v_mfma_f32_32x32x16_bf16 v[176:191], a[164:167], v[52:55], v[176:191]
  v_mfma_f32_32x32x16_bf16 v[128:143], a[168:171], v[56:59], v[128:143]
  v_mfma_f32_32x32x16_bf16 v[144:159], a[168:171], v[60:63], v[144:159]
  v_mfma_f32_32x32x16_bf16 v[160:175], a[172:175], v[56:59], v[160:175]
  v_mfma_f32_32x32x16_bf16 v[176:191], a[172:175], v[60:63], v[176:191]
  s_waitcnt vmcnt(3)
  v_readfirstlane_b32 s66, v207
  s_mul_i32 s67, s83, 8
  s_nop 0
  s_bfe_u32 s66, s66, 524288
  s_cmp_eq_u32 s66, s67
  s_cbranch_scc0 k_A2_c1_spin
k_A2_c1_ok:
  s_barrier
  s_lshr_b32 s3, s15, 4
  v_add_u32 v201, 32768, v201
  v_add_u32 v202, 32768, v202
  s_and_b32 s3, s3, 32767
  buffer_load_dwordx4 v[80:83], v201, s[44:47], s3 offen sc1
  buffer_load_dwordx4 v[84:87], v202, s[44:47], s3 offen sc1
  s_add_u32 s3, s3, 4096
  s_and_b32 s3, s3, 32767
  buffer_load_dwordx4 v[88:91], v201, s[44:47], s3 offen sc1
  buffer_load_dwordx4 v[92:95], v202, s[44:47], s3 offen sc1
  s_add_u32 s3, s3, 4096
  s_and_b32 s3, s3, 32767
  buffer_load_dwordx4 v[96:99], v201, s[44:47], s3 offen sc1
  buffer_load_dwordx4 v[100:103], v202, s[44:47], s3 offen sc1
  s_add_u32 s3, s3, 4096
  s_and_b32 s3, s3, 32767
  buffer_load_dwordx4 v[104:107], v201, s[44:47], s3 offen sc1
  buffer_load_dwordx4 v[108:111], v202, s[44:47], s3 offen sc1
  s_waitcnt vmcnt(6)
  v_mfma_f32_32x32x16_bf16 v[128:143], a[176:179], v[80:83], v[128:143]
  s_add_u32 s3, s3, 4096
  s_and_b32 s3, s3, 32767
  buffer_load_dwordx4 v[0:3], v201, s[44:47], s3 offen sc1
  v_mfma_f32_32x32x16_bf16 v[144:159], a[176:179], v[84:87], v[144:159]
  buffer_load_dwordx4 v[4:7], v202, s[44:47], s3 offen sc1
  v_mfma_f32_32x32x16_bf16 v[160:175], a[180:183], v[80:83], v[160:175]
  s_add_u32 s3, s3, 4096
  s_and_b32 s3, s3, 32767
  buffer_load_dwordx4 v[8:11], v201, s[44:47], s3 offen sc1
  v_mfma_f32_32x32x16_bf16 v[176:191], a[180:183], v[84:87], v[176:191]
  s_waitcnt vmcnt(7)
  s_add_u32 s68, s82, 0
  buffer_load_dword v207, v209, s[44:47], s68 offen sc1
  buffer_load_dwordx4 v[12:15], v202, s[44:47], s3 offen sc1
  v_mfma_f32_32x32x16_bf16 v[128:143], a[184:187], v[88:91], v[128:143]
  s_add_u32 s3, s3, 4096
  s_and_b32 s3, s3, 32767
  buffer_load_dwordx4 v[16:19], v201, s[44:47], s3 offen sc1
  v_mfma_f32_32x32x16_bf16 v[144:159], a[184:187], v[92:95], v[144:159]
  v_mfma_f32_32x32x16_bf16 v[160:175], a[188:191], v[88:91], v[160:175]
  buffer_load_dwordx4 v[20:23], v202, s[44:47], s3 offen sc1
  v_mfma_f32_32x32x16_bf16 v[176:191], a[188:191], v[92:95], v[176:191]
  s_barrier
  s_waitcnt vmcnt(9)
  s_add_u32 s3, s3, 4096
  s_and_b32 s3, s3, 32767
  ds_read_b64_tr_b16 a[64:65], v216 offset:16384
  ds_read_b64_tr_b16 a[66:67], v216 offset:17408
  buffer_load_dwordx4 v[24:27], v201, s[44:47], s3 offen sc1
  v_mfma_f32_32x32x16_bf16 v[128:143], a[192:195], v[96:99], v[128:143]
  ds_read_b64_tr_b16 a[68:69], v217 offset:16384
  ds_read_b64_tr_b16 a[70:71], v217 offset:17408
  ds_read_b64_tr_b16 a[72:73], v216 offset:18432
  ds_read_b64_tr_b16 a[74:75], v216 offset:19456
  ds_read_b64_tr_b16 a[76:77], v217 offset:18432
  buffer_load_dwordx4 v[28:31], v202, s[44:47], s3 offen sc1
  v_mfma_f32_32x32x16_bf16 v[144:159], a[192:195], v[100:103], v[144:159]
  ds_read_b64_tr_b16 a[78:79], v217 offset:19456
  ds_read_b64_tr_b16 a[80:81], v218 offset:32768
  ds_read_b64_tr_b16 a[82:83], v218 offset:33792
  ds_read_b64_tr_b16 a[84:85], v218 offset:36864
  ds_read_b64_tr_b16 a[86:87], v218 offset:37888
  ds_read_b64_tr_b16 a[88:89], v218 offset:40960
  ds_read_b64_tr_b16 a[90:91], v218 offset:41984
  v_mfma_f32_32x32x16_bf16 v[160:175], a[196:199], v[96:99], v[160:175]
  ds_read_b64_tr_b16 a[92:93], v218 offset:45056
  ds_read_b64_tr_b16 a[94:95], v218 offset:46080
  ds_read_b64_tr_b16 a[96:97], v218 offset:34816
  ds_read_b64_tr_b16 a[98:99], v218 offset:35840
  ds_read_b64_tr_b16 a[100:101], v218 offset:38912
  ds_read_b64_tr_b16 a[102:103], v218 offset:39936
  ds_read_b64_tr_b16 a[104:105], v218 offset:43008
  v_mfma_f32_32x32x16_bf16 v[176:191], a[196:199], v[100:103], v[176:191]
  s_waitcnt vmcnt(9)
  ds_read_b64_tr_b16 a[106:107], v218 offset:44032
  ds_read_b64_tr_b16 a[108:109], v218 offset:47104
  ds_read_b64_tr_b16 a[110:111], v218 offset:48128
  ds_read_b64_tr_b16 a[112:113], v218 offset:16384
  ds_read_b64_tr_b16 a[114:115], v218 offset:17408
  ds_read_b64_tr_b16 a[116:117], v218 offset:20480
  ds_read_b64_tr_b16 a[118:119], v218 offset:21504
  v_mfma_f32_32x32x16_bf16 v[128:143], a[200:203], v[104:107], v[128:143]
  ds_read_b64_tr_b16 a[120:121], v218 offset:24576
  ds_read_b64_tr_b16 a[122:123], v218 offset:25600
  ds_read_b64_tr_b16 a[124:125], v218 offset:28672
  ds_read_b64_tr_b16 a[126:127], v218 offset:29696
  ds_read_b64_tr_b16 a[128:129], v218 offset:18432
  ds_read_b64_tr_b16 a[130:131], v218 offset:19456
  ds_read_b64_tr_b16 a[132:133], v218 offset:22528
  v_mfma_f32_32x32x16_bf16 v[144:159], a[200:203], v[108:111], v[144:159]
  ds_read_b64_tr_b16 a[134:135], v218 offset:23552
  ds_read_b64_tr_b16 a[136:137], v218 offset:26624
  ds_read_b64_tr_b16 a[138:139], v218 offset:27648
  ds_read_b64_tr_b16 a[140:141], v218 offset:30720
  ds_read_b64_tr_b16 a[142:143], v218 offset:31744
  ds_read_b64_tr_b16 a[144:145], v218 offset:49152
  ds_read_b64_tr_b16 a[146:147], v218 offset:50176
  v_mfma_f32_32x32x16_bf16 v[160:175], a[204:207], v[104:107], v[160:175]
  ds_read_b64_tr_b16 a[148:149], v218 offset:53248
  ds_read_b64_tr_b16 a[150:151], v218 offset:54272
  ds_read_b64_tr_b16 a[152:153], v218 offset:57344
  ds_read_b64_tr_b16 a[154:155], v218 offset:58368
  ds_read_b64_tr_b16 a[156:157], v218 offset:61440
  ds_read_b64_tr_b16 a[158:159], v218 offset:62464
  ds_read_b64_tr_b16 a[160:161], v218 offset:51200
  v_mfma_f32_32x32x16_bf16 v[176:191], a[204:207], v[108:111], v[176:191]
  s_waitcnt vmcnt(5)
  v_readfirstlane_b32 s66, v207
  s_mul_i32 s67, s83, 8
  s_nop 0
  s_bfe_u32 s66, s66, 524296
  s_cmp_eq_u32 s66, s67
  s_cbranch_scc0 k_A2_cH_spin
k_A2_cH_ok:
  s_barrier
  s_add_u32 s68, s82, 65536
  buffer_load_dword v208, v209, s[44:47], s68 offen sc1
  s_lshr_b32 s3, s15, 4
  s_and_b32 s3, s3, 16383
  v_add_u32 v201, 32768, v201
  v_add_u32 v202, 32768, v202
  buffer_load_dwordx4 v[32:35], v201, s[44:47], s3 offen sc1
  v_mfma_f32_32x32x16_bf16 v[128:143], a[208:211], v[0:3], v[128:143]
  ds_read_b64_tr_b16 a[162:163], v218 offset:52224
  ds_read_b64_tr_b16 a[164:165], v218 offset:55296
  ds_read_b64_tr_b16 a[166:167], v218 offset:56320
  ds_read_b64_tr_b16 a[168:169], v218 offset:59392
  ds_read_b64_tr_b16 a[170:171], v218 offset:60416
  buffer_load_dwordx4 v[36:39], v202, s[44:47], s3 offen sc1
  v_mfma_f32_32x32x16_bf16 v[144:159], a[208:211], v[4:7], v[144:159]
  s_add_u32 s3, s3, 4096
  s_and_b32 s3, s3, 16383
  ds_read_b64_tr_b16 a[172:173], v218 offset:63488
  ds_read_b64_tr_b16 a[174:175], v218 offset:64512
  ds_read_b64_tr_b16 a[176:177], v220 offset:0
  buffer_load_dwordx4 v[40:43], v201, s[44:47], s3 offen sc1
  v_mfma_f32_32x32x16_bf16 v[160:175], a[212:215], v[0:3], v[160:175]
  ds_read_b64_tr_b16 a[178:179], v220 offset:1024
  ds_read_b64_tr_b16 a[180:181], v220 offset:4096
  ds_read_b64_tr_b16 a[182:183], v220 offset:5120
  ds_read_b64_tr_b16 a[184:185], v220 offset:8192
  ds_read_b64_tr_b16 a[186:187], v220 offset:9216
  buffer_load_dwordx4 v[44:47], v202, s[44:47], s3 offen sc1
  v_mfma_f32_32x32x16_bf16 v[176:191], a[212:215], v[4:7], v[176:191]
  s_waitcnt vmcnt(9)
  s_add_u32 s3, s3, 4096
  s_and_b32 s3, s3, 16383
  ds_read_b64_tr_b16 a[188:189], v220 offset:12288
  ds_read_b64_tr_b16 a[190:191], v220 offset:13312
  ds_read_b64_tr_b16 a[192:193], v220 offset:2048
  buffer_load_dwordx4 v[48:51], v201, s[44:47], s3 offen sc1
  v_mfma_f32_32x32x16_bf16 v[128:143], a[216:219], v[8:11], v[128:143]
  ds_read_b64_tr_b16 a[194:195], v220 offset:3072
  ds_read_b64_tr_b16 a[196:197], v220 offset:6144
  ds_read_b64_tr_b16 a[198:199], v220 offset:7168
  ds_read_b64_tr_b16 a[200:201], v220 offset:10240
  ds_read_b64_tr_b16 a[202:203], v220 offset:11264
  buffer_load_dwordx4 v[52:55], v202, s[44:47], s3 offen sc1
  v_mfma_f32_32x32x16_bf16 v[144:159], a[216:219], v[12:15], v[144:159]
  s_add_u32 s3, s3, 4096
  s_and_b32 s3, s3, 16383
  ds_read_b64_tr_b16 a[204:205], v220 offset:14336
  ds_read_b64_tr_b16 a[206:207], v220 offset:15360
  buffer_load_dwordx4 v[56:59], v201, s[44:47], s3 offen sc1
  v_permlane16_swap_b32 v112, v116
  v_mfma_f32_32x32x16_bf16 v[160:175], a[220:223], v[8:11], v[160:175]
  buffer_load_dwordx4 v[60:63], v202, s[44:47], s3 offen sc1
  v_permlane16_swap_b32 v113, v117
  v_permlane16_swap_b32 v114, v118
  v_permlane16_swap_b32 v115, v119
  v_lshlrev_b32 v238, 16, v112
  v_and_b32 v239, s74, v112
  v_mfma_f32_32x32x16_bf16 v[176:191], a[220:223], v[12:15], v[176:191]
  s_waitcnt vmcnt(11)
  v_lshlrev_b32 v240, 16, v113
  v_and_b32 v241, s74, v113
  v_lshlrev_b32 v242, 16, v114
  v_and_b32 v243, s74, v114
  v_lshlrev_b32 v244, 16, v115
  v_and_b32 v245, s74, v115
  v_lshlrev_b32 v246, 16, v116
  v_mfma_f32_32x32x16_bf16 v[128:143], a[224:227], v[16:19], v[128:143]
  v_and_b32 v247, s74, v116
  v_lshlrev_b32 v248, 16, v117
  v_and_b32 v249, s74, v117
  v_lshlrev_b32 v250, 16, v118
  v_and_b32 v251, s74, v118
  v_lshlrev_b32 v252, 16, v119
  v_and_b32 v253, s74, v119
  v_mfma_f32_32x32x16_bf16 v[144:159], a[224:227], v[20:23], v[144:159]
  v_mfma_f32_32x32x16_bf16 v[160:175], a[228:231], v[16:19], v[160:175]
  v_mfma_f32_32x32x16_bf16 v[176:191], a[228:231], v[20:23], v[176:191]
  s_waitcnt vmcnt(8)
  v_readfirstlane_b32 s66, v208
  s_mul_i32 s67, s83, 8
  s_nop 0
  s_bfe_u32 s66, s66, 524304
  s_cmp_eq_u32 s66, s67
  s_cbranch_scc0 k_A2_cO_spin
k_A2_cO_ok:
  s_barrier
  s_lshr_b32 s3, s15, 4
  s_and_b32 s3, s3, 32767
  v_add_u32 v201, 16384, v201
  v_add_u32 v202, 16384, v202
  buffer_load_dwordx4 v[80:83], v201, s[44:47], s3 offen sc1
  v_mfma_f32_32x32x16_bf16 v[128:143], a[232:235], v[24:27], v[128:143]
  buffer_load_dwordx4 v[84:87], v202, s[44:47], s3 offen sc1
  v_mfma_f32_32x32x16_bf16 v[144:159], a[232:235], v[28:31], v[144:159]
  s_add_u32 s3, s3, 4096
  s_and_b32 s3, s3, 32767
  buffer_load_dwordx4 v[88:91], v201, s[44:47], s3 offen sc1
  v_mfma_f32_32x32x16_bf16 v[160:175], a[236:239], v[24:27], v[160:175]
  buffer_load_dwordx4 v[92:95], v202, s[44:47], s3 offen sc1
  v_mfma_f32_32x32x16_bf16 v[176:191], a[236:239], v[28:31], v[176:191]
  s_waitcnt vmcnt(10)
  s_add_u32 s3, s3, 4096
  s_and_b32 s3, s3, 32767
  buffer_load_dwordx4 v[96:99], v201, s[44:47], s3 offen sc1
  v_mfma_f32_32x32x16_bf16 v[128:143], a[240:243], v[32:35], v[128:143]
  buffer_load_dwordx4 v[100:103], v202, s[44:47], s3 offen sc1
  v_mfma_f32_32x32x16_bf16 v[144:159], a[240:243], v[36:39], v[144:159]
  v_mfma_f32_32x32x16_bf16 v[160:175], a[244:247], v[32:35], v[160:175]
  s_add_u32 s3, s3, 4096
  s_and_b32 s3, s3, 32767
  buffer_load_dwordx4 v[104:107], v201, s[44:47], s3 offen sc1
  v_mfma_f32_32x32x16_bf16 v[176:191], a[244:247], v[36:39], v[176:191]
  s_waitcnt vmcnt(11)
  buffer_load_dwordx4 v[108:111], v202, s[44:47], s3 offen sc1
  v_mfma_f32_32x32x16_bf16 v[128:143], a[248:251], v[40:43], v[128:143]
  s_add_u32 s3, s3, 4096
  s_and_b32 s3, s3, 32767
  buffer_load_dwordx4 v[0:3], v201, s[44:47], s3 offen sc1
  v_mfma_f32_32x32x16_bf16 v[144:159], a[248:251], v[44:47], v[144:159]
  buffer_load_dwordx4 v[4:7], v202, s[44:47], s3 offen sc1
  v_mfma_f32_32x32x16_bf16 v[160:175], a[252:255], v[40:43], v[160:175]
  s_add_u32 s3, s3, 4096
  s_and_b32 s3, s3, 32767
  buffer_load_dwordx4 v[8:11], v201, s[44:47], s3 offen sc1
  v_mfma_f32_32x32x16_bf16 v[176:191], a[252:255], v[44:47], v[176:191]
  s_waitcnt vmcnt(13) lgkmcnt(15)
  v_mfma_f32_32x32x16_bf16 v[128:143], a[0:3], v[48:51], v[128:143]
  buffer_load_dwordx4 v[12:15], v202, s[44:47], s3 offen sc1
  v_mfma_f32_32x32x16_bf16 v[144:159], a[0:3], v[52:55], v[144:159]
  s_add_u32 s3, s3, 4096
  s_and_b32 s3, s3, 32767
  buffer_load_dwordx4 v[16:19], v201, s[44:47], s3 offen sc1
  v_mfma_f32_32x32x16_bf16 v[160:175], a[4:7], v[48:51], v[160:175]
  buffer_load_dwordx4 v[20:23], v202, s[44:47], s3 offen sc1
  v_mfma_f32_32x32x16_bf16 v[176:191], a[4:7], v[52:55], v[176:191]
  s_waitcnt vmcnt(14)
  s_add_u32 s3, s3, 4096
  s_and_b32 s3, s3, 32767
  buffer_load_dwordx4 v[24:27], v201, s[44:47], s3 offen sc1
  v_mfma_f32_32x32x16_bf16 v[128:143], a[8:11], v[56:59], v[128:143]
  v_mfma_f32_32x32x16_bf16 v[144:159], a[8:11], v[60:63], v[144:159]
  buffer_load_dwordx4 v[28:31], v202, s[44:47], s3 offen sc1
  v_mfma_f32_32x32x16_bf16 v[160:175], a[12:15], v[56:59], v[160:175]
  s_add_u32 m0, s65, 65536
  s_lshr_b32 s0, s15, 4
  s_add_u32 s0, s0, 0
  s_and_b32 s0, s0, 32767
  s_add_u32 s0, s0, s100
  buffer_load_dwordx4 v200, s[44:47], s0 offen sc1 lds
  v_mfma_f32_32x32x16_bf16 v[176:191], a[12:15], v[60:63], v[176:191]
  s_waitcnt vmcnt(15)
  buffer_load_dwordx4 v200, s[44:47], s0 offen offset:1024 sc1 lds
  v_mfma_f32_32x32x16_bf16 v[128:143], a[16:19], v[80:83], v[128:143]
  buffer_load_dwordx4 v200, s[44:47], s0 offen offset:2048 sc1 lds
  v_mfma_f32_32x32x16_bf16 v[144:159], a[16:19], v[84:87], v[144:159]
  buffer_load_dwordx4 v200, s[44:47], s0 offen offset:3072 sc1 lds
  v_mfma_f32_32x32x16_bf16 v[160:175], a[20:23], v[80:83], v[160:175]
  s_add_u32 m0, s65, 81920
  s_lshr_b32 s0, s15, 4
  s_add_u32 s0, s0, 8192
  s_and_b32 s0, s0, 32767
  s_add_u32 s0, s0, s100
  buffer_load_dwordx4 v200, s[44:47], s0 offen sc1 lds
  v_mfma_f32_32x32x16_bf16 v[176:191], a[20:23], v[84:87], v[176:191]
  s_waitcnt vmcnt(17)
  v_mfma_f32_32x32x16_bf16 v[128:143], a[24:27], v[88:91], v[128:143]
  buffer_load_dwordx4 v200, s[44:47], s0 offen offset:1024 sc1 lds
  v_mfma_f32_32x32x16_bf16 v[144:159], a[24:27], v[92:95], v[144:159]
  buffer_load_dwordx4 v200, s[44:47], s0 offen offset:2048 sc1 lds
  v_mfma_f32_32x32x16_bf16 v[160:175], a[28:31], v[88:91], v[160:175]
  buffer_load_dwordx4 v200, s[44:47], s0 offen offset:3072 sc1 lds
  v_mfma_f32_32x32x16_bf16 v[176:191], a[28:31], v[92:95], v[176:191]
  s_waitcnt vmcnt(18)
  s_add_u32 m0, s65, 98304
  s_lshr_b32 s0, s15, 4
  s_add_u32 s0, s0, 16384
  s_and_b32 s0, s0, 32767
  s_add_u32 s0, s0, s100
  buffer_load_dwordx4 v200, s[44:47], s0 offen sc1 lds
  v_mfma_f32_32x32x16_bf16 v[128:143], a[32:35], v[96:99], v[128:143]
  buffer_load_dwordx4 v200, s[44:47], s0 offen offset:1024 sc1 lds
  v_mfma_f32_32x32x16_bf16 v[144:159], a[32:35], v[100:103], v[144:159]
  buffer_load_dwordx4 v200, s[44:47], s0 offen offset:2048 sc1 lds
  v_mfma_f32_32x32x16_bf16 v[160:175], a[36:39], v[96:99], v[160:175]
  v_mfma_f32_32x32x16_bf16 v[176:191], a[36:39], v[100:103], v[176:191]
  s_waitcnt vmcnt(19)
  buffer_load_dwordx4 v200, s[44:47], s0 offen offset:3072 sc1 lds
  v_mfma_f32_32x32x16_bf16 v[128:143], a[40:43], v[104:107], v[128:143]
  s_add_u32 m0, s65, 114688
  s_lshr_b32 s0, s15, 4
  s_add_u32 s0, s0, 24576
  s_and_b32 s0, s0, 32767
  s_add_u32 s0, s0, s100
  buffer_load_dwordx4 v200, s[44:47], s0 offen sc1 lds
  v_mfma_f32_32x32x16_bf16 v[144:159], a[40:43], v[108:111], v[144:159]
  buffer_load_dwordx4 v200, s[44:47], s0 offen offset:1024 sc1 lds
  v_mfma_f32_32x32x16_bf16 v[160:175], a[44:47], v[104:107], v[160:175]
  buffer_load_dwordx4 v200, s[44:47], s0 offen offset:2048 sc1 lds
  v_mfma_f32_32x32x16_bf16 v[176:191], a[44:47], v[108:111], v[176:191]
  s_waitcnt vmcnt(21)
  buffer_load_dwordx4 v200, s[44:47], s0 offen offset:3072 sc1 lds
  v_mfma_f32_32x32x16_bf16 v[128:143], a[48:51], v[0:3], v[128:143]
  v_mfma_f32_32x32x16_bf16 v[144:159], a[48:51], v[4:7], v[144:159]
  v_mfma_f32_32x32x16_bf16 v[160:175], a[52:55], v[0:3], v[160:175]
  v_mfma_f32_32x32x16_bf16 v[176:191], a[52:55], v[4:7], v[176:191]
  s_waitcnt lgkmcnt(0)
  s_barrier
  s_waitcnt vmcnt(20)
  v_mfma_f32_32x32x16_bf16 v[176:191], a[60:63], v[12:15], v[176:191]
  s_waitcnt vmcnt(18)
  v_mfma_f32_32x32x16_bf16 v[176:191], a[68:71], v[20:23], v[176:191]
  s_waitcnt vmcnt(16)
  v_mfma_f32_32x32x16_bf16 v[176:191], a[76:79], v[28:31], v[176:191]
  v_mfma_f32_32x32x16_bf16 v[160:175], a[60:63], v[8:11], v[160:175]
  v_mfma_f32_32x32x16_bf16 v[160:175], a[68:71], v[16:19], v[160:175]
  v_mfma_f32_32x32x16_bf16 v[160:175], a[76:79], v[24:27], v[160:175]
  s_nop 8
  ds_write_b128 v226, v[176:179] offset:0
  v_mfma_f32_32x32x16_bf16 v[144:159], a[56:59], v[12:15], v[144:159]
  v_mfma_f32_32x32x16_bf16 v[144:159], a[64:67], v[20:23], v[144:159]
  ds_write_b128 v226, v[180:183] offset:1024
  v_mfma_f32_32x32x16_bf16 v[144:159], a[72:75], v[28:31], v[144:159]
  v_mfma_f32_32x32x16_bf16 v[128:143], a[56:59], v[8:11], v[128:143]
  ds_write_b128 v226, v[184:187] offset:2048
  v_mfma_f32_32x32x16_bf16 v[128:143], a[64:67], v[16:19], v[128:143]
  v_mfma_f32_32x32x16_bf16 v[128:143], a[72:75], v[24:27], v[128:143]
  s_waitcnt vmcnt(8)
  ds_write_b128 v226, v[188:191] offset:3072
  s_barrier
  ds_read_b128 v[0:3], v222 offset:0
  ds_read_b128 v[4:7], v222 offset:1024
  ds_read_b128 v[8:11], v222 offset:2048
  ds_read_b128 v[12:15], v222 offset:3072
  s_waitcnt lgkmcnt(3)
  v_mfma_f32_32x32x16_bf16 v[64:79], a[80:83], v[0:3], 0
  s_waitcnt lgkmcnt(2)
  ds_read_b128 v[16:19], v222 offset:8192
  ds_write_b128 v225, v[160:163] offset:0
  v_mfma_f32_32x32x16_bf16 v[64:79], a[84:87], v[4:7], v[64:79]
  s_waitcnt lgkmcnt(2)
  ds_read_b128 v[20:23], v222 offset:9216
  ds_write_b128 v225, v[164:167] offset:1024
  v_mfma_f32_32x32x16_bf16 v[64:79], a[88:91], v[8:11], v[64:79]
  ds_read_b128 v[24:27], v222 offset:10240
  ds_write_b128 v225, v[168:171] offset:2048
  v_mfma_f32_32x32x16_bf16 v[64:79], a[92:95], v[12:15], v[64:79]
  s_waitcnt lgkmcnt(3)
  ds_read_b128 v[28:31], v222 offset:11264
  ds_write_b128 v225, v[172:175] offset:3072
  v_mfma_f32_32x32x16_bf16 v[64:79], a[96:99], v[16:19], v[64:79]
  ds_read_b128 v[0:3], v222 offset:16384
  ds_write_b128 v224, v[144:147] offset:0
  v_mfma_f32_32x32x16_bf16 v[64:79], a[100:103], v[20:23], v[64:79]
  s_waitcnt lgkmcnt(3)
  ds_read_b128 v[4:7], v222 offset:17408
  ds_write_b128 v224, v[148:151] offset:1024
  v_mfma_f32_32x32x16_bf16 v[64:79], a[104:107], v[24:27], v[64:79]
  ds_read_b128 v[8:11], v222 offset:18432
  ds_write_b128 v224, v[152:155] offset:2048
  v_mfma_f32_32x32x16_bf16 v[64:79], a[108:111], v[28:31], v[64:79]
  s_waitcnt lgkmcnt(3)
  ds_read_b128 v[12:15], v222 offset:19456
  ds_write_b128 v224, v[156:159] offset:3072
  v_mfma_f32_32x32x16_bf16 v[64:79], a[112:115], v[0:3], v[64:79]
  s_waitcnt vmcnt(0) lgkmcnt(0)
  s_barrier
  ds_read_b128 v[16:19], v222 offset:24576
  ds_read_b128 v[144:147], v227 offset:0
  ds_read_b128 v[148:151], v227 offset:1024
  ds_read_b128 v[152:155], v227 offset:2048
  ds_read_b128 v[156:159], v227 offset:3072
  ds_read_b128 v[160:163], v228 offset:0
  ds_read_b128 v[164:167], v228 offset:1024
  ds_read_b128 v[168:171], v228 offset:2048
  ds_read_b128 v[172:175], v228 offset:3072
  v_mfma_f32_32x32x16_bf16 v[64:79], a[116:119], v[4:7], v[64:79]
  ds_read_b128 v[20:23], v222 offset:25600
  ds_read_b128 v[176:179], v229 offset:0
  ds_read_b128 v[180:183], v229 offset:1024
  ds_read_b128 v[184:187], v229 offset:2048
  ds_read_b128 v[188:191], v229 offset:3072
  v_mfma_f32_32x32x16_bf16 v[64:79], a[120:123], v[8:11], v[64:79]
  s_waitcnt lgkmcnt(11)
  ds_read_b128 v[24:27], v222 offset:26624
  v_add_f32 v128, v128, v144
  v_add_f32 v129, v129, v145
  v_add_f32 v130, v130, v146
  v_add_f32 v131, v131, v147
  v_add_f32 v132, v132, v148
  v_add_f32 v133, v133, v149
  v_add_f32 v134, v134, v150
  v_add_f32 v135, v135, v151
  v_mfma_f32_32x32x16_bf16 v[64:79], a[124:127], v[12:15], v[64:79]
  s_waitcnt lgkmcnt(5)
  ds_read_b128 v[28:31], v222 offset:27648
  v_add_f32 v136, v136, v152
  v_add_f32 v137, v137, v153
  v_add_f32 v138, v138, v154
  v_add_f32 v139, v139, v155
  v_add_f32 v140, v140, v156
  v_add_f32 v141, v141, v157
  v_add_f32 v142, v142, v158
  v_add_f32 v143, v143, v159
  v_mfma_f32_32x32x16_bf16 v[64:79], a[128:131], v[16:19], v[64:79]
  s_waitcnt lgkmcnt(4)
  ds_read_b128 v[0:3], v222 offset:32768
  v_add_f32 v160, v160, v176
  v_add_f32 v161, v161, v177
  v_add_f32 v162, v162, v178
  v_add_f32 v163, v163, v179
  v_add_f32 v164, v164, v180
  v_add_f32 v165, v165, v181
  v_add_f32 v166, v166, v182
  v_add_f32 v167, v167, v183
  v_mfma_f32_32x32x16_bf16 v[64:79], a[132:135], v[20:23], v[64:79]
  s_waitcnt lgkmcnt(1)
  ds_read_b128 v[4:7], v222 offset:33792
  v_add_f32 v168, v168, v184
  v_add_f32 v169, v169, v185
  v_add_f32 v170, v170, v186
  v_add_f32 v171, v171, v187
  v_add_f32 v172, v172, v188
  v_add_f32 v173, v173, v189
  v_add_f32 v174, v174, v190
  v_add_f32 v175, v175, v191
  v_mfma_f32_32x32x16_bf16 v[64:79], a[136:139], v[24:27], v[64:79]
  ds_read_b128 v[8:11], v222 offset:34816
  v_add_f32 v128, v128, v160
  v_add_f32 v129, v129, v161
  v_add_f32 v130, v130, v162
  v_add_f32 v131, v131, v163
  v_mul_f32 v144, s72, v128
  v_mul_f32 v145, s72, v129
  v_mul_f32 v146, s72, v130
  v_mul_f32 v147, s72, v131
  v_mfma_f32_32x32x16_bf16 v[64:79], a[140:143], v[28:31], v[64:79]
  s_waitcnt lgkmcnt(1)
  ds_read_b128 v[12:15], v222 offset:35840
  v_exp_f32 v144, v144
  v_exp_f32 v145, v145
  v_exp_f32 v146, v146
  v_exp_f32 v147, v147
  v_mfma_f32_32x32x16_bf16 v[64:79], a[144:147], v[0:3], v[64:79]
  ds_read_b128 v[16:19], v222 offset:40960
  v_add_f32 v144, 1.0, v144
  v_add_f32 v145, 1.0, v145
  v_add_f32 v146, 1.0, v146
  v_add_f32 v147, 1.0, v147
  v_rcp_f32 v144, v144
  v_mfma_f32_32x32x16_bf16 v[64:79], a[148:151], v[4:7], v[64:79]
  s_waitcnt lgkmcnt(1)
  ds_read_b128 v[20:23], v222 offset:41984
  v_rcp_f32 v145, v145
  v_rcp_f32 v146, v146
  v_rcp_f32 v147, v147
  v_mul_f32 v128, v128, v144
  v_mul_f32 v129, v129, v145
  v_mfma_f32_32x32x16_bf16 v[64:79], a[152:155], v[8:11], v[64:79]
  ds_read_b128 v[24:27], v222 offset:43008
  v_mul_f32 v130, v130, v146
  v_mul_f32 v131, v131, v147
  v_add_f32 v132, v132, v164
  v_add_f32 v133, v133, v165
  v_add_f32 v134, v134, v166
  v_add_f32 v135, v135, v167
  v_mul_f32 v148, s72, v132
  v_mfma_f32_32x32x16_bf16 v[64:79], a[156:159], v[12:15], v[64:79]
  s_waitcnt lgkmcnt(1)
  ds_read_b128 v[28:31], v222 offset:44032
  v_mul_f32 v149, s72, v133
  v_mul_f32 v150, s72, v134
  v_mul_f32 v151, s72, v135
  v_exp_f32 v148, v148
  v_exp_f32 v149, v149
  v_mfma_f32_32x32x16_bf16 v[64:79], a[160:163], v[16:19], v[64:79]
  ds_read_b128 v[0:3], v222 offset:49152
  v_exp_f32 v150, v150
  v_exp_f32 v151, v151
  v_add_f32 v148, 1.0, v148
  v_add_f32 v149, 1.0, v149
  v_add_f32 v150, 1.0, v150
  v_mfma_f32_32x32x16_bf16 v[64:79], a[164:167], v[20:23], v[64:79]
  s_waitcnt lgkmcnt(1)
  ds_read_b128 v[4:7], v222 offset:50176
  v_add_f32 v151, 1.0, v151
  v_rcp_f32 v148, v148
  v_rcp_f32 v149, v149
  v_rcp_f32 v150, v150
  v_mfma_f32_32x32x16_bf16 v[64:79], a[168:171], v[24:27], v[64:79]
  ds_read_b128 v[8:11], v222 offset:51200
  v_rcp_f32 v151, v151
  v_mul_f32 v132, v132, v148
  v_mul_f32 v133, v133, v149
  v_mul_f32 v134, v134, v150
  v_mul_f32 v135, v135, v151
  v_add_f32 v136, v136, v168
  v_mfma_f32_32x32x16_bf16 v[64:79], a[172:175], v[28:31], v[64:79]
  s_waitcnt lgkmcnt(1)
  ds_read_b128 v[12:15], v222 offset:52224
  v_add_f32 v137, v137, v169
  v_add_f32 v138, v138, v170
  v_add_f32 v139, v139, v171
  v_mul_f32 v152, s72, v136
  v_mul_f32 v153, s72, v137
  v_mul_f32 v154, s72, v138
  v_mul_f32 v155, s72, v139
  v_mfma_f32_32x32x16_bf16 v[64:79], a[176:179], v[0:3], v[64:79]
  ds_read_b128 v[16:19], v222 offset:57344
  v_exp_f32 v152, v152
  v_exp_f32 v153, v153
  v_exp_f32 v154, v154
  v_mfma_f32_32x32x16_bf16 v[64:79], a[180:183], v[4:7], v[64:79]
  s_waitcnt lgkmcnt(1)
  ds_read_b128 v[20:23], v222 offset:58368
  v_exp_f32 v155, v155
  v_add_f32 v152, 1.0, v152
  v_add_f32 v153, 1.0, v153
  v_add_f32 v154, 1.0, v154
  v_add_f32 v155, 1.0, v155
  v_rcp_f32 v152, v152
  v_mfma_f32_32x32x16_bf16 v[64:79], a[184:187], v[8:11], v[64:79]
  ds_read_b128 v[24:27], v222 offset:59392
  v_rcp_f32 v153, v153
  v_rcp_f32 v154, v154
  v_rcp_f32 v155, v155
  v_mul_f32 v136, v136, v152
  v_mfma_f32_32x32x16_bf16 v[64:79], a[188:191], v[12:15], v[64:79]
  s_waitcnt lgkmcnt(1)
  ds_read_b128 v[28:31], v222 offset:60416
  v_mul_f32 v137, v137, v153
  v_mul_f32 v138, v138, v154
  v_mul_f32 v139, v139, v155
  v_add_f32 v140, v140, v172
  v_add_f32 v141, v141, v173
  v_add_f32 v142, v142, v174
  v_add_f32 v143, v143, v175
  v_mfma_f32_32x32x16_bf16 v[64:79], a[192:195], v[16:19], v[64:79]
  v_mul_f32 v156, s72, v140
  v_mul_f32 v157, s72, v141
  v_mul_f32 v158, s72, v142
  v_mul_f32 v159, s72, v143
  v_exp_f32 v156, v156
  v_mfma_f32_32x32x16_bf16 v[64:79], a[196:199], v[20:23], v[64:79]
  s_waitcnt lgkmcnt(0)
  v_exp_f32 v157, v157
  v_exp_f32 v158, v158
  v_exp_f32 v159, v159
  v_add_f32 v156, 1.0, v156
  v_add_f32 v157, 1.0, v157
  v_mfma_f32_32x32x16_bf16 v[64:79], a[200:203], v[24:27], v[64:79]
  v_add_f32 v158, 1.0, v158
  v_add_f32 v159, 1.0, v159
  v_rcp_f32 v156, v156
  v_rcp_f32 v157, v157
  v_mfma_f32_32x32x16_bf16 v[64:79], a[204:207], v[28:31], v[64:79]
  v_rcp_f32 v158, v158
  v_rcp_f32 v159, v159
  v_mul_f32 v140, v140, v156
  v_mul_f32 v141, v141, v157
  v_mul_f32 v142, v142, v158
  v_mul_f32 v143, v143, v159
  s_nop 5
  v_pk_fma_f32 v[238:239], v[64:65], v[128:129], v[238:239]
  v_pk_fma_f32 v[240:241], v[66:67], v[130:131], v[240:241]
  v_pk_fma_f32 v[242:243], v[68:69], v[132:133], v[242:243]
  v_pk_fma_f32 v[244:245], v[70:71], v[134:135], v[244:245]
  v_cvt_pk_bf16_f32 v112, v238, v239
  v_cvt_pk_bf16_f32 v113, v240, v241
  v_cvt_pk_bf16_f32 v114, v242, v243
  v_cvt_pk_bf16_f32 v115, v244, v245
  v_pk_fma_f32 v[246:247], v[72:73], v[136:137], v[246:247]
  v_pk_fma_f32 v[248:249], v[74:75], v[138:139], v[248:249]
  v_pk_fma_f32 v[250:251], v[76:77], v[140:141], v[250:251]
  v_pk_fma_f32 v[252:253], v[78:79], v[142:143], v[252:253]
  v_cvt_pk_bf16_f32 v116, v246, v247
  v_cvt_pk_bf16_f32 v117, v248, v249
  v_cvt_pk_bf16_f32 v118, v250, v251
  v_cvt_pk_bf16_f32 v119, v252, v253
  v_permlane16_swap_b32 v112, v116
  v_permlane16_swap_b32 v113, v117
  v_permlane16_swap_b32 v114, v118
  v_permlane16_swap_b32 v115, v119
  buffer_store_dwordx4 v[112:115], v231, s[60:63], 0 offen sc0 sc1
  buffer_store_dwordx4 v[116:119], v232, s[60:63], 0 offen sc0 sc1
  s_endpgm
k_A_rdy_spin:
  s_mov_b32 s67, 0
k_A_rdy_loop:
  buffer_load_dword v221, v209, s[48:51], s100 offen sc1
  s_waitcnt vmcnt(0)
  v_readfirstlane_b32 s66, v221
  s_add_u32 s67, s67, 1
  s_cmp_gt_u32 s67, 2000000
  s_cbranch_scc1 k_A_rdy_ok
  s_bfe_u32 s66, s66, 524288
  s_cmp_eq_u32 s66, 1
  s_cbranch_scc0 k_A_rdy_loop
  s_branch k_A_rdy_ok
k_A_c0_spin:
  s_mov_b32 s67, 0
  s_add_u32 s68, s82, 65536
k_A_c0_loop:
  buffer_load_dword v207, v209, s[44:47], s68 offen sc1
  s_waitcnt vmcnt(0)
  v_readfirstlane_b32 s66, v207
  s_add_u32 s67, s67, 1
  s_cmp_gt_u32 s67, 2000000
  s_cbranch_scc1 k_A_c0_ok
  s_bfe_u32 s66, s66, 524288
  s_cmp_eq_u32 s66, 8
  s_cbranch_scc0 k_A_c0_loop
  s_branch k_A_c0_ok
k_A2_c1_spin:
  s_mov_b32 s67, 0
  s_add_u32 s68, s82, 0
k_A2_c1_loop:
  buffer_load_dword v207, v209, s[44:47], s68 offen sc1
  s_waitcnt vmcnt(0)
  v_readfirstlane_b32 s66, v207
  s_add_u32 s67, s67, 1
  s_cmp_gt_u32 s67, 2000000
  s_cbranch_scc1 k_A2_c1_ok
  s_bfe_u32 s66, s66, 524288
  s_cmp_eq_u32 s66, 8
  s_cbranch_scc0 k_A2_c1_loop
  s_branch k_A2_c1_ok
k_A2_cH_spin:
  s_mov_b32 s67, 0
  s_add_u32 s68, s82, 0
k_A2_cH_loop:
  buffer_load_dword v207, v209, s[44:47], s68 offen sc1
  s_waitcnt vmcnt(0)
  v_readfirstlane_b32 s66, v207
  s_add_u32 s67, s67, 1
  s_cmp_gt_u32 s67, 2000000
  s_cbranch_scc1 k_A2_cH_ok
  s_bfe_u32 s66, s66, 524296
  s_cmp_eq_u32 s66, 8
  s_cbranch_scc0 k_A2_cH_loop
  s_branch k_A2_cH_ok
k_A2_cO_spin:
  s_mov_b32 s67, 0
  s_add_u32 s68, s82, 65536
k_A2_cO_loop:
  buffer_load_dword v208, v209, s[44:47], s68 offen sc1
  s_waitcnt vmcnt(0)
  v_readfirstlane_b32 s66, v208
  s_add_u32 s67, s67, 1
  s_cmp_gt_u32 s67, 2000000
  s_cbranch_scc1 k_A2_cO_ok
  s_bfe_u32 s66, s66, 524304
  s_cmp_eq_u32 s66, 8
  s_cbranch_scc0 k_A2_cO_loop
  s_branch k_A2_cO_ok
k_B_rdy_spin:
  s_mov_b32 s67, 0
k_B_rdy_loop:
  buffer_load_dword v221, v209, s[48:51], s100 offen sc1
  s_waitcnt vmcnt(0)
  v_readfirstlane_b32 s66, v221
  s_add_u32 s67, s67, 1
  s_cmp_gt_u32 s67, 2000000
  s_cbranch_scc1 k_B_rdy_ok
  s_bfe_u32 s66, s66, 524288
  s_cmp_eq_u32 s66, 1
  s_cbranch_scc0 k_B_rdy_loop
  s_branch k_B_rdy_ok
k_B_kv_spin:
  s_mov_b32 s67, 0
  s_add_u32 s68, s80, 0
k_B_kv_loop:
  buffer_load_dword v207, v209, s[44:47], s68 offen sc1
  s_waitcnt vmcnt(0)
  v_readfirstlane_b32 s66, v207
  s_add_u32 s67, s67, 1
  s_cmp_gt_u32 s67, 2000000
  s_cbranch_scc1 k_B_kv_ok
  s_bfe_u32 s66, s66, 524288
  s_cmp_eq_u32 s66, 16
  s_cbranch_scc0 k_B_kv_loop
  s_branch k_B_kv_ok
k_B_c0_spin:
  s_mov_b32 s67, 0
  s_add_u32 s68, s82, 65536
k_B_c0_loop:
  buffer_load_dword v208, v209, s[44:47], s68 offen sc1
  s_waitcnt vmcnt(0)
  v_readfirstlane_b32 s66, v208
  s_add_u32 s67, s67, 1
  s_cmp_gt_u32 s67, 2000000
  s_cbranch_scc1 k_B_c0_ok
  s_bfe_u32 s66, s66, 524288
  s_cmp_eq_u32 s66, 8
  s_cbranch_scc0 k_B_c0_loop
  s_branch k_B_c0_ok
k_B2_c1_spin:
  s_mov_b32 s67, 0
  s_add_u32 s68, s82, 0
k_B2_c1_loop:
  buffer_load_dword v207, v209, s[44:47], s68 offen sc1
  s_waitcnt vmcnt(0)
  v_readfirstlane_b32 s66, v207
  s_add_u32 s67, s67, 1
  s_cmp_gt_u32 s67, 2000000
  s_cbranch_scc1 k_B2_c1_ok
  s_bfe_u32 s66, s66, 524288
  s_cmp_eq_u32 s66, 8
  s_cbranch_scc0 k_B2_c1_loop
  s_branch k_B2_c1_ok
k_B2_cH_spin:
  s_mov_b32 s67, 0
  s_add_u32 s68, s82, 0
k_B2_cH_loop:
  buffer_load_dword v207, v209, s[44:47], s68 offen sc1
  s_waitcnt vmcnt(0)
  v_readfirstlane_b32 s66, v207
  s_add_u32 s67, s67, 1
  s_cmp_gt_u32 s67, 2000000
  s_cbranch_scc1 k_B2_cH_ok
  s_bfe_u32 s66, s66, 524296
  s_cmp_eq_u32 s66, 8
  s_cbranch_scc0 k_B2_cH_loop
  s_branch k_B2_cH_ok
k_B2_cO_spin:
  s_mov_b32 s67, 0
  s_add_u32 s68, s82, 65536
k_B2_cO_loop:
  buffer_load_dword v208, v209, s[44:47], s68 offen sc1
  s_waitcnt vmcnt(0)
  v_readfirstlane_b32 s66, v208
  s_add_u32 s67, s67, 1
  s_cmp_gt_u32 s67, 2000000
  s_cbranch_scc1 k_B2_cO_ok
  s_bfe_u32 s66, s66, 524304
  s_cmp_eq_u32 s66, 8
  s_cbranch_scc0 k_B2_cO_loop
  s_branch k_B2_cO_ok
k_exit:
  s_endpgm
k_end:
.section .rodata,"a"
.p2align 6
.amdhsa_kernel recurrent_scan__linear_attn_block__glu_gated_glu__prompt_kernel
  .amdhsa_next_free_vgpr 512
  .amdhsa_next_free_sgpr 102
  .amdhsa_accum_offset 256
  .amdhsa_group_segment_fixed_size 0
  .amdhsa_kernarg_size 80
  .amdhsa_user_sgpr_count 2
  .amdhsa_user_sgpr_kernarg_segment_ptr 1
  .amdhsa_system_sgpr_workgroup_id_x 1
.end_amdhsa_kernel
```
